```python
import torch

def _softmax(x, axis=-1):
    return torch.softmax(x, dim=axis)
def _gelu(x):
    return torch.nn.functional.gelu(x, approximate="tanh")
def _silu(x):
    return torch.nn.functional.silu(x)
def _sigmoid(x):
    return torch.sigmoid(x)
def _layernorm(x, axis=-1, eps=1e-5):
    m = x.mean(dim=axis, keepdim=True)
    v = x.var(dim=axis, keepdim=True, unbiased=False)
    return (x - m) / torch.sqrt(v + eps)
def _scatter_add(tgt, idx, src, axis=0):
    return tgt.clone().index_add_(axis, idx, src)
def _segment_sum(src, seg, n):
    out = torch.zeros((n,) + src.shape[1:], dtype=src.dtype)
    return out.index_add_(0, seg, src)
def _pad(x, pw):
    flat = tuple(v for pair in reversed(pw) for v in pair)
    return torch.nn.functional.pad(x, flat)

kernel_name = 'concat_heads__ssm_conv_s4d__spectral_gfnet__prompt'

def setup_inputs():

    _w = (lambda a: (lambda t: t.to(torch.bfloat16) if t.is_floating_point() else t)(torch.as_tensor(a)))
    def _A_setup():
        Bsz, L, D, N = 1, 2048, 576, 128
        return {
            "u": _w((lambda *s: torch.randn(*s, dtype=torch.bfloat16) * 0.05)(Bsz, L, D)),
            "log_A_real": _w((lambda *s: torch.randn(*s, dtype=torch.bfloat16) * 6.4)(D, N) * 0.5),
            "A_imag": _w((lambda *s: torch.randn(*s, dtype=torch.bfloat16) * 0.05)(D, N) * 3.14),
            "C_real": _w((lambda *s: torch.randn(*s, dtype=torch.bfloat16) * 0.05)(D, N) / N ** 0.5),
            "C_imag": _w((lambda *s: torch.randn(*s, dtype=torch.bfloat16) * 0.05)(D, N) / N ** 0.5),
            "log_dt": _w((lambda *s: torch.randn(*s, dtype=torch.bfloat16) * 0.05)(D) * 0.5 - 4.0),
            "D_skip": _w((lambda *s: torch.randn(*s, dtype=torch.bfloat16) * 0.05)(D)),
        }
    _A_in = _A_setup()

    def _B_setup():
        B, S, D = 1, 2048, 576
        Df = D // 2 + 1
        return {
            "x": _w((lambda *s: torch.randn(*s, dtype=torch.bfloat16) * 0.05)(B, S, D)),
            "w_r": _w((lambda *s: torch.randn(*s, dtype=torch.bfloat16) * 0.8)(S, Df) * 0.02),
            "w_i": _w((lambda *s: torch.randn(*s, dtype=torch.bfloat16) * 0.8)(S, Df) * 0.02),
        }
    _B_in = _B_setup()

    return {
        "A_u": _A_in["u"],
        "A_log_A_real": _A_in["log_A_real"],
        "A_A_imag": _A_in["A_imag"],
        "A_C_real": _A_in["C_real"],
        "A_C_imag": _A_in["C_imag"],
        "A_log_dt": _A_in["log_dt"],
        "A_D_skip": _A_in["D_skip"],
        "B_x": _B_in["x"],
        "B_w_r": _B_in["w_r"],
        "B_w_i": _B_in["w_i"],
    }

def reference(A_u, A_log_A_real, A_A_imag, A_C_real, A_C_imag, A_log_dt, A_D_skip, B_x, B_w_r, B_w_i):
    def _A_ref(u, log_A_real, A_imag, C_real, C_imag, log_dt, D_skip):
        L = u.shape[1]
        dt = torch.exp(log_dt)
        A = -torch.exp(log_A_real) + 1j * A_imag
        C = (C_real + 1j * C_imag) * dt[:, None]
        pos = (lambda x, dt: x.to(dt))(torch.arange(L), log_dt.dtype)
        P = torch.exp((A * dt[:, None])[:, :, None] * pos[None, None, :])
        K = 2.0 * torch.einsum("dn,dnl->dl", C, P).real
        L2 = 2 * L
        u_t = (lambda x, *d: x.permute(*d))(u, 0, 2, 1)
        Kf = (lambda x, *a, **k: torch.fft.rfft(x.float(), *a, **k))(K, L2)
        Uf = (lambda x, *a, **k: torch.fft.rfft(x.float(), *a, **k))(u_t, L2)
        y = (lambda x, *a, **k: torch.fft.irfft(x, *a, **k).to(torch.bfloat16))(Uf * Kf[None, :, :], L2)[:, :, :L]
        y = (lambda x, *d: x.permute(*d))(y, 0, 2, 1)
        return y + u * D_skip[None, None, :]

    def _B_ref(x, w_r, w_i):
        B, S, D = x.shape
        X = (lambda x, axes=(-2,-1): torch.fft.rfft2(x.float(), dim=axes))(x, axes=(-2, -1))
        W = w_r + 1j * w_i
        X = X * W
        y = (lambda x, s, axes=(-2,-1): torch.fft.irfft2(x, s=s, dim=axes).to(torch.bfloat16))(X, (S, D), axes=(-2, -1))
        return y

    a = _A_ref(A_u, A_log_A_real, A_A_imag, A_C_real, A_C_imag, A_log_dt, A_D_skip)
    b = _B_ref(B_x, B_w_r, B_w_i)
    return torch.concatenate([a, b], axis=-1)
```

```asm
; @launch grid=(236,1,1) block=(768,1,1) lds=163840
.amdgcn_target "amdgcn-amd-amdhsa--gfx950"
.text
.globl concat_heads__ssm_conv_s4d__spectral_gfnet__prompt_kernel
.p2align 8
.type concat_heads__ssm_conv_s4d__spectral_gfnet__prompt_kernel,@function
concat_heads__ssm_conv_s4d__spectral_gfnet__prompt_kernel:
    s_cmp_ge_u32 s2, 236
    s_cbranch_scc1 L_exit
    s_load_dwordx16 s[8:23], s[0:1], 0
    s_load_dwordx8 s[56:63], s[0:1], 64
    s_load_dwordx2 s[24:25], s[0:1], 96
    s_setprio 3
    v_lshrrev_b32 v2, 6, v0
    s_getpc_b64 s[4:5]
L_pc:
    v_and_b32 v1, 63, v0
    v_readfirstlane_b32 s31, v2
    s_add_u32 s6, s4, L_tab-L_pc
    s_addc_u32 s7, s5, 0
    v_lshlrev_b32 v7, 4, v1
    s_and_b32 s33, s2, 7
    s_bfe_u32 s32, s2, 0x40003
    s_cmp_ge_u32 s31, 5
    s_cbranch_scc1 L_pf2
    s_cmp_eq_u32 s31, 4
    s_cbranch_scc1 L_pf1
    s_mul_i32 s3, s31, 3
    s_cmp_lt_u32 s2, 128
    s_cselect_b32 s30, 8, 4
    s_mov_b32 s28, 155904
    s_cselect_b32 s28, 83632, s28
    s_mov_b32 s29, 31744
    s_cselect_b32 s29, 20480, s29
    s_min_u32 s3, s3, s30
    s_lshl_b32 s3, s3, 10
    s_add_u32 m0, s3, s28
    s_add_u32 s3, s3, s29
    v_add_u32 v4, s3, v7
    global_load_lds_dwordx4 v4, s[6:7]
    global_load_lds_dwordx4 v4, s[6:7] offset:1024
    global_load_lds_dwordx4 v4, s[6:7] offset:2048
    s_branch L_pf2
L_pf1:
    s_cmp_lt_u32 s2, 128
    s_cselect_b32 s3, 2, 0
    s_cselect_b32 s30, 0, L_A2-L_pc
    v_lshl_add_u32 v4, s32, 10, v7
    v_lshlrev_b32 v4, s3, v4
    v_add_u32 v4, s30, v4
    global_load_dword v167, v4, s[4:5]
L_pf2:
    v_and_b32 v2, 15, v1
    v_lshrrev_b32 v3, 4, v1
    s_cmp_ge_u32 s2, 128
    s_cbranch_scc1 L_A0
L_B:
    s_lshl_b32 s30, s33, 4
    s_add_u32 s30, s30, s32
    s_mov_b32 s26, 0x1000000
    s_mov_b32 s27, 0x20000
    s_cmp_ge_u32 s31, 9
    s_cbranch_scc1 L_B_stub
    s_mul_i32 s44, s30, 1152
    s_lshl_b32 s3, s31, 7
    s_add_u32 s44, s44, s3
    s_add_u32 s45, s44, 147456
    s_add_u32 s46, s44, 294912
    s_add_u32 s47, s44, 442368
    v_mul_u32_u24 v4, 589824, v3
    v_lshl_add_u32 v4, v2, 3, v4
    s_waitcnt lgkmcnt(0)
    s_mov_b64 s[8:9], s[22:23]
    s_mov_b32 s10, 2359296
    s_mov_b32 s11, 0x20000
    buffer_load_dwordx2 v[112:113], v4, s[8:11], s44 offen
    buffer_load_dwordx2 v[114:115], v4, s[8:11], s45 offen
    buffer_load_dwordx2 v[116:117], v4, s[8:11], s46 offen
    buffer_load_dwordx2 v[118:119], v4, s[8:11], s47 offen
    buffer_load_dword v99, off, s[24:27], 0
    s_branch L_B_main
L_A0:
    s_mul_i32 s30, s33, 13
    s_min_u32 s3, s33, 4
    s_add_u32 s30, s30, s3
    s_add_u32 s30, s30, s32
    s_mul_i32 s3, s30, 43
    s_lshr_b32 s3, s3, 8
    s_mul_i32 s4, s3, 6
    s_sub_u32 s4, s30, s4
    s_lshl_b32 s4, s4, 2
    s_lshr_b32 s4, 0xdb9630, s4
    s_and_b32 s4, s4, 15
    s_lshl_b32 s3, s3, 4
    s_add_u32 s3, s3, s4
    s_lshl_b32 s54, s3, 2
    s_lshr_b32 s48, s31, 1
    s_lshr_b32 s49, s31, 2
    s_xor_b32 s49, s49, s31
    s_and_b32 s49, s49, 1
    s_and_b32 s50, s31, 14
    s_add_u32 s50, s50, s54
    s_add_u32 s51, s50, s49
    s_lshl_b32 s51, s51, 7
    v_lshl_add_u32 v4, v1, 1, s51
    v_mov_b32 v5, s50
    s_waitcnt lgkmcnt(0)
    global_load_ushort v164, v5, s[18:19]
    global_load_ushort v160, v4, s[10:11]
    global_load_ushort v161, v4, s[12:13]
    global_load_ushort v162, v4, s[14:15]
    global_load_ushort v163, v4, s[16:17]
    global_load_ushort v9, v5, s[20:21]
L_A:
    s_mul_i32 s3, s32, 182016
    s_lshl_b32 s4, s33, 7
    s_add_u32 s3, s3, s4
    v_and_b32 v32, 255, v0
    v_lshrrev_b32 v32, 1, v32
    v_and_b32 v6, 1, v0
    v_lshl_add_u32 v6, v6, 7, s3
    v_mul_u32_u24 v32, 1152, v32
    v_add_u32 v32, v32, v6
    v_add_u32 v33, 147456, v32
    v_min_u32 v32, 2359168, v32
    v_min_u32 v33, 2359168, v33
    s_mul_i32 s3, s32, 19
    s_lshl_b32 s4, s48, 6
    s_add_u32 s3, s3, s4
    v_add_u32 v35, s3, v1
    v_and_b32 v35, 255, v35
    s_xor_b32 s3, s49, 1
    s_lshl_b32 s3, s3, 8
    v_add_u32 v35, s3, v35
    s_cmp_lt_u32 s31, 8
    s_cselect_b32 s34, s49, 0
    v_mul_u32_u24 v39, 4608, v35
    v_add_u32 v39, s54, v39
    s_mov_b32 s26, 0x1000000
    s_mov_b32 s27, 0x20000
    s_mov_b32 s52, 0x05040100
    s_mov_b32 s53, 0x07060302
    s_mul_i32 s55, s48, 16768
    s_add_u32 s55, s55, 55296
    s_mul_i32 s57, s49, 3088
    s_add_u32 s57, s57, s55
    s_mul_i32 s58, s31, 4608
    s_mov_b32 m0, s58
    v_mov_b32 v100, 0
    v_mov_b32 v101, 0
    v_mov_b32 v102, 0
    v_mov_b32 v103, 0
    s_lshl_b32 s56, s49, 10
    s_add_u32 s56, s56, s55
    s_add_u32 s3, s57, 10592
    v_mov_b32 v4, s3
    v_cmp_eq_u32 vcc, 2, v1
    s_mov_b32 s3, 163072
    s_mov_b64 exec, 7
    v_lshl_add_u32 v5, v1, 4, s3
    v_cndmask_b32 v5, v5, v4, vcc
    ds_write_b128 v5, v[100:103]
    s_mov_b64 exec, -1
    s_lshl_b32 s3, s49, 9
    s_sub_u32 s3, s55, s3
    s_add_u32 s3, s3, 1068
    v_lshlrev_b32 v4, 3, v1
    v_sub_u32 v15, s3, v4
    v_add_u32 v54, s55, v4
    v_lshlrev_b32 v6, 4, v3
    v_lshl_add_u32 v4, v2, 5, s55
    v_sub_u32 v48, v4, v6
    v_add_u32 v53, v4, v6
    v_lshl_add_u32 v4, v2, 4, s55
    v_add_u32 v52, v4, v6
    v_lshl_add_u32 v4, v2, 3, s55
    v_sub_u32 v50, v4, v6
    v_mov_b32 v55, s55
    v_add_u32 v7, 155904, v7
    s_setprio 1
    s_cmp_eq_u32 s49, 0
    s_cbranch_scc0 L_A_z1
    v_lshl_add_u32 v4, v1, 4, s55
    ds_write_b128 v4, v[100:103] offset:4864
    ds_write_b128 v4, v[100:103] offset:5472
    s_branch L_A_z2
L_A_z1:
    v_min_u32 v4, 4, v2
    v_cmp_lt_u32 vcc, 2, v4
    v_mul_u32_u24 v5, 1216, v3
    v_lshl_add_u32 v4, v4, 4, s55
    v_mov_b32 v6, 1040
    v_cndmask_b32 v6, 0, v6, vcc
    v_add3_u32 v4, v4, v5, v6
    ds_write_b128 v4, v[100:103]
L_A_z2:
    s_cmp_ge_u32 s31, 4
    s_cbranch_scc1 L_A_tb
    s_waitcnt vmcnt(6)
L_A_tb:
    s_waitcnt lgkmcnt(0)
    s_barrier
    s_cmp_lt_u32 s31, 8
    s_cbranch_scc1 L_A_nopf
    global_load_dword v43, v32, s[8:9]
    s_cmp_eq_u32 s31, 8
    s_cbranch_scc0 L_A_nopf
    global_load_dword v47, v33, s[8:9]
L_A_nopf:
    ds_read_b128 v[10:13], v7 offset:5120
    ds_read_b128 v[96:99], v7 offset:6144
    ds_read_b128 v[16:19], v7
    ds_read_b128 v[20:23], v7 offset:1024
    ds_read_b128 v[24:27], v7 offset:2048
    ds_read_b128 v[28:31], v7 offset:3072
    s_sub_u32 s4, s55, 16
    s_waitcnt lgkmcnt(4)
    v_add_u32 v10, s58, v10
    v_add_u32 v11, s58, v11
    v_add_u32 v12, s57, v12
    v_add_u32 v13, s56, v13
    v_add_u32 v14, s56, v96
    v_add_u32 v49, s55, v97
    v_add_u32 v51, s55, v98
    v_mov_b32 v8, v99
    v_max_i32 v14, s4, v14
    s_cmp_eq_u32 s34, 1
    s_cbranch_scc0 L_A_nog
    global_load_dwordx3 v[32:34], v39, s[8:9]
    global_load_dwordx3 v[36:38], v39, s[8:9] offset:1152
    global_load_dwordx3 v[40:42], v39, s[8:9] offset:2304
    s_waitcnt vmcnt(3)
    s_branch L_A2
L_A_nog:
    s_cmp_ge_u32 s31, 8
    s_cbranch_scc1 L_A_pw2
    s_waitcnt vmcnt(0)
L_A_pw2:
    s_waitcnt vmcnt(2)
    s_cmp_eq_u32 s31, 8
    s_cbranch_scc1 L_A2
    s_waitcnt vmcnt(1)
    s_branch L_A2
L_B_stub:
    v_mov_b32 v62, 105136
    v_mov_b32 v63, 1
    v_mov_b32 v8, 0
    v_mov_b32 v9, 0
    v_mov_b32 v10, 0
    v_mov_b32 v11, 0
    s_mov_b64 exec, 1
    ds_write_b128 v62, v[8:11]
    s_mov_b64 exec, -1
    s_lshl_b32 s3, s30, 6
    s_add_u32 s3, s3, 38912
    s_load_dwordx8 s[32:39], s[6:7], s3
    s_add_u32 s3, s3, 32
    s_load_dwordx4 s[40:43], s[6:7], s3
    s_cmp_lt_u32 s30, 16
    s_cselect_b32 s3, 768, 0
    s_and_b32 s4, s30, 2
    s_mul_i32 s4, s4, 192
    s_add_u32 s3, s3, s4
    s_lshl_b32 s4, s31, 5
    s_add_u32 s3, s3, s4
    s_add_u32 s3, s3, 47104
    s_load_dwordx4 s[48:51], s[6:7], s3
    s_add_u32 s3, s3, 16
    s_load_dwordx4 s[96:99], s[6:7], s3
    s_sub_u32 s5, s31, 9
    s_mul_i32 s3, s5, 3072
    s_add_u32 s4, s3, 94896
    s_mov_b32 m0, s4
    s_and_b32 s4, s30, 0x71
    s_cmp_eq_u32 s4, 1
    s_mov_b32 s4, 0
    s_cselect_b32 s4, 10240, s4
    s_add_u32 s3, s3, s4
    v_add_u32 v4, s3, v7
    v_mul_u32_u24 v5, 7282, v1
    v_lshrrev_b32 v5, 16, v5
    v_mul_u32_u24 v5, 9104, v5
    v_add_u32 v24, v5, v7
    s_waitcnt lgkmcnt(0)
    s_mov_b64 s[20:21], s[60:61]
    s_mov_b32 s22, 4718592
    s_mov_b32 s23, 0x20000
    s_mov_b64 s[100:101], s[56:57]
    s_mov_b64 s[16:17], s[58:59]
    s_mov_b64 s[12:13], s[56:57]
    s_mov_b64 s[16:17], s[58:59]
    s_mov_b32 s14, 1183744
    s_mov_b32 s15, 0x20000
    s_mov_b32 s18, 1183744
    s_mov_b32 s19, 0x20000
    s_sub_u32 s62, s31, 9
    s_cmp_eq_u32 s33, 0
    s_cselect_b32 s8, s12, s16
    s_cselect_b32 s9, s13, s17
    s_cselect_b32 s44, s16, s12
    s_cselect_b32 s45, s17, s13
    s_mov_b32 s10, 1183744
    s_mov_b32 s11, 0x20000
    s_mov_b32 s46, 1183744
    s_mov_b32 s47, 0x20000
    s_mul_i32 s3, s62, 388416
    s_add_u32 s52, s41, s3
    s_mul_i32 s63, s62, 6048
    s_add_u32 s63, s63, 18688
    s_xor_b32 s62, s33, 19152
    s_add_u32 s62, s62, s63
    s_add_u32 s63, s63, s33
    global_load_lds_dwordx4 v4, s[6:7]
    global_load_lds_dwordx4 v4, s[6:7] offset:1024
    global_load_lds_dwordx4 v4, s[6:7] offset:2048
    global_load_lds_dwordx4 v4, s[6:7] offset:3072
    s_barrier
    s_mov_b32 s3, s52
    s_bitset0_b32 exec_hi, 31
    s_mov_b32 m0, s63
    s_add_u32 s63, s63, 1008
    buffer_load_dwordx4 v24, s[8:11], s3 offen lds
    s_add_u32 s3, s3, 64736
    s_mov_b32 m0, s63
    s_add_u32 s63, s63, 1008
    buffer_load_dwordx4 v24, s[8:11], s3 offen lds
    s_add_u32 s3, s3, 64736
    s_mov_b32 m0, s63
    s_add_u32 s63, s63, 1008
    buffer_load_dwordx4 v24, s[8:11], s3 offen lds
    s_add_u32 s3, s3, 64736
    s_mov_b32 m0, s63
    s_add_u32 s63, s63, 1008
    buffer_load_dwordx4 v24, s[8:11], s3 offen lds
    s_add_u32 s3, s3, 64736
    s_mov_b32 m0, s63
    s_add_u32 s63, s63, 1008
    buffer_load_dwordx4 v24, s[8:11], s3 offen lds
    s_add_u32 s3, s3, 64736
    s_mov_b32 m0, s63
    s_add_u32 s63, s63, 1008
    buffer_load_dwordx4 v24, s[8:11], s3 offen lds
    s_add_u32 s3, s3, 64736
    s_mov_b32 m0, s63
    s_add_u32 s63, s63, 1008
    buffer_load_dwordx4 v24, s[8:11], s3 offen lds
    s_mov_b64 exec, -1
    s_branch L_B_help
L_B_main:
    s_setprio 2
    v_mov_b32 v62, 105136
    v_mov_b32 v63, 1
    s_mov_b32 s52, 0x05040100
    s_mov_b32 s53, 0x07060302
    s_mov_b64 s[20:21], s[60:61]
    s_mov_b32 s22, 4718592
    s_mov_b32 s23, 0x20000
    s_mov_b64 s[100:101], s[56:57]
    s_mov_b64 s[16:17], s[58:59]
    v_lshrrev_b32 v4, 1, v2
    v_and_b32 v5, 1, v2
    v_lshlrev_b32 v6, 9, v3
    v_add_u32 v6, s30, v6
    v_mul_u32_u24 v6, v6, v4
    v_lshl_add_u32 v6, v5, 9, v6
    v_lshlrev_b32 v8, 7, v4
    v_cmp_eq_u32 vcc, 1, v2
    v_mov_b32 v124, 0x400
    s_mov_b32 s3, 0x3a000000
    v_cndmask_b32 v6, v6, 0, vcc
    v_cndmask_b32 v8, v8, v124, vcc
    v_cvt_f32_u32 v6, v6
    v_cvt_f32_u32 v8, v8
    v_mul_f32 v6, s3, v6
    v_mul_f32 v8, s3, v8
    v_cos_f32 v120, v6
    v_add_f32 v6, v6, v8
    v_cos_f32 v121, v6
    v_add_f32 v6, v6, v8
    v_cos_f32 v122, v6
    v_add_f32 v6, v6, v8
    v_cos_f32 v123, v6
    v_cvt_pk_bf16_f32 v60, v120, v121
    v_cvt_pk_bf16_f32 v61, v122, v123
    v_mul_u32_u24 v4, 1168, v2
    v_lshl_add_u32 v4, v3, 5, v4
    s_lshl_b32 s3, s31, 7
    v_add_u32 v4, s3, v4
    v_bfe_u32 v5, v1, 4, 1
    v_bfe_u32 v8, v1, 1, 1
    v_lshl_add_u32 v5, v5, 1, v8
    v_min_u32 v5, 2, v5
    v_lshlrev_b32 v5, 3, v5
    v_and_b32 v8, 1, v1
    v_mad_u32_u24 v5, v8, 24, v5
    v_bfe_u32 v8, v1, 2, 2
    v_mad_u32_u24 v5, v8, 48, v5
    v_lshrrev_b32 v9, 5, v1
    v_mul_u32_u24 v8, 576, v9
    s_mul_i32 s3, s31, 2336
    v_add3_u32 v5, v5, v8, s3
    s_mul_i32 s44, s30, 25728
    s_mul_i32 s3, s31, 3072
    s_add_u32 s44, s44, s3
    s_add_u32 s44, s44, 4194304
    s_cmp_eq_u32 s31, 0
    s_cselect_b32 s3, 0, 1024
    s_add_u32 s44, s44, s3
    s_cmp_eq_u32 s31, 0
    s_movk_i32 s3, 768
    s_cselect_b32 s3, 1024, s3
    s_add_u32 s45, s44, s3
    s_add_u32 s46, s45, s3
    s_add_u32 s47, s46, s3
    v_add_u32 v7, 83632, v7
    v_mov_b32 v6, 1073741824
    v_and_b32 v8, 31, v1
    s_cmp_ge_u32 s31, 4
    s_cbranch_scc1 L_B_w6
    s_waitcnt vmcnt(5)
L_B_w6:
    s_barrier
    s_cmp_eq_u32 s31, 8
    s_cbranch_scc1 L_B_c24e
    ds_read_b128 v[16:19], v7 offset:0
    ds_read_b128 v[20:23], v7 offset:1024
    ds_read_b128 v[24:27], v7 offset:2048
    ds_read_b128 v[28:31], v7 offset:3072
    s_cmp_eq_u32 s31, 0
    s_cbranch_scc1 L_B_sp1
    ds_read_b128 v[56:59], v7 offset:10240
    ds_read_b128 v[32:35], v7 offset:4096
    ds_read_b128 v[36:39], v7 offset:5120
    ds_read_b128 v[40:43], v7 offset:6144
    ds_read_b128 v[44:47], v7 offset:7168
    ds_read_b128 v[48:51], v7 offset:8192
    ds_read_b128 v[52:55], v7 offset:9216
    v_cmp_gt_u32 vcc, 24, v8
    s_waitcnt lgkmcnt(6)
    v_mad_u32_u24 v8, v9, 24, v58
    s_branch L_B_sp1e
L_B_sp1:
    ds_read_b64 v[32:33], v7 offset:4096
    ds_read_b32 v58, v7 offset:10248
    v_cmp_lt_u32 vcc, 12, v8
    v_subrev_u32 v10, 13, v8
    s_nop 0
    v_cndmask_b32 v10, v8, v10, vcc
    v_cndmask_b32 v11, 0, -1, vcc
    v_and_b32 v12, 12, v10
    v_add_u32 v12, v12, v10
    v_cmp_lt_u32 vcc, 11, v10
    s_nop 1
    v_cndmask_b32 v12, v12, 4, vcc
    v_lshl_add_u32 v12, v9, 5, v12
    v_lshlrev_b32 v12, 4, v12
    v_add_u32 v12, 83632, v12
    ds_read_b128 v[120:123], v12
    ds_read_b128 v[124:127], v12 offset:1024
    ds_read_b128 v[128:131], v12 offset:2048
    ds_read_b64 v[34:35], v12 offset:4104
    ds_read_b128 v[36:39], v12 offset:5120
    ds_read_b128 v[40:43], v12 offset:6144
    ds_read_b128 v[44:47], v12 offset:7168
    ds_read_b128 v[48:51], v12 offset:8192
    ds_read_b128 v[52:55], v12 offset:9216
    ds_read_b64 v[56:57], v12 offset:10240
    s_waitcnt lgkmcnt(7)
    v_bfi_b32 v64, v11, 0, v126
    v_and_b32 v70, v11, v126
    v_bfi_b32 v76, v11, 0, v120
    v_and_b32 v82, v11, v120
    v_bfi_b32 v65, v11, 0, v127
    v_and_b32 v71, v11, v127
    v_bfi_b32 v77, v11, 0, v121
    v_and_b32 v83, v11, v121
    v_bfi_b32 v66, v11, 0, v128
    v_and_b32 v72, v11, v128
    v_bfi_b32 v78, v11, 0, v122
    v_and_b32 v84, v11, v122
    v_bfi_b32 v67, v11, 0, v129
    v_and_b32 v73, v11, v129
    v_bfi_b32 v79, v11, 0, v123
    v_and_b32 v85, v11, v123
    v_bfi_b32 v68, v11, 0, v130
    v_and_b32 v74, v11, v130
    v_bfi_b32 v80, v11, 0, v124
    v_and_b32 v86, v11, v124
    v_bfi_b32 v69, v11, 0, v131
    v_and_b32 v75, v11, v131
    v_bfi_b32 v81, v11, 0, v125
    v_and_b32 v87, v11, v125
    v_cmp_gt_u32 vcc, 26, v8
    v_and_b32 v8, 16, v11
    v_add_u32 v8, v8, v10
    v_lshl_add_u32 v8, v9, 5, v8
L_B_sp1e:
    v_lshlrev_b32 v8, 4, v8
    v_cndmask_b32 v6, v6, v8, vcc
L_B_c24e:
    s_waitcnt vmcnt(0)
    v_perm_b32 v120, v114, v112, s52
    v_perm_b32 v121, v118, v116, s52
    v_perm_b32 v122, v114, v112, s53
    v_perm_b32 v123, v118, v116, s53
    v_perm_b32 v124, v115, v113, s52
    v_perm_b32 v125, v119, v117, s52
    v_perm_b32 v126, v115, v113, s53
    v_perm_b32 v127, v119, v117, s53
    v_mfma_f32_16x16x16_bf16 v[132:135], v[120:121], v[60:61], 0
    v_mfma_f32_16x16x16_bf16 v[136:139], v[122:123], v[60:61], 0
    v_mfma_f32_16x16x16_bf16 v[140:143], v[124:125], v[60:61], 0
    v_mfma_f32_16x16x16_bf16 v[144:147], v[126:127], v[60:61], 0
    s_nop 5
    v_cvt_pk_bf16_f32 v148, v132, v136
    v_cvt_pk_bf16_f32 v150, v133, v137
    v_cvt_pk_bf16_f32 v152, v134, v138
    v_cvt_pk_bf16_f32 v154, v135, v139
    v_cvt_pk_bf16_f32 v149, v140, v144
    v_cvt_pk_bf16_f32 v151, v141, v145
    ds_write_b128 v4, v[148:151] offset:0
    v_cvt_pk_bf16_f32 v153, v142, v146
    v_cvt_pk_bf16_f32 v155, v143, v147
    ds_write_b128 v4, v[152:155] offset:16
    s_waitcnt lgkmcnt(0)
    s_barrier
    s_cmp_eq_u32 s31, 8
    s_cbranch_scc1 L_B_h8
    ds_read_b64_tr_b16 v[120:121], v5 offset:0
    ds_read_b64_tr_b16 v[122:123], v5 offset:192
    ds_read_b64_tr_b16 v[124:125], v5 offset:384
    ds_read_b64_tr_b16 v[126:127], v5 offset:1168
    ds_read_b64_tr_b16 v[128:129], v5 offset:1360
    ds_read_b64_tr_b16 v[130:131], v5 offset:1552
    s_cmp_eq_u32 s31, 0
    s_cbranch_scc1 L_B_sp2
    s_waitcnt lgkmcnt(4)
    v_mfma_f32_32x32x16_bf16 v[132:147], v[120:123], v[22:25], 0
    v_mfma_f32_32x32x16_bf16 v[148:163], v[120:123], v[16:19], 0
    s_waitcnt lgkmcnt(2)
    v_mfma_f32_32x32x16_bf16 v[132:147], v[124:127], v[26:29], v[132:147]
    v_mfma_f32_32x32x16_bf16 v[148:163], v[124:127], v[20:23], v[148:163]
    s_waitcnt lgkmcnt(0)
    v_mfma_f32_32x32x16_bf16 v[132:147], v[128:131], v[30:33], v[132:147]
    v_mfma_f32_32x32x16_bf16 v[148:163], v[128:131], v[24:27], v[148:163]
    s_branch L_B_sp2e
L_B_sp2:
    s_waitcnt lgkmcnt(4)
    v_mfma_f32_32x32x16_bf16 v[132:147], v[120:123], v[64:67], 0
    v_mfma_f32_32x32x16_bf16 v[148:163], v[120:123], v[76:79], 0
    s_waitcnt lgkmcnt(2)
    v_mfma_f32_32x32x16_bf16 v[132:147], v[124:127], v[68:71], v[132:147]
    v_mfma_f32_32x32x16_bf16 v[148:163], v[124:127], v[80:83], v[148:163]
    s_waitcnt lgkmcnt(0)
    v_mfma_f32_32x32x16_bf16 v[132:147], v[128:131], v[72:75], v[132:147]
    v_mfma_f32_32x32x16_bf16 v[148:163], v[128:131], v[84:87], v[148:163]
L_B_sp2e:
    s_waitcnt vmcnt(0)
    v_readfirstlane_b32 s28, v99
    s_nop 0
    s_add_u32 s28, s28, 1
    s_and_b32 s28, s28, 0xbfffbfff
    v_mov_b32 v99, s28
    v_mov_b32 v103, s28
    v_mov_b32 v107, s28
    v_mov_b32 v111, s28
    s_lshl_b32 s3, s30, 6
    s_add_u32 s3, s3, 38912
    s_load_dwordx8 s[32:39], s[6:7], s3
    s_add_u32 s3, s3, 32
    s_load_dwordx4 s[40:43], s[6:7], s3
    s_cmp_lt_u32 s30, 16
    s_cselect_b32 s3, 768, 0
    s_and_b32 s4, s30, 2
    s_mul_i32 s4, s4, 192
    s_add_u32 s3, s3, s4
    s_lshl_b32 s4, s31, 5
    s_add_u32 s3, s3, s4
    s_add_u32 s3, s3, 47104
    s_load_dwordx4 s[48:51], s[6:7], s3
    s_add_u32 s3, s3, 16
    s_load_dwordx4 s[96:99], s[6:7], s3
    v_pk_mul_f32 v[164:165], v[132:133], v[46:47]
    v_pk_mul_f32 v[166:167], v[134:135], v[48:49]
    v_pk_mul_f32 v[132:133], v[132:133], v[34:35]
    v_pk_mul_f32 v[134:135], v[134:135], v[36:37]
    v_pk_fma_f32 v[132:133], v[148:149], v[46:47], v[132:133] neg_lo:[1,0,0] neg_hi:[1,0,0]
    v_pk_fma_f32 v[134:135], v[150:151], v[48:49], v[134:135] neg_lo:[1,0,0] neg_hi:[1,0,0]
    v_pk_fma_f32 v[148:149], v[148:149], v[34:35], v[164:165]
    v_pk_fma_f32 v[150:151], v[150:151], v[36:37], v[166:167]
    v_pk_mul_f32 v[164:165], v[136:137], v[50:51]
    v_pk_mul_f32 v[166:167], v[138:139], v[52:53]
    v_pk_mul_f32 v[136:137], v[136:137], v[38:39]
    v_pk_mul_f32 v[138:139], v[138:139], v[40:41]
    v_pk_fma_f32 v[136:137], v[152:153], v[50:51], v[136:137] neg_lo:[1,0,0] neg_hi:[1,0,0]
    v_pk_fma_f32 v[138:139], v[154:155], v[52:53], v[138:139] neg_lo:[1,0,0] neg_hi:[1,0,0]
    v_pk_fma_f32 v[152:153], v[152:153], v[38:39], v[164:165]
    v_pk_fma_f32 v[154:155], v[154:155], v[40:41], v[166:167]
    v_pk_mul_f32 v[164:165], v[140:141], v[54:55]
    v_pk_mul_f32 v[166:167], v[142:143], v[56:57]
    v_pk_mul_f32 v[140:141], v[140:141], v[42:43]
    v_pk_mul_f32 v[142:143], v[142:143], v[44:45]
    v_pk_fma_f32 v[140:141], v[156:157], v[54:55], v[140:141] neg_lo:[1,0,0] neg_hi:[1,0,0]
    v_pk_fma_f32 v[142:143], v[158:159], v[56:57], v[142:143] neg_lo:[1,0,0] neg_hi:[1,0,0]
    v_pk_fma_f32 v[156:157], v[156:157], v[42:43], v[164:165]
    v_pk_fma_f32 v[158:159], v[158:159], v[44:45], v[166:167]
    v_cvt_pk_bf16_f32 v120, v132, v133
    v_cvt_pk_bf16_f32 v121, v134, v135
    v_cvt_pk_bf16_f32 v122, v136, v137
    v_cvt_pk_bf16_f32 v123, v138, v139
    v_cvt_pk_bf16_f32 v124, v140, v141
    v_cvt_pk_bf16_f32 v125, v142, v143
    v_cvt_pk_bf16_f32 v126, v148, v149
    v_cvt_pk_bf16_f32 v127, v150, v151
    v_cvt_pk_bf16_f32 v128, v152, v153
    v_cvt_pk_bf16_f32 v129, v154, v155
    v_cvt_pk_bf16_f32 v130, v156, v157
    v_cvt_pk_bf16_f32 v131, v158, v159
    v_mfma_f32_32x32x16_bf16 v[132:147], v[22:25], v[120:123], 0
    v_mfma_f32_32x32x16_bf16 v[148:163], v[16:19], v[120:123], 0
    v_mfma_f32_32x32x16_bf16 v[132:147], v[26:29], v[124:127], v[132:147]
    v_mfma_f32_32x32x16_bf16 v[148:163], v[20:23], v[124:127], v[148:163]
    v_mfma_f32_32x32x16_bf16 v[132:147], v[30:33], v[128:131], v[132:147]
    v_mfma_f32_32x32x16_bf16 v[148:163], v[24:27], v[128:131], v[148:163]
    s_nop 11
    v_cvt_pk_bf16_f32 v96, v132, v148
    v_cvt_pk_bf16_f32 v97, v133, v149
    v_cvt_pk_bf16_f32 v98, v134, v150
    buffer_store_dwordx4 v[96:99], v6, s[24:27], s44 offen sc1
    v_cvt_pk_bf16_f32 v100, v135, v151
    v_cvt_pk_bf16_f32 v101, v136, v152
    v_cvt_pk_bf16_f32 v102, v137, v153
    buffer_store_dwordx4 v[100:103], v6, s[24:27], s45 offen sc1
    v_cvt_pk_bf16_f32 v104, v138, v154
    v_cvt_pk_bf16_f32 v105, v139, v155
    v_cvt_pk_bf16_f32 v106, v140, v156
    buffer_store_dwordx4 v[104:107], v6, s[24:27], s46 offen sc1
    v_cvt_pk_bf16_f32 v108, v141, v157
    v_cvt_pk_bf16_f32 v109, v142, v158
    v_cvt_pk_bf16_f32 v110, v143, v159
    buffer_store_dwordx4 v[108:111], v6, s[24:27], s47 offen sc1
L_B_p1done:
    s_barrier
    s_waitcnt lgkmcnt(0)
    s_mov_b32 s34, 0
    s_branch L_B_u3
L_B_h8:
    s_setprio 0
    s_lshl_b32 s3, s30, 6
    s_add_u32 s3, s3, 38912
    s_load_dwordx8 s[32:39], s[6:7], s3
    s_add_u32 s3, s3, 32
    s_load_dwordx4 s[40:43], s[6:7], s3
    s_cmp_lt_u32 s30, 16
    s_cselect_b32 s3, 768, 0
    s_and_b32 s4, s30, 2
    s_mul_i32 s4, s4, 192
    s_add_u32 s3, s3, s4
    s_lshl_b32 s4, s31, 5
    s_add_u32 s3, s3, s4
    s_add_u32 s3, s3, 47104
    s_load_dwordx4 s[48:51], s[6:7], s3
    s_add_u32 s3, s3, 16
    s_load_dwordx4 s[96:99], s[6:7], s3
    s_branch L_B_p1done
L_B_help:
    s_barrier
    s_setprio 1
    v_add_u32 v7, 83632, v7
    s_mul_i32 s57, s31, 102912
    s_add_u32 s57, s57, s32
    s_add_u32 s58, s57, 823296
    s_add_u32 s59, s58, 823296
    s_add_u32 s61, s59, 823296
    v_cmp_gt_u32 s[54:55], s40, v2
    v_lshlrev_b32 v10, 4, v2
    v_mul_u32_u24 v11, 25728, v3
    v_mov_b32 v12, 1073741824
    v_add_u32 v11, v11, v10
    v_cndmask_b32 v88, v12, v11, s[54:55]
    s_mul_i32 s4, s31, 832
    s_add_u32 s4, s4, 57008
    v_mul_u32_u24 v11, 208, v3
    v_add3_u32 v89, v11, v10, s4
    s_lshl_b32 s3, s37, 1
    s_add_u32 s3, s3, s31
    s_cmp_ge_u32 s3, 10
    s_cselect_b32 s56, 1, 0
    s_cmp_lt_u32 s31, 8
    s_cselect_b32 s56, 2, s56
    v_lshrrev_b32 v10, 1, v3
    v_lshl_add_u32 v10, v10, 6, v2
    v_cmp_eq_u32 vcc, 0, v10
    v_mul_i32_i24 v10, s39, v10
    v_add_u32 v10, s42, v10
    v_mov_b32 v15, s36
    v_cndmask_b32 v15, 0, v15, vcc
    v_bfe_u32 v11, v1, 3, 1
    v_and_b32 v12, 3, v1
    v_lshl_add_u32 v11, v11, 2, v12
    v_lshl_add_u32 v11, v3, 5, v11
    v_mul_u32_u24 v11, 208, v11
    v_and_b32 v12, 1, v3
    v_bfe_u32 v13, v1, 2, 1
    v_mad_i32_i24 v92, v12, s51, v10
    v_mad_i32_i24 v93, v12, s99, v10
    v_mad_i32_i24 v94, v13, s49, v11
    v_mad_i32_i24 v95, v13, s97, v11
    v_add_u32 v92, s50, v92
    v_add_u32 v93, s98, v93
    v_sub_u32 v14, v92, v15
    v_sub_u32 v15, v93, v15
    v_add_u32 v94, s48, v94
    v_add_u32 v95, s96, v95
    s_waitcnt vmcnt(7)
    s_mov_b64 exec, 1
    ds_add_u32 v62, v63 offset:8
    s_mov_b64 exec, -1
    s_mov_b32 s3, 1048576
L_B_spin8h:
    ds_read_b32 v13, v62 offset:8
    s_sub_u32 s3, s3, 1
    s_cbranch_scc1 L_B_spun8h
    s_waitcnt lgkmcnt(0)
    v_cmp_ne_u32 vcc, 3, v13
    s_nop 4
    s_cbranch_vccz L_B_spun8h
    s_setprio 0
    s_sleep 1
    s_branch L_B_spin8h
L_B_spun8h:
    s_setprio 1
    ds_read_b128 v[64:67], v7 offset:11264
    ds_read_b128 v[68:71], v7 offset:12288
    ds_read_b128 v[72:75], v7 offset:13312
    ds_read_b128 v[76:79], v7 offset:14336
    ds_read_b128 v[80:83], v7 offset:15360
    ds_read_b128 v[84:87], v7 offset:16384
    ds_read_b128 v[112:115], v7 offset:17408
    ds_read_b128 v[116:119], v7 offset:18432
    ds_read_b128 v[148:151], v7 offset:19456
    ds_read_b128 v[152:155], v7 offset:20480
    v_mov_b32 v96, 0
    v_mov_b32 v97, 0
    v_mov_b32 v98, 0
    v_mov_b32 v99, 0
    v_mov_b32 v100, 0
    v_mov_b32 v101, 0
    v_mov_b32 v102, 0
    v_mov_b32 v103, 0
    v_mov_b32 v104, 0
    v_mov_b32 v105, 0
    v_mov_b32 v106, 0
    v_mov_b32 v107, 0
    v_mov_b32 v108, 0
    v_mov_b32 v109, 0
    v_mov_b32 v110, 0
    v_mov_b32 v111, 0
    s_cmp_eq_u32 s31, 11
    s_cselect_b32 s34, s34, 0
    v_mov_b32 v16, 0
    v_mov_b32 v17, 0
    v_mov_b32 v18, 0
    v_mov_b32 v19, 0
    v_mov_b32 v20, 0
    v_mov_b32 v21, 0
    v_mov_b32 v22, 0
    v_mov_b32 v23, 0
    s_setprio 3
    s_barrier
    s_mov_b32 s3, s52
    s_bitset0_b32 exec_hi, 31
    s_mov_b32 m0, s62
    s_add_u32 s62, s62, 1008
    buffer_load_dwordx4 v24, s[44:47], s3 offen lds
    s_add_u32 s3, s3, 64736
    s_mov_b32 m0, s62
    s_add_u32 s62, s62, 1008
    buffer_load_dwordx4 v24, s[44:47], s3 offen lds
    s_add_u32 s3, s3, 64736
    s_mov_b32 m0, s62
    s_add_u32 s62, s62, 1008
    buffer_load_dwordx4 v24, s[44:47], s3 offen lds
    s_add_u32 s3, s3, 64736
    s_mov_b32 m0, s62
    s_add_u32 s62, s62, 1008
    buffer_load_dwordx4 v24, s[44:47], s3 offen lds
    s_add_u32 s3, s3, 64736
    s_mov_b32 m0, s62
    s_add_u32 s62, s62, 1008
    buffer_load_dwordx4 v24, s[44:47], s3 offen lds
    s_add_u32 s3, s3, 64736
    s_mov_b32 m0, s62
    s_add_u32 s62, s62, 1008
    buffer_load_dwordx4 v24, s[44:47], s3 offen lds
    s_add_u32 s3, s3, 64736
    s_mov_b32 m0, s62
    s_add_u32 s62, s62, 1008
    buffer_load_dwordx4 v24, s[44:47], s3 offen lds
    s_mov_b64 exec, -1
    s_waitcnt vmcnt(0)
    s_branch L_B_gw
L_B_u3:
    s_mul_i32 s57, s31, 102912
    s_add_u32 s57, s57, s32
    s_add_u32 s58, s57, 823296
    s_add_u32 s59, s58, 823296
    s_add_u32 s61, s59, 823296
    v_cmp_gt_u32 s[54:55], s40, v2
    v_lshlrev_b32 v10, 4, v2
    v_mul_u32_u24 v11, 25728, v3
    v_mov_b32 v12, 1073741824
    v_add_u32 v11, v11, v10
    v_cndmask_b32 v88, v12, v11, s[54:55]
    s_mul_i32 s4, s31, 832
    s_add_u32 s4, s4, 57008
    v_mul_u32_u24 v11, 208, v3
    v_add3_u32 v89, v11, v10, s4
    s_lshl_b32 s3, s37, 1
    s_add_u32 s3, s3, s31
    s_cmp_ge_u32 s3, 10
    s_cselect_b32 s56, 1, 0
    s_cmp_lt_u32 s31, 8
    s_cselect_b32 s56, 2, s56
    v_lshrrev_b32 v10, 1, v3
    v_lshl_add_u32 v10, v10, 6, v2
    v_cmp_eq_u32 vcc, 0, v10
    v_mul_i32_i24 v10, s39, v10
    v_add_u32 v10, s42, v10
    v_mov_b32 v15, s36
    v_cndmask_b32 v15, 0, v15, vcc
    v_bfe_u32 v11, v1, 3, 1
    v_and_b32 v12, 3, v1
    v_lshl_add_u32 v11, v11, 2, v12
    v_lshl_add_u32 v11, v3, 5, v11
    v_mul_u32_u24 v11, 208, v11
    v_and_b32 v12, 1, v3
    v_bfe_u32 v13, v1, 2, 1
    v_mad_i32_i24 v92, v12, s51, v10
    v_mad_i32_i24 v93, v12, s99, v10
    v_mad_i32_i24 v94, v13, s49, v11
    v_mad_i32_i24 v95, v13, s97, v11
    v_add_u32 v92, s50, v92
    v_add_u32 v93, s98, v93
    v_sub_u32 v14, v92, v15
    v_sub_u32 v15, v93, v15
    v_add_u32 v94, s48, v94
    v_add_u32 v95, s96, v95
    ds_read_b128 v[64:67], v7 offset:11264
    ds_read_b128 v[68:71], v7 offset:12288
    ds_read_b128 v[72:75], v7 offset:13312
    ds_read_b128 v[76:79], v7 offset:14336
    ds_read_b128 v[80:83], v7 offset:15360
    ds_read_b128 v[84:87], v7 offset:16384
    ds_read_b128 v[112:115], v7 offset:17408
    ds_read_b128 v[116:119], v7 offset:18432
    ds_read_b128 v[148:151], v7 offset:19456
    ds_read_b128 v[152:155], v7 offset:20480
    v_mov_b32 v96, 0
    v_mov_b32 v97, 0
    v_mov_b32 v98, 0
    v_mov_b32 v99, 0
    v_mov_b32 v100, 0
    v_mov_b32 v101, 0
    v_mov_b32 v102, 0
    v_mov_b32 v103, 0
    v_mov_b32 v104, 0
    v_mov_b32 v105, 0
    v_mov_b32 v106, 0
    v_mov_b32 v107, 0
    v_mov_b32 v108, 0
    v_mov_b32 v109, 0
    v_mov_b32 v110, 0
    v_mov_b32 v111, 0
    s_cmp_eq_u32 s31, 8
    s_cbranch_scc1 L_B_gw
    s_waitcnt vmcnt(0)
    buffer_load_dwordx4 v[120:123], v88, s[24:27], s57 offen sc1
    buffer_load_dwordx4 v[124:127], v88, s[24:27], s58 offen sc1
    buffer_load_dwordx4 v[128:131], v88, s[24:27], s59 offen sc1
    buffer_load_dwordx4 v[160:163], v88, s[24:27], s61 offen sc1
L_B_gw:
    s_setprio 1
    s_cmp_ge_u32 s31, 8
    s_cbranch_scc1 L_B_st1
    s_mov_b32 s3, 1048576
L_B_poll1:
    s_waitcnt vmcnt(0)
    v_cmp_ne_u32 vcc, s28, v123
    v_cmp_ne_u32 s[4:5], s28, v127
    v_cmp_ne_u32 s[6:7], s28, v131
    v_cmp_ne_u32 s[8:9], s28, v163
    s_or_b64 s[10:11], vcc, s[4:5]
    s_or_b64 s[12:13], s[6:7], s[8:9]
    s_or_b64 s[10:11], s[10:11], s[12:13]
    s_and_b64 s[10:11], s[10:11], s[54:55]
    s_cbranch_scc0 L_B_poll1x
    s_sub_u32 s3, s3, 1
    s_cbranch_scc1 L_B_poll1x
    s_sleep 1
    s_and_b64 exec, vcc, s[54:55]
    s_cbranch_scc0 L_B_poll1_0
    buffer_load_dwordx4 v[120:123], v88, s[24:27], s57 offen sc1
L_B_poll1_0:
    s_and_b64 exec, s[4:5], s[54:55]
    s_cbranch_scc0 L_B_poll1_1
    buffer_load_dwordx4 v[124:127], v88, s[24:27], s58 offen sc1
L_B_poll1_1:
    s_and_b64 exec, s[6:7], s[54:55]
    s_cbranch_scc0 L_B_poll1_2
    buffer_load_dwordx4 v[128:131], v88, s[24:27], s59 offen sc1
L_B_poll1_2:
    s_and_b64 exec, s[8:9], s[54:55]
    s_cbranch_scc0 L_B_poll1_3
    buffer_load_dwordx4 v[160:163], v88, s[24:27], s61 offen sc1
L_B_poll1_3:
    s_mov_b64 exec, -1
    s_branch L_B_poll1
L_B_poll1x:
    s_mov_b64 exec, s[54:55]
    ds_write_b128 v89, v[120:123] offset:0
    ds_write_b128 v89, v[124:127] offset:6656
    ds_write_b128 v89, v[128:131] offset:13312
    ds_write_b128 v89, v[160:163] offset:19968
    s_mov_b64 exec, -1
L_B_st1:
    s_waitcnt lgkmcnt(0)
    s_barrier
    s_cmp_eq_u32 s56, 0
    s_cbranch_scc1 L_B_p2skip
    s_cmp_eq_u32 s56, 1
    s_cbranch_scc1 L_B_p2one
    ds_read_b32 v120, v94 offset:57008
    ds_read_b32 v121, v94 offset:58672
    ds_read_b32 v122, v94 offset:60336
    ds_read_b32 v123, v94 offset:62000
    ds_read_b32 v124, v95 offset:57008
    ds_read_b32 v125, v95 offset:58672
    ds_read_b32 v126, v95 offset:60336
    ds_read_b32 v127, v95 offset:62000
    s_waitcnt lgkmcnt(4)
    v_mfma_f32_16x16x32_bf16 v[132:135], v[120:123], v[64:67], 0
    v_mfma_f32_16x16x32_bf16 v[136:139], v[120:123], v[68:71], 0
    s_waitcnt lgkmcnt(0)
    v_mfma_f32_16x16x32_bf16 v[140:143], v[124:127], v[64:67], 0
    v_mfma_f32_16x16x32_bf16 v[144:147], v[124:127], v[68:71], 0
    s_cmp_eq_u32 s35, 0
    s_cbranch_scc0 L_B_gm2
    ds_read_u16_d16_hi v96, v92 offset:18688
    ds_read_u16_d16_hi v100, v92 offset:37840
    ds_read_u16_d16_hi v97, v92 offset:20992
    ds_read_u16_d16_hi v101, v92 offset:40144
    ds_read_u16_d16_hi v98, v92 offset:23296
    ds_read_u16_d16_hi v102, v92 offset:42448
    ds_read_u16_d16_hi v99, v92 offset:25600
    ds_read_u16_d16_hi v103, v92 offset:44752
    ds_read_u16_d16_hi v104, v93 offset:18688
    ds_read_u16_d16_hi v108, v93 offset:37840
    ds_read_u16_d16_hi v105, v93 offset:20992
    ds_read_u16_d16_hi v109, v93 offset:40144
    ds_read_u16_d16_hi v106, v93 offset:23296
    ds_read_u16_d16_hi v110, v93 offset:42448
    ds_read_u16_d16_hi v107, v93 offset:25600
    ds_read_u16_d16_hi v111, v93 offset:44752
    s_branch L_B_gme2
L_B_gm2:
    ds_read_u16_d16_hi v96, v14 offset:25600
    ds_read_u16_d16_hi v100, v14 offset:44752
    ds_read_u16_d16_hi v97, v92 offset:23296
    ds_read_u16_d16_hi v101, v92 offset:42448
    ds_read_u16_d16_hi v98, v92 offset:20992
    ds_read_u16_d16_hi v102, v92 offset:40144
    ds_read_u16_d16_hi v99, v92 offset:18688
    ds_read_u16_d16_hi v103, v92 offset:37840
    ds_read_u16_d16_hi v104, v15 offset:25600
    ds_read_u16_d16_hi v108, v15 offset:44752
    ds_read_u16_d16_hi v105, v93 offset:23296
    ds_read_u16_d16_hi v109, v93 offset:42448
    ds_read_u16_d16_hi v106, v93 offset:20992
    ds_read_u16_d16_hi v110, v93 offset:40144
    ds_read_u16_d16_hi v107, v93 offset:18688
    ds_read_u16_d16_hi v111, v93 offset:37840
L_B_gme2:
    v_pk_mul_f32 v[164:165], v[132:133], v[84:85]
    v_pk_mul_f32 v[166:167], v[134:135], v[86:87]
    v_pk_mul_f32 v[132:133], v[132:133], v[80:81]
    v_pk_mul_f32 v[134:135], v[134:135], v[82:83]
    v_pk_fma_f32 v[132:133], v[136:137], v[84:85], v[132:133] neg_lo:[1,0,0] neg_hi:[1,0,0]
    v_pk_fma_f32 v[134:135], v[138:139], v[86:87], v[134:135] neg_lo:[1,0,0] neg_hi:[1,0,0]
    v_pk_fma_f32 v[136:137], v[136:137], v[80:81], v[164:165]
    v_pk_fma_f32 v[138:139], v[138:139], v[82:83], v[166:167]
    v_cvt_pk_bf16_f32 v120, v132, v136
    v_cvt_pk_bf16_f32 v121, v133, v137
    v_cvt_pk_bf16_f32 v122, v134, v138
    v_cvt_pk_bf16_f32 v123, v135, v139
    s_nop 1
    v_mfma_f32_16x16x32_bf16 v[132:135], v[72:75], v[120:123], 0
    v_mfma_f32_16x16x32_bf16 v[136:139], v[76:79], v[120:123], 0
    v_pk_mul_f32 v[164:165], v[140:141], v[84:85]
    v_pk_mul_f32 v[166:167], v[142:143], v[86:87]
    v_pk_mul_f32 v[140:141], v[140:141], v[80:81]
    v_pk_mul_f32 v[142:143], v[142:143], v[82:83]
    v_pk_fma_f32 v[140:141], v[144:145], v[84:85], v[140:141] neg_lo:[1,0,0] neg_hi:[1,0,0]
    v_pk_fma_f32 v[142:143], v[146:147], v[86:87], v[142:143] neg_lo:[1,0,0] neg_hi:[1,0,0]
    v_pk_fma_f32 v[144:145], v[144:145], v[80:81], v[164:165]
    v_pk_fma_f32 v[146:147], v[146:147], v[82:83], v[166:167]
    v_cvt_pk_bf16_f32 v124, v140, v144
    v_cvt_pk_bf16_f32 v125, v141, v145
    v_cvt_pk_bf16_f32 v126, v142, v146
    v_cvt_pk_bf16_f32 v127, v143, v147
    s_nop 1
    v_mfma_f32_16x16x32_bf16 v[140:143], v[72:75], v[124:127], 0
    v_mfma_f32_16x16x32_bf16 v[144:147], v[76:79], v[124:127], 0
    s_waitcnt lgkmcnt(0)
    s_cmp_eq_u32 s35, 0
    s_cbranch_scc0 L_B_wm2
    v_pk_mul_f32 v[164:165], v[132:133], v[100:101]
    v_pk_mul_f32 v[166:167], v[134:135], v[102:103]
    v_pk_mul_f32 v[132:133], v[132:133], v[96:97]
    v_pk_mul_f32 v[134:135], v[134:135], v[98:99]
    v_pk_fma_f32 v[132:133], v[136:137], v[100:101], v[132:133] neg_lo:[1,0,0] neg_hi:[1,0,0]
    v_pk_fma_f32 v[134:135], v[138:139], v[102:103], v[134:135] neg_lo:[1,0,0] neg_hi:[1,0,0]
    v_pk_fma_f32 v[136:137], v[136:137], v[96:97], v[164:165]
    v_pk_fma_f32 v[138:139], v[138:139], v[98:99], v[166:167]
    v_cvt_pk_bf16_f32 v120, v132, -v136
    v_cvt_pk_bf16_f32 v121, v133, -v137
    v_cvt_pk_bf16_f32 v122, v134, -v138
    v_cvt_pk_bf16_f32 v123, v135, -v139
    s_nop 1
    v_mfma_f32_16x16x32_bf16 v[132:135], v[120:123], v[72:75], 0
    v_mfma_f32_16x16x32_bf16 v[136:139], v[120:123], v[76:79], 0
    v_pk_mul_f32 v[164:165], v[140:141], v[108:109]
    v_pk_mul_f32 v[166:167], v[142:143], v[110:111]
    v_pk_mul_f32 v[140:141], v[140:141], v[104:105]
    v_pk_mul_f32 v[142:143], v[142:143], v[106:107]
    v_pk_fma_f32 v[140:141], v[144:145], v[108:109], v[140:141] neg_lo:[1,0,0] neg_hi:[1,0,0]
    v_pk_fma_f32 v[142:143], v[146:147], v[110:111], v[142:143] neg_lo:[1,0,0] neg_hi:[1,0,0]
    v_pk_fma_f32 v[144:145], v[144:145], v[104:105], v[164:165]
    v_pk_fma_f32 v[146:147], v[146:147], v[106:107], v[166:167]
    v_cvt_pk_bf16_f32 v124, v140, -v144
    v_cvt_pk_bf16_f32 v125, v141, -v145
    v_cvt_pk_bf16_f32 v126, v142, -v146
    v_cvt_pk_bf16_f32 v127, v143, -v147
    s_nop 1
    v_mfma_f32_16x16x32_bf16 v[140:143], v[124:127], v[72:75], 0
    v_mfma_f32_16x16x32_bf16 v[144:147], v[124:127], v[76:79], 0
    s_branch L_B_wme2
L_B_wm2:
    v_pk_mul_f32 v[164:165], v[132:133], v[100:101]
    v_pk_mul_f32 v[166:167], v[134:135], v[102:103]
    v_pk_mul_f32 v[132:133], v[132:133], v[96:97]
    v_pk_mul_f32 v[134:135], v[134:135], v[98:99]
    v_pk_fma_f32 v[132:133], v[136:137], v[100:101], v[132:133]
    v_pk_fma_f32 v[134:135], v[138:139], v[102:103], v[134:135]
    v_pk_fma_f32 v[136:137], v[136:137], v[96:97], v[164:165] neg_lo:[0,0,1] neg_hi:[0,0,1]
    v_pk_fma_f32 v[138:139], v[138:139], v[98:99], v[166:167] neg_lo:[0,0,1] neg_hi:[0,0,1]
    v_cvt_pk_bf16_f32 v120, v132, -v136
    v_cvt_pk_bf16_f32 v121, v133, -v137
    v_cvt_pk_bf16_f32 v122, v134, -v138
    v_cvt_pk_bf16_f32 v123, v135, -v139
    s_nop 1
    v_mfma_f32_16x16x32_bf16 v[132:135], v[120:123], v[72:75], 0
    v_mfma_f32_16x16x32_bf16 v[136:139], v[120:123], v[76:79], 0
    v_pk_mul_f32 v[164:165], v[140:141], v[108:109]
    v_pk_mul_f32 v[166:167], v[142:143], v[110:111]
    v_pk_mul_f32 v[140:141], v[140:141], v[104:105]
    v_pk_mul_f32 v[142:143], v[142:143], v[106:107]
    v_pk_fma_f32 v[140:141], v[144:145], v[108:109], v[140:141]
    v_pk_fma_f32 v[142:143], v[146:147], v[110:111], v[142:143]
    v_pk_fma_f32 v[144:145], v[144:145], v[104:105], v[164:165] neg_lo:[0,0,1] neg_hi:[0,0,1]
    v_pk_fma_f32 v[146:147], v[146:147], v[106:107], v[166:167] neg_lo:[0,0,1] neg_hi:[0,0,1]
    v_cvt_pk_bf16_f32 v124, v140, -v144
    v_cvt_pk_bf16_f32 v125, v141, -v145
    v_cvt_pk_bf16_f32 v126, v142, -v146
    v_cvt_pk_bf16_f32 v127, v143, -v147
    s_nop 1
    v_mfma_f32_16x16x32_bf16 v[140:143], v[124:127], v[72:75], 0
    v_mfma_f32_16x16x32_bf16 v[144:147], v[124:127], v[76:79], 0
L_B_wme2:
    v_pk_mul_f32 v[164:165], v[132:133], v[116:117]
    v_pk_mul_f32 v[166:167], v[134:135], v[118:119]
    v_pk_mul_f32 v[132:133], v[132:133], v[112:113]
    v_pk_mul_f32 v[134:135], v[134:135], v[114:115]
    v_pk_fma_f32 v[132:133], v[136:137], v[116:117], v[132:133] neg_lo:[1,0,0] neg_hi:[1,0,0]
    v_pk_fma_f32 v[134:135], v[138:139], v[118:119], v[134:135] neg_lo:[1,0,0] neg_hi:[1,0,0]
    v_pk_fma_f32 v[136:137], v[136:137], v[112:113], v[164:165]
    v_pk_fma_f32 v[138:139], v[138:139], v[114:115], v[166:167]
    v_cvt_pk_bf16_f32 v120, v132, v136
    v_cvt_pk_bf16_f32 v121, v133, v137
    v_cvt_pk_bf16_f32 v122, v134, v138
    v_cvt_pk_bf16_f32 v123, v135, v139
    s_nop 1
    v_mfma_f32_16x16x32_bf16 v[132:135], v[148:151], v[120:123], 0
    v_mfma_f32_16x16x32_bf16 v[136:139], v[152:155], v[120:123], 0
    v_pk_mul_f32 v[164:165], v[140:141], v[116:117]
    v_pk_mul_f32 v[166:167], v[142:143], v[118:119]
    v_pk_mul_f32 v[140:141], v[140:141], v[112:113]
    v_pk_mul_f32 v[142:143], v[142:143], v[114:115]
    v_pk_fma_f32 v[140:141], v[144:145], v[116:117], v[140:141] neg_lo:[1,0,0] neg_hi:[1,0,0]
    v_pk_fma_f32 v[142:143], v[146:147], v[118:119], v[142:143] neg_lo:[1,0,0] neg_hi:[1,0,0]
    v_pk_fma_f32 v[144:145], v[144:145], v[112:113], v[164:165]
    v_pk_fma_f32 v[146:147], v[146:147], v[114:115], v[166:167]
    v_cvt_pk_bf16_f32 v124, v140, v144
    v_cvt_pk_bf16_f32 v125, v141, v145
    v_cvt_pk_bf16_f32 v126, v142, v146
    v_cvt_pk_bf16_f32 v127, v143, v147
    s_nop 1
    v_mfma_f32_16x16x32_bf16 v[140:143], v[148:151], v[124:127], 0
    v_mfma_f32_16x16x32_bf16 v[144:147], v[152:155], v[124:127], 0
    v_cvt_pk_bf16_f32 v120, v132, v136
    v_cvt_pk_bf16_f32 v121, v133, v137
    v_cvt_pk_bf16_f32 v122, v134, v138
    v_cvt_pk_bf16_f32 v123, v135, v139
    ds_write_b32 v94, v120 offset:57008
    ds_write_b32 v94, v121 offset:58672
    ds_write_b32 v94, v122 offset:60336
    ds_write_b32 v94, v123 offset:62000
    v_cvt_pk_bf16_f32 v124, v140, v144
    v_cvt_pk_bf16_f32 v125, v141, v145
    v_cvt_pk_bf16_f32 v126, v142, v146
    v_cvt_pk_bf16_f32 v127, v143, v147
    ds_write_b32 v95, v124 offset:57008
    ds_write_b32 v95, v125 offset:58672
    ds_write_b32 v95, v126 offset:60336
    ds_write_b32 v95, v127 offset:62000
    s_waitcnt lgkmcnt(0)
    s_branch L_B_p2e
L_B_p2one:
    s_cmp_eq_u32 s34, 0
    s_cbranch_scc1 L_B_wh
    v_lshrrev_b32 v5, 1, v3
    v_lshlrev_b32 v5, 6, v5
    v_add_u32 v5, v5, v2
    v_lshlrev_b32 v5, 4, v5
    v_add_u32 v5, s38, v5
    v_sub_u32 v6, 0x800, v5
    s_cmp_eq_u32 s35, 0
    s_cselect_b64 vcc, -1, 0
    s_mov_b32 s3, 147968
    s_cselect_b32 s3, -147968, s3
    s_cselect_b32 s4, 0, 576
    v_cndmask_b32 v5, v5, v6, vcc
    v_mul_u32_u24 v26, 578, v5
    v_add_u32 v26, s4, v26
    v_add_u32 v27, s3, v26
    v_add_u32 v28, s3, v27
    v_add_u32 v29, s3, v28
    s_mov_b32 exec_lo, 0xffff
    s_mov_b32 exec_hi, 0xffff
    global_load_short_d16_hi v16, v26, s[100:101]
    global_load_short_d16_hi v20, v26, s[16:17]
    global_load_short_d16_hi v17, v27, s[100:101]
    global_load_short_d16_hi v21, v27, s[16:17]
    global_load_short_d16_hi v18, v28, s[100:101]
    global_load_short_d16_hi v22, v28, s[16:17]
    global_load_short_d16_hi v19, v29, s[100:101]
    global_load_short_d16_hi v23, v29, s[16:17]
    s_mov_b64 exec, -1
L_B_wh:
    ds_read_b32 v120, v94 offset:57008
    ds_read_b32 v121, v94 offset:58672
    ds_read_b32 v122, v94 offset:60336
    ds_read_b32 v123, v94 offset:62000
    s_waitcnt lgkmcnt(0)
    v_mfma_f32_16x16x32_bf16 v[132:135], v[120:123], v[64:67], 0
    v_mfma_f32_16x16x32_bf16 v[136:139], v[120:123], v[68:71], 0
    s_cmp_eq_u32 s35, 0
    s_cbranch_scc0 L_B_gm1
    ds_read_u16_d16_hi v96, v92 offset:18688
    ds_read_u16_d16_hi v100, v92 offset:37840
    ds_read_u16_d16_hi v97, v92 offset:20992
    ds_read_u16_d16_hi v101, v92 offset:40144
    ds_read_u16_d16_hi v98, v92 offset:23296
    ds_read_u16_d16_hi v102, v92 offset:42448
    ds_read_u16_d16_hi v99, v92 offset:25600
    ds_read_u16_d16_hi v103, v92 offset:44752
    s_branch L_B_gme1
L_B_gm1:
    ds_read_u16_d16_hi v96, v14 offset:25600
    ds_read_u16_d16_hi v100, v14 offset:44752
    ds_read_u16_d16_hi v97, v92 offset:23296
    ds_read_u16_d16_hi v101, v92 offset:42448
    ds_read_u16_d16_hi v98, v92 offset:20992
    ds_read_u16_d16_hi v102, v92 offset:40144
    ds_read_u16_d16_hi v99, v92 offset:18688
    ds_read_u16_d16_hi v103, v92 offset:37840
L_B_gme1:
    v_pk_mul_f32 v[164:165], v[132:133], v[84:85]
    v_pk_mul_f32 v[166:167], v[134:135], v[86:87]
    v_pk_mul_f32 v[132:133], v[132:133], v[80:81]
    v_pk_mul_f32 v[134:135], v[134:135], v[82:83]
    v_pk_fma_f32 v[132:133], v[136:137], v[84:85], v[132:133] neg_lo:[1,0,0] neg_hi:[1,0,0]
    v_pk_fma_f32 v[134:135], v[138:139], v[86:87], v[134:135] neg_lo:[1,0,0] neg_hi:[1,0,0]
    v_pk_fma_f32 v[136:137], v[136:137], v[80:81], v[164:165]
    v_pk_fma_f32 v[138:139], v[138:139], v[82:83], v[166:167]
    v_cvt_pk_bf16_f32 v120, v132, v136
    v_cvt_pk_bf16_f32 v121, v133, v137
    v_cvt_pk_bf16_f32 v122, v134, v138
    v_cvt_pk_bf16_f32 v123, v135, v139
    s_nop 1
    v_mfma_f32_16x16x32_bf16 v[132:135], v[72:75], v[120:123], 0
    v_mfma_f32_16x16x32_bf16 v[136:139], v[76:79], v[120:123], 0
    s_waitcnt lgkmcnt(0)
    s_cmp_eq_u32 s34, 0
    s_cbranch_scc1 L_B_wx1
    s_waitcnt vmcnt(0) lgkmcnt(0)
    s_mov_b32 exec_lo, 0xffff
    s_mov_b32 exec_hi, 0xffff
    v_add_f32 v96, v96, v16
    v_sub_f32 v100, v100, v20
    v_mul_f32 v96, 0.5, v96
    v_mul_f32 v100, 0.5, v100
    v_add_f32 v97, v97, v17
    v_sub_f32 v101, v101, v21
    v_mul_f32 v97, 0.5, v97
    v_mul_f32 v101, 0.5, v101
    v_add_f32 v98, v98, v18
    v_sub_f32 v102, v102, v22
    v_mul_f32 v98, 0.5, v98
    v_mul_f32 v102, 0.5, v102
    v_add_f32 v99, v99, v19
    v_sub_f32 v103, v103, v23
    v_mul_f32 v99, 0.5, v99
    v_mul_f32 v103, 0.5, v103
    s_mov_b64 exec, -1
L_B_wx1:
    s_cmp_eq_u32 s35, 0
    s_cbranch_scc0 L_B_wm1
    s_nop 1
    v_pk_mul_f32 v[164:165], v[132:133], v[100:101]
    v_pk_mul_f32 v[166:167], v[134:135], v[102:103]
    v_pk_mul_f32 v[132:133], v[132:133], v[96:97]
    v_pk_mul_f32 v[134:135], v[134:135], v[98:99]
    v_pk_fma_f32 v[132:133], v[136:137], v[100:101], v[132:133] neg_lo:[1,0,0] neg_hi:[1,0,0]
    v_pk_fma_f32 v[134:135], v[138:139], v[102:103], v[134:135] neg_lo:[1,0,0] neg_hi:[1,0,0]
    v_pk_fma_f32 v[136:137], v[136:137], v[96:97], v[164:165]
    v_pk_fma_f32 v[138:139], v[138:139], v[98:99], v[166:167]
    v_cvt_pk_bf16_f32 v120, v132, -v136
    v_cvt_pk_bf16_f32 v121, v133, -v137
    v_cvt_pk_bf16_f32 v122, v134, -v138
    v_cvt_pk_bf16_f32 v123, v135, -v139
    s_nop 1
    v_mfma_f32_16x16x32_bf16 v[132:135], v[120:123], v[72:75], 0
    v_mfma_f32_16x16x32_bf16 v[136:139], v[120:123], v[76:79], 0
    s_branch L_B_wme1
L_B_wm1:
    s_nop 1
    v_pk_mul_f32 v[164:165], v[132:133], v[100:101]
    v_pk_mul_f32 v[166:167], v[134:135], v[102:103]
    v_pk_mul_f32 v[132:133], v[132:133], v[96:97]
    v_pk_mul_f32 v[134:135], v[134:135], v[98:99]
    v_pk_fma_f32 v[132:133], v[136:137], v[100:101], v[132:133]
    v_pk_fma_f32 v[134:135], v[138:139], v[102:103], v[134:135]
    v_pk_fma_f32 v[136:137], v[136:137], v[96:97], v[164:165] neg_lo:[0,0,1] neg_hi:[0,0,1]
    v_pk_fma_f32 v[138:139], v[138:139], v[98:99], v[166:167] neg_lo:[0,0,1] neg_hi:[0,0,1]
    v_cvt_pk_bf16_f32 v120, v132, -v136
    v_cvt_pk_bf16_f32 v121, v133, -v137
    v_cvt_pk_bf16_f32 v122, v134, -v138
    v_cvt_pk_bf16_f32 v123, v135, -v139
    s_nop 1
    v_mfma_f32_16x16x32_bf16 v[132:135], v[120:123], v[72:75], 0
    v_mfma_f32_16x16x32_bf16 v[136:139], v[120:123], v[76:79], 0
L_B_wme1:
    s_nop 6
    v_pk_mul_f32 v[164:165], v[132:133], v[116:117]
    v_pk_mul_f32 v[166:167], v[134:135], v[118:119]
    v_pk_mul_f32 v[132:133], v[132:133], v[112:113]
    v_pk_mul_f32 v[134:135], v[134:135], v[114:115]
    v_pk_fma_f32 v[132:133], v[136:137], v[116:117], v[132:133] neg_lo:[1,0,0] neg_hi:[1,0,0]
    v_pk_fma_f32 v[134:135], v[138:139], v[118:119], v[134:135] neg_lo:[1,0,0] neg_hi:[1,0,0]
    v_pk_fma_f32 v[136:137], v[136:137], v[112:113], v[164:165]
    v_pk_fma_f32 v[138:139], v[138:139], v[114:115], v[166:167]
    v_cvt_pk_bf16_f32 v120, v132, v136
    v_cvt_pk_bf16_f32 v121, v133, v137
    v_cvt_pk_bf16_f32 v122, v134, v138
    v_cvt_pk_bf16_f32 v123, v135, v139
    s_nop 1
    v_mfma_f32_16x16x32_bf16 v[132:135], v[148:151], v[120:123], 0
    v_mfma_f32_16x16x32_bf16 v[136:139], v[152:155], v[120:123], 0
    s_nop 7
    v_cvt_pk_bf16_f32 v120, v132, v136
    v_cvt_pk_bf16_f32 v121, v133, v137
    v_cvt_pk_bf16_f32 v122, v134, v138
    v_cvt_pk_bf16_f32 v123, v135, v139
    ds_write_b32 v94, v120 offset:57008
    ds_write_b32 v94, v121 offset:58672
    ds_write_b32 v94, v122 offset:60336
    ds_write_b32 v94, v123 offset:62000
    s_waitcnt lgkmcnt(0)
L_B_p2e:
L_B_p2skip:
    s_add_u32 s28, s28, 1
    s_and_b32 s28, s28, 0xbfffbfff
    s_barrier
    s_cmp_ge_u32 s31, 8
    s_cbranch_scc1 L_B_st3
    ds_read_b128 v[120:123], v89 offset:0
    ds_read_b128 v[124:127], v89 offset:6656
    ds_read_b128 v[128:131], v89 offset:13312
    ds_read_b128 v[160:163], v89 offset:19968
    s_waitcnt lgkmcnt(3)
    v_mov_b32 v123, s28
    buffer_store_dwordx4 v[120:123], v88, s[24:27], s57 offen sc1
    s_waitcnt lgkmcnt(2)
    v_mov_b32 v127, s28
    buffer_store_dwordx4 v[124:127], v88, s[24:27], s58 offen sc1
    s_waitcnt lgkmcnt(1)
    v_mov_b32 v131, s28
    buffer_store_dwordx4 v[128:131], v88, s[24:27], s59 offen sc1
    s_waitcnt lgkmcnt(0)
    v_mov_b32 v163, s28
    buffer_store_dwordx4 v[160:163], v88, s[24:27], s61 offen sc1
    s_or_b32 s3, s30, s31
    s_cmp_eq_u32 s3, 0
    s_cbranch_scc0 L_B_st3
    buffer_store_dword v123, off, s[24:27], 0
L_B_st3:
    s_cmp_ge_u32 s31, 9
    s_cbranch_scc1 L_end
    s_cmp_eq_u32 s31, 0
    s_cbranch_scc0 L_B_h2
    v_and_b32 v4, 31, v1
    v_lshlrev_b32 v4, 4, v4
    v_add_u32 v4, 83632, v4
    ds_read_b64 v[136:137], v4 offset:1032
    ds_read_b128 v[138:141], v4 offset:2048
    ds_read_b128 v[142:145], v4 offset:3072
    ds_read_b64 v[146:147], v4 offset:4096
    ds_read_b64 v[34:35], v4 offset:4104
    ds_read_b128 v[36:39], v4 offset:5120
    ds_read_b128 v[40:43], v4 offset:6144
    ds_read_b128 v[44:47], v4 offset:7168
    ds_read_b128 v[48:51], v4 offset:8192
    ds_read_b128 v[52:55], v4 offset:9216
    ds_read_b64 v[56:57], v4 offset:10240
    ds_read_b32 v12, v4 offset:4616
    ds_read_b32 v13, v4 offset:7688
L_B_h2:
    v_lshlrev_b32 v6, 7, v2
    v_add_u32 v6, s30, v6
    v_cvt_f32_u32 v6, v6
    v_mul_f32 v6, 0x3a000000, v6
    v_lshlrev_b32 v7, 1, v3
    v_cvt_f32_u32 v7, v7
    v_mul_f32 v7, v6, v7
    v_add_f32 v6, v6, v7
    v_cvt_f32_u32 v4, v2
    v_mul_f32 v4, 0.5, v4
    v_cos_f32 v8, v7
    v_sin_f32 v9, v7
    v_cos_f32 v4, v4
    v_cos_f32 v10, v6
    v_sin_f32 v11, v6
    v_cmp_eq_u32 vcc, 0, v3
    s_nop 1
    v_cndmask_b32 v9, v9, v4, vcc
    v_cvt_pk_bf16_f32 v62, v8, v9
    v_cvt_pk_bf16_f32 v63, v10, v11
    v_lshrrev_b32 v14, 2, v1
    v_mul_u32_u24 v14, 1168, v14
    v_and_b32 v5, 3, v1
    v_lshl_add_u32 v14, v5, 4, v14
    s_lshl_b32 s3, s31, 7
    v_add_u32 v14, s3, v14
    v_mul_u32_u24 v15, 294912, v2
    v_lshl_add_u32 v15, v3, 4, v15
    s_mul_i32 s60, s30, 2304
    s_add_u32 s60, s60, s3
    s_cmp_eq_u32 s31, 8
    s_cbranch_scc1 L_B_b5
    v_perm_b32 v64, v28, v22, s52
    v_perm_b32 v80, v22, v16, s52
    v_perm_b32 v65, v28, v22, s53
    v_perm_b32 v81, v22, v16, s53
    v_perm_b32 v66, v29, v23, s52
    v_perm_b32 v82, v23, v17, s52
    v_perm_b32 v68, v29, v23, s53
    v_perm_b32 v84, v23, v17, s53
    v_perm_b32 v69, v30, v24, s52
    v_perm_b32 v85, v24, v18, s52
    v_perm_b32 v70, v30, v24, s53
    v_perm_b32 v86, v24, v18, s53
    v_perm_b32 v72, v31, v25, s52
    v_perm_b32 v88, v25, v19, s52
    v_perm_b32 v73, v31, v25, s53
    v_perm_b32 v89, v25, v19, s53
    v_perm_b32 v74, v32, v26, s52
    v_perm_b32 v90, v26, v20, s52
    v_perm_b32 v76, v32, v26, s53
    v_perm_b32 v92, v26, v20, s53
    v_perm_b32 v77, v33, v27, s52
    v_perm_b32 v93, v27, v21, s52
    v_perm_b32 v78, v33, v27, s53
    v_perm_b32 v94, v27, v21, s53
    v_mov_b32 v67, 0
    v_mov_b32 v83, 0
    v_mov_b32 v71, 0
    v_mov_b32 v87, 0
    v_mov_b32 v75, 0
    v_mov_b32 v91, 0
    v_mov_b32 v79, 0
    v_mov_b32 v95, 0
    v_lshrrev_b32 v7, 5, v1
    v_bfe_u32 v5, v1, 2, 1
    v_lshl_add_u32 v4, v7, 1, v5
    s_cmp_eq_u32 s31, 0
    s_cselect_b32 s3, 13, 12
    v_bfe_u32 v5, v1, 3, 2
    v_and_b32 v6, 3, v1
    v_lshl_add_u32 v5, v5, 2, v6
    s_cselect_b32 s4, 16, 12
    v_mad_u32_u24 v4, v4, s4, v5
    v_lshlrev_b32 v4, 4, v4
    v_cmp_gt_u32 s[56:57], s3, v5
    v_mov_b32 v6, 1073741824
    s_nop 0
    v_cndmask_b32 v4, v6, v4, s[56:57]
    v_mul_u32_u24 v5, 48, v58
    v_mad_u32_u24 v5, v7, 24, v5
    s_mul_i32 s3, s31, 2336
    v_add_u32 v5, s3, v5
    s_cmp_eq_u32 s31, 0
    s_cbranch_scc1 L_B_sp3
    v_mov_b32 v96, v64
    v_mov_b32 v108, v80
    v_mov_b32 v97, v65
    v_mov_b32 v109, v81
    v_mov_b32 v98, v66
    v_mov_b32 v110, v82
    v_mov_b32 v99, v68
    v_mov_b32 v111, v84
    v_mov_b32 v100, v69
    v_mov_b32 v112, v85
    v_mov_b32 v101, v70
    v_mov_b32 v113, v86
    v_mov_b32 v102, v72
    v_mov_b32 v114, v88
    v_mov_b32 v103, v73
    v_mov_b32 v115, v89
    v_mov_b32 v104, v74
    v_mov_b32 v116, v90
    v_mov_b32 v105, v76
    v_mov_b32 v117, v92
    v_mov_b32 v106, v77
    v_mov_b32 v118, v93
    v_mov_b32 v107, v78
    v_mov_b32 v119, v94
    s_branch L_B_sp3e
L_B_sp3:
    v_sub_u32 v7, 0, v7
    v_lshlrev_b32 v8, 31, v58
    v_or_b32 v8, 0x3f803f80, v8
    s_waitcnt lgkmcnt(0)
    v_mul_f32 v34, 0.5, v34
    v_mul_f32 v46, 0.5, v46
    v_mul_f32 v12, 0.5, v12
    v_mul_f32 v13, 0.5, v13
    v_bfi_b32 v96, v7, 0, v8
    v_and_b32 v108, v7, v8
    v_perm_b32 v8, v142, v136, s53
    v_bfi_b32 v97, v7, 0, v8
    v_and_b32 v109, v7, v8
    v_perm_b32 v8, v143, v137, s52
    v_bfi_b32 v98, v7, 0, v8
    v_and_b32 v110, v7, v8
    v_perm_b32 v8, v143, v137, s53
    v_bfi_b32 v99, v7, 0, v8
    v_and_b32 v111, v7, v8
    v_perm_b32 v8, v144, v138, s52
    v_bfi_b32 v100, v7, 0, v8
    v_and_b32 v112, v7, v8
    v_perm_b32 v8, v144, v138, s53
    v_bfi_b32 v101, v7, 0, v8
    v_and_b32 v113, v7, v8
    v_perm_b32 v8, v145, v139, s52
    v_bfi_b32 v102, v7, 0, v8
    v_and_b32 v114, v7, v8
    v_perm_b32 v8, v145, v139, s53
    v_bfi_b32 v103, v7, 0, v8
    v_and_b32 v115, v7, v8
    v_perm_b32 v8, v146, v140, s52
    v_bfi_b32 v104, v7, 0, v8
    v_and_b32 v116, v7, v8
    v_perm_b32 v8, v146, v140, s53
    v_bfi_b32 v105, v7, 0, v8
    v_and_b32 v117, v7, v8
    v_perm_b32 v8, v147, v141, s52
    v_bfi_b32 v106, v7, 0, v8
    v_and_b32 v118, v7, v8
    v_perm_b32 v8, v147, v141, s53
    v_bfi_b32 v107, v7, 0, v8
    v_and_b32 v119, v7, v8
L_B_sp3e:
    buffer_load_dwordx4 v[120:123], v4, s[24:27], s44 offen sc1
    buffer_load_dwordx4 v[124:127], v4, s[24:27], s45 offen sc1
    buffer_load_dwordx4 v[128:131], v4, s[24:27], s46 offen sc1
    buffer_load_dwordx4 v[132:135], v4, s[24:27], s47 offen sc1
    s_mov_b32 s3, 1048576
L_B_poll2:
    s_waitcnt vmcnt(0)
    v_cmp_ne_u32 vcc, s28, v123
    v_cmp_ne_u32 s[4:5], s28, v127
    v_cmp_ne_u32 s[6:7], s28, v131
    v_cmp_ne_u32 s[8:9], s28, v135
    s_or_b64 s[10:11], vcc, s[4:5]
    s_or_b64 s[12:13], s[6:7], s[8:9]
    s_or_b64 s[10:11], s[10:11], s[12:13]
    s_and_b64 s[10:11], s[10:11], s[56:57]
    s_cbranch_scc0 L_B_poll2x
    s_sub_u32 s3, s3, 1
    s_cbranch_scc1 L_B_poll2x
    s_sleep 1
    s_and_b64 exec, vcc, s[56:57]
    s_cbranch_scc0 L_B_poll2_0
    buffer_load_dwordx4 v[120:123], v4, s[24:27], s44 offen sc1
L_B_poll2_0:
    s_and_b64 exec, s[4:5], s[56:57]
    s_cbranch_scc0 L_B_poll2_1
    buffer_load_dwordx4 v[124:127], v4, s[24:27], s45 offen sc1
L_B_poll2_1:
    s_and_b64 exec, s[6:7], s[56:57]
    s_cbranch_scc0 L_B_poll2_2
    buffer_load_dwordx4 v[128:131], v4, s[24:27], s46 offen sc1
L_B_poll2_2:
    s_and_b64 exec, s[8:9], s[56:57]
    s_cbranch_scc0 L_B_poll2_3
    buffer_load_dwordx4 v[132:135], v4, s[24:27], s47 offen sc1
L_B_poll2_3:
    s_mov_b64 exec, -1
    s_branch L_B_poll2
L_B_poll2x:
    v_mfma_f32_32x32x16_bf16 v[136:151], v[120:123], v[64:67], 0
    v_mfma_f32_32x32x16_bf16 v[152:167], v[120:123], v[80:83], 0
    v_mfma_f32_32x32x16_bf16 v[136:151], v[124:127], v[68:71], v[136:151]
    v_mfma_f32_32x32x16_bf16 v[152:167], v[124:127], v[84:87], v[152:167]
    v_mfma_f32_32x32x16_bf16 v[136:151], v[128:131], v[72:75], v[136:151]
    v_mfma_f32_32x32x16_bf16 v[152:167], v[128:131], v[88:91], v[152:167]
    v_mfma_f32_32x32x16_bf16 v[136:151], v[132:135], v[76:79], v[136:151]
    v_mfma_f32_32x32x16_bf16 v[152:167], v[132:135], v[92:95], v[152:167]
    s_nop 10
    v_pk_mul_f32 v[8:9], v[136:137], v[46:47]
    v_pk_mul_f32 v[10:11], v[138:139], v[48:49]
    v_pk_mul_f32 v[136:137], v[136:137], v[34:35]
    v_pk_mul_f32 v[138:139], v[138:139], v[36:37]
    v_pk_fma_f32 v[136:137], v[152:153], v[46:47], v[136:137] neg_lo:[1,0,0] neg_hi:[1,0,0]
    v_pk_fma_f32 v[138:139], v[154:155], v[48:49], v[138:139] neg_lo:[1,0,0] neg_hi:[1,0,0]
    v_pk_fma_f32 v[152:153], v[152:153], v[34:35], v[8:9]
    v_pk_fma_f32 v[154:155], v[154:155], v[36:37], v[10:11]
    v_pk_mul_f32 v[8:9], v[140:141], v[50:51]
    v_pk_mul_f32 v[10:11], v[142:143], v[52:53]
    v_pk_mul_f32 v[140:141], v[140:141], v[38:39]
    v_pk_mul_f32 v[142:143], v[142:143], v[40:41]
    v_pk_fma_f32 v[140:141], v[156:157], v[50:51], v[140:141] neg_lo:[1,0,0] neg_hi:[1,0,0]
    v_pk_fma_f32 v[142:143], v[158:159], v[52:53], v[142:143] neg_lo:[1,0,0] neg_hi:[1,0,0]
    v_pk_fma_f32 v[156:157], v[156:157], v[38:39], v[8:9]
    v_pk_fma_f32 v[158:159], v[158:159], v[40:41], v[10:11]
    v_pk_mul_f32 v[8:9], v[144:145], v[54:55]
    v_pk_mul_f32 v[10:11], v[146:147], v[56:57]
    v_pk_mul_f32 v[144:145], v[144:145], v[42:43]
    v_pk_mul_f32 v[146:147], v[146:147], v[44:45]
    v_pk_fma_f32 v[144:145], v[160:161], v[54:55], v[144:145] neg_lo:[1,0,0] neg_hi:[1,0,0]
    v_pk_fma_f32 v[146:147], v[162:163], v[56:57], v[146:147] neg_lo:[1,0,0] neg_hi:[1,0,0]
    v_pk_fma_f32 v[160:161], v[160:161], v[42:43], v[8:9]
    v_pk_fma_f32 v[162:163], v[162:163], v[44:45], v[10:11]
    s_cmp_eq_u32 s31, 0
    s_cbranch_scc0 L_B_sp4
    v_mul_f32 v152, v148, v12
    v_fma_f32 v152, -v164, v13, v152
L_B_sp4:
    v_cvt_pk_bf16_f32 v120, v136, v152
    v_cvt_pk_bf16_f32 v121, v137, v153
    v_cvt_pk_bf16_f32 v122, v138, v154
    v_cvt_pk_bf16_f32 v123, v139, v155
    v_cvt_pk_bf16_f32 v124, v140, v156
    v_cvt_pk_bf16_f32 v125, v141, v157
    v_cvt_pk_bf16_f32 v126, v142, v158
    v_cvt_pk_bf16_f32 v127, v143, v159
    v_cvt_pk_bf16_f32 v128, v144, v160
    v_cvt_pk_bf16_f32 v129, v145, v161
    v_cvt_pk_bf16_f32 v130, v146, v162
    v_cvt_pk_bf16_f32 v131, v147, v163
    v_mfma_f32_32x32x16_bf16 v[136:151], v[120:123], v[96:99], 0
    v_mfma_f32_32x32x16_bf16 v[136:151], v[124:127], v[100:103], v[136:151]
    v_mfma_f32_32x32x16_bf16 v[136:151], v[128:131], v[104:107], v[136:151]
    v_mfma_f32_32x32x16_bf16 v[152:167], v[120:123], v[108:111], 0
    v_mfma_f32_32x32x16_bf16 v[152:167], v[124:127], v[112:115], v[152:167]
    v_mfma_f32_32x32x16_bf16 v[152:167], v[128:131], v[116:119], v[152:167]
    s_mov_b32 exec_lo, 0xffffff
    s_mov_b32 exec_hi, 0xffffff
    s_nop 6
    v_cvt_pk_bf16_f32 v64, v136, v137
    v_cvt_pk_bf16_f32 v65, v138, v139
    ds_write_b64 v5, v[64:65] offset:0
    v_cvt_pk_bf16_f32 v66, v140, v141
    v_cvt_pk_bf16_f32 v67, v142, v143
    ds_write_b64 v5, v[66:67] offset:8
    v_cvt_pk_bf16_f32 v68, v144, v145
    v_cvt_pk_bf16_f32 v69, v146, v147
    ds_write_b64 v5, v[68:69] offset:16
    v_cvt_pk_bf16_f32 v70, v152, v153
    v_cvt_pk_bf16_f32 v71, v154, v155
    ds_write_b64 v5, v[70:71] offset:1168
    v_cvt_pk_bf16_f32 v72, v156, v157
    v_cvt_pk_bf16_f32 v73, v158, v159
    ds_write_b64 v5, v[72:73] offset:1176
    v_cvt_pk_bf16_f32 v74, v160, v161
    v_cvt_pk_bf16_f32 v75, v162, v163
    ds_write_b64 v5, v[74:75] offset:1184
    s_mov_b64 exec, -1
    s_waitcnt lgkmcnt(0)
L_B_b5:
    s_barrier
    ds_read_b64_tr_b16 v[120:121], v14 offset:0
    ds_read_b64_tr_b16 v[122:123], v14 offset:8
    ds_read_b64_tr_b16 v[124:125], v14 offset:64
    ds_read_b64_tr_b16 v[126:127], v14 offset:72
    s_waitcnt lgkmcnt(3)
    v_mfma_f32_16x16x16_bf16 v[136:139], v[120:121], v[62:63], 0
    s_waitcnt lgkmcnt(2)
    v_mfma_f32_16x16x16_bf16 v[140:143], v[122:123], v[62:63], 0
    s_waitcnt lgkmcnt(1)
    v_mfma_f32_16x16x16_bf16 v[144:147], v[124:125], v[62:63], 0
    s_waitcnt lgkmcnt(0)
    v_mfma_f32_16x16x16_bf16 v[148:151], v[126:127], v[62:63], 0
    s_nop 1
    v_cvt_pk_bf16_f32 v152, v136, v137
    v_cvt_pk_bf16_f32 v153, v138, v139
    v_cvt_pk_bf16_f32 v154, v140, v141
    v_cvt_pk_bf16_f32 v155, v142, v143
    buffer_store_dwordx4 v[152:155], v15, s[20:23], s60 offen offset:1152 sc1
    v_cvt_pk_bf16_f32 v156, v144, v145
    v_cvt_pk_bf16_f32 v157, v146, v147
    v_cvt_pk_bf16_f32 v158, v148, v149
    v_cvt_pk_bf16_f32 v159, v150, v151
    buffer_store_dwordx4 v[156:159], v15, s[20:23], s60 offen offset:1216 sc1
    s_branch L_end
.p2align 7
.type L_tab,@object
L_tab:
.long 0x3f80,0x3f80,0x3f80,0x3f80,0x3f80,0x3ec43f6d,0x3f353f35,0x3f6d3ec4
.long 0x3f80,0x3f353f35,0x3f800000,0x3f35bf35,0x3f80,0x3f6d3ec4,0x3f35bf35,0xbec4bf6d
.long 0x3f80,0x3f800000,0xbf80,0xbf800000,0x3f80,0x3f6dbec4,0xbf35bf35,0xbec43f6d
.long 0x3f80,0x3f35bf35,0xbf800000,0x3f353f35,0x3f80,0x3ec4bf6d,0xbf353f35,0x3f6dbec4
.long 0x3f80,0xbf80,0x3f80,0xbf80,0x3f80,0xbec4bf6d,0x3f353f35,0xbf6dbec4
.long 0x3f80,0xbf35bf35,0x3f800000,0xbf353f35,0x3f80,0xbf6dbec4,0x3f35bf35,0x3ec43f6d
.long 0x3f80,0xbf800000,0xbf80,0x3f800000,0x3f80,0xbf6d3ec4,0xbf35bf35,0x3ec4bf6d
.long 0x3f80,0xbf353f35,0xbf800000,0xbf35bf35,0x3f80,0xbec43f6d,0xbf353f35,0xbf6d3ec4
.long 0x3f80,0x3f80,0x3f80,0x3f80,0x3f800000,0x3f6dbec4,0x3f35bf35,0x3ec4bf6d
.long 0xbf80,0xbf35bf35,0xbf800000,0xbf353f35,0xbf800000,0xbec43f6d,0x3f353f35,0x3f6dbec4
.long 0x3f80,0x3f800000,0xbf80,0xbf800000,0x3f800000,0xbec4bf6d,0xbf353f35,0x3f6d3ec4
.long 0xbf80,0xbf353f35,0x3f800000,0xbf35bf35,0xbf800000,0x3f6d3ec4,0xbf35bf35,0x3ec43f6d
.long 0x3f80,0xbf80,0x3f80,0xbf80,0x3f800000,0xbf6d3ec4,0x3f35bf35,0xbec43f6d
.long 0xbf80,0x3f353f35,0xbf800000,0x3f35bf35,0xbf800000,0x3ec4bf6d,0x3f353f35,0xbf6d3ec4
.long 0x3f80,0xbf800000,0xbf80,0x3f800000,0x3f800000,0x3ec43f6d,0xbf353f35,0xbf6dbec4
.long 0xbf80,0x3f35bf35,0x3f800000,0x3f353f35,0xbf800000,0xbf6dbec4,0xbf35bf35,0xbec4bf6d
.long 0x3f80,0x3f80,0x3f80,0x3f80,0xbf80,0xbec4bf6d,0xbf35bf35,0xbf6dbec4
.long 0x3f80,0x3f353f35,0x3f800000,0x3f35bf35,0xbf80,0xbf6dbec4,0xbf353f35,0x3ec43f6d
.long 0x3f80,0x3f800000,0xbf80,0xbf800000,0xbf80,0xbf6d3ec4,0x3f353f35,0x3ec4bf6d
.long 0x3f80,0x3f35bf35,0xbf800000,0x3f353f35,0xbf80,0xbec43f6d,0x3f35bf35,0xbf6d3ec4
.long 0x3f80,0xbf80,0x3f80,0xbf80,0xbf80,0x3ec43f6d,0xbf35bf35,0x3f6d3ec4
.long 0x3f80,0xbf35bf35,0x3f800000,0xbf353f35,0xbf80,0x3f6d3ec4,0xbf353f35,0xbec4bf6d
.long 0x3f80,0xbf800000,0xbf80,0x3f800000,0xbf80,0x3f6dbec4,0x3f353f35,0xbec43f6d
.long 0x3f80,0xbf353f35,0xbf800000,0xbf35bf35,0xbf80,0x3ec4bf6d,0x3f35bf35,0x3f6dbec4
.long 0x3f80,0x3f80,0x3f80,0x3f80,0xbf800000,0xbf6d3ec4,0xbf353f35,0xbec43f6d
.long 0xbf80,0xbf35bf35,0xbf800000,0xbf353f35,0x3f800000,0x3ec4bf6d,0xbf35bf35,0xbf6d3ec4
.long 0x3f80,0x3f800000,0xbf80,0xbf800000,0xbf800000,0x3ec43f6d,0x3f35bf35,0xbf6dbec4
.long 0xbf80,0xbf353f35,0x3f800000,0xbf35bf35,0x3f800000,0xbf6dbec4,0x3f353f35,0xbec4bf6d
.long 0x3f80,0xbf80,0x3f80,0xbf80,0xbf800000,0x3f6dbec4,0xbf353f35,0x3ec4bf6d
.long 0xbf80,0x3f353f35,0xbf800000,0x3f35bf35,0x3f800000,0xbec43f6d,0xbf35bf35,0x3f6dbec4
.long 0x3f80,0xbf800000,0xbf80,0x3f800000,0xbf800000,0xbec4bf6d,0x3f35bf35,0x3f6d3ec4
.long 0xbf80,0x3f35bf35,0x3f800000,0x3f353f35,0x3f800000,0x3f6d3ec4,0x3f353f35,0x3ec43f6d
.long 0x3f808000,0x3f808000,0x3f808000,0x3f808000,0x3f808000,0x3f6dbec4,0x3f35bf35,0x3ec4bf6d
.long 0x3f808000,0x3f35bf35,0xbf80,0xbf35bf35,0x3f808000,0x3ec4bf6d,0xbf35bf35,0xbf6d3ec4
.long 0x3f808000,0xbf80,0xbf808000,0x3f80,0x3f808000,0xbec4bf6d,0xbf353f35,0x3f6d3ec4
.long 0x3f808000,0xbf35bf35,0x3f80,0x3f35bf35,0x3f808000,0xbf6dbec4,0x3f353f35,0xbec4bf6d
.long 0x3f808000,0xbf808000,0x3f808000,0xbf808000,0x3f808000,0xbf6d3ec4,0x3f35bf35,0xbec43f6d
.long 0x3f808000,0xbf353f35,0xbf80,0x3f353f35,0x3f808000,0xbec43f6d,0xbf35bf35,0x3f6dbec4
.long 0x3f808000,0x3f80,0xbf808000,0xbf80,0x3f808000,0x3ec43f6d,0xbf353f35,0xbf6dbec4
.long 0x3f808000,0x3f353f35,0x3f80,0xbf353f35,0x3f808000,0x3f6d3ec4,0x3f353f35,0x3ec43f6d
.long 0x3f808000,0x3f808000,0x3f808000,0x3f808000,0xbf80,0xbec4bf6d,0xbf35bf35,0xbf6dbec4
.long 0xbf808000,0xbf353f35,0x3f80,0x3f353f35,0x3f80,0x3f6d3ec4,0x3f35bf35,0xbec4bf6d
.long 0x3f808000,0xbf80,0xbf808000,0x3f80,0xbf80,0xbf6d3ec4,0x3f353f35,0x3ec4bf6d
.long 0xbf808000,0x3f353f35,0xbf80,0xbf353f35,0x3f80,0x3ec4bf6d,0xbf353f35,0x3f6dbec4
.long 0x3f808000,0xbf808000,0x3f808000,0xbf808000,0xbf80,0x3ec43f6d,0xbf35bf35,0x3f6d3ec4
.long 0xbf808000,0x3f35bf35,0x3f80,0xbf35bf35,0x3f80,0xbf6dbec4,0x3f35bf35,0x3ec43f6d
.long 0x3f808000,0x3f80,0xbf808000,0xbf80,0xbf80,0x3f6dbec4,0x3f353f35,0xbec43f6d
.long 0xbf808000,0xbf35bf35,0xbf80,0x3f35bf35,0x3f80,0xbec43f6d,0xbf353f35,0xbf6d3ec4
.long 0x3f808000,0x3f808000,0x3f808000,0x3f808000,0xbf808000,0xbf6d3ec4,0xbf353f35,0xbec43f6d
.long 0x3f808000,0x3f35bf35,0xbf80,0xbf35bf35,0xbf808000,0xbec43f6d,0x3f353f35,0x3f6dbec4
.long 0x3f808000,0xbf80,0xbf808000,0x3f80,0xbf808000,0x3ec43f6d,0x3f35bf35,0xbf6dbec4
.long 0x3f808000,0xbf35bf35,0x3f80,0x3f35bf35,0xbf808000,0x3f6d3ec4,0xbf35bf35,0x3ec43f6d
.long 0x3f808000,0xbf808000,0x3f808000,0xbf808000,0xbf808000,0x3f6dbec4,0xbf353f35,0x3ec4bf6d
.long 0x3f808000,0xbf353f35,0xbf80,0x3f353f35,0xbf808000,0x3ec4bf6d,0x3f353f35,0xbf6d3ec4
.long 0x3f808000,0x3f80,0xbf808000,0xbf80,0xbf808000,0xbec4bf6d,0x3f35bf35,0x3f6d3ec4
.long 0x3f808000,0x3f353f35,0x3f80,0xbf353f35,0xbf808000,0xbf6dbec4,0xbf35bf35,0xbec4bf6d
.long 0x3f808000,0x3f808000,0x3f808000,0x3f808000,0x3f80,0x3ec43f6d,0x3f353f35,0x3f6d3ec4
.long 0xbf808000,0xbf353f35,0x3f80,0x3f353f35,0xbf80,0xbf6dbec4,0xbf353f35,0x3ec43f6d
.long 0x3f808000,0xbf80,0xbf808000,0x3f80,0x3f80,0x3f6dbec4,0xbf35bf35,0xbec43f6d
.long 0xbf808000,0x3f353f35,0xbf80,0xbf353f35,0xbf80,0xbec43f6d,0x3f35bf35,0xbf6d3ec4
.long 0x3f808000,0xbf808000,0x3f808000,0xbf808000,0x3f80,0xbec4bf6d,0x3f353f35,0xbf6dbec4
.long 0xbf808000,0x3f35bf35,0x3f80,0xbf35bf35,0xbf80,0x3f6d3ec4,0xbf353f35,0xbec4bf6d
.long 0x3f808000,0x3f80,0xbf808000,0xbf80,0x3f80,0xbf6d3ec4,0xbf35bf35,0x3ec4bf6d
.long 0xbf808000,0xbf35bf35,0xbf80,0x3f35bf35,0xbf80,0x3ec4bf6d,0x3f35bf35,0x3f6dbec4
.long 0x3f80,0x3f80,0x3f80,0x3f80,0x3f80,0x3f353f35,0x3f800000,0x3f35bf35
.long 0x3f80,0x3f800000,0xbf80,0xbf800000,0x3f80,0x3f35bf35,0xbf800000,0x3f353f35
.long 0x0,0x0,0x0,0x0,0x0,0x0,0x0,0x0
.long 0x0,0x0,0x0,0x0,0x0,0x0,0x0,0x0
.long 0x3f80,0xbf80,0x3f80,0xbf80,0x3f80,0xbf35bf35,0x3f800000,0xbf353f35
.long 0x3f80,0xbf800000,0xbf80,0x3f800000,0x3f80,0xbf353f35,0xbf800000,0xbf35bf35
.long 0x0,0x0,0x0,0x0,0x0,0x0,0x0,0x0
.long 0x0,0x0,0x0,0x0,0x0,0x0,0x0,0x0
.long 0x0,0x0,0x0,0x0,0x0,0x0,0x0,0x0
.long 0x0,0x0,0x0,0x0,0x0,0x0,0x0,0x0
.long 0x3f80,0x3f80,0x3f80,0x3f80,0x3f80,0x3f353f35,0x3f800000,0x3f35bf35
.long 0x3f80,0x3f800000,0xbf80,0xbf800000,0x3f80,0x3f35bf35,0xbf800000,0x3f353f35
.long 0x0,0x0,0x0,0x0,0x0,0x0,0x0,0x0
.long 0x0,0x0,0x0,0x0,0x0,0x0,0x0,0x0
.long 0x3f80,0xbf80,0x3f80,0xbf80,0x3f80,0xbf35bf35,0x3f800000,0xbf353f35
.long 0x3f80,0xbf800000,0xbf80,0x3f800000,0x3f80,0xbf353f35,0xbf800000,0xbf35bf35
.long 0x3f80,0x3f80,0x3f80,0x3f80,0xbf80,0xbf35bf35,0xbf800000,0xbf353f35
.long 0x3f80,0x3f800000,0xbf80,0xbf800000,0xbf80,0xbf353f35,0x3f800000,0xbf35bf35
.long 0x0,0x0,0x0,0x0,0x0,0x0,0x0,0x0
.long 0x0,0x0,0x0,0x0,0x0,0x0,0x0,0x0
.long 0x3f80,0xbf80,0x3f80,0xbf80,0xbf80,0x3f353f35,0xbf800000,0x3f35bf35
.long 0x3f80,0xbf800000,0xbf80,0x3f800000,0xbf80,0x3f35bf35,0x3f800000,0x3f353f35
.long 0x0,0x0,0x0,0x0,0x0,0x0,0x0,0x0
.long 0x0,0x0,0x0,0x0,0x0,0x0,0x0,0x0
.long 0x0,0x0,0x0,0x0,0x0,0x0,0x0,0x0
.long 0x0,0x0,0x0,0x0,0x0,0x0,0x0,0x0
.long 0x3f80,0x3f80,0x3f80,0x3f80,0xbf80,0xbf35bf35,0xbf800000,0xbf353f35
.long 0x3f80,0x3f800000,0xbf80,0xbf800000,0xbf80,0xbf353f35,0x3f800000,0xbf35bf35
.long 0x0,0x0,0x0,0x0,0x0,0x0,0x0,0x0
.long 0x0,0x0,0x0,0x0,0x0,0x0,0x0,0x0
.long 0x3f80,0xbf80,0x3f80,0xbf80,0xbf80,0x3f353f35,0xbf800000,0x3f35bf35
.long 0x3f80,0xbf800000,0xbf80,0x3f800000,0xbf80,0x3f35bf35,0x3f800000,0x3f353f35
.long 0x3f808000,0x3f808000,0x3f808000,0x3f808000,0x3f808000,0x3f35bf35,0xbf80,0xbf35bf35
.long 0x3f808000,0xbf80,0xbf808000,0x3f80,0x3f808000,0xbf35bf35,0x3f80,0x3f35bf35
.long 0x0,0x0,0x0,0x0,0x0,0x0,0x0,0x0
.long 0x0,0x0,0x0,0x0,0x0,0x0,0x0,0x0
.long 0x3f808000,0xbf808000,0x3f808000,0xbf808000,0x3f808000,0xbf353f35,0xbf80,0x3f353f35
.long 0x3f808000,0x3f80,0xbf808000,0xbf80,0x3f808000,0x3f353f35,0x3f80,0xbf353f35
.long 0x0,0x0,0x0,0x0,0x0,0x0,0x0,0x0
.long 0x0,0x0,0x0,0x0,0x0,0x0,0x0,0x0
.long 0x0,0x0,0x0,0x0,0x0,0x0,0x0,0x0
.long 0x0,0x0,0x0,0x0,0x0,0x0,0x0,0x0
.long 0x3f808000,0x3f808000,0x3f808000,0x3f808000,0x3f808000,0x3f35bf35,0xbf80,0xbf35bf35
.long 0x3f808000,0xbf80,0xbf808000,0x3f80,0x3f808000,0xbf35bf35,0x3f80,0x3f35bf35
.long 0x0,0x0,0x0,0x0,0x0,0x0,0x0,0x0
.long 0x0,0x0,0x0,0x0,0x0,0x0,0x0,0x0
.long 0x3f808000,0xbf808000,0x3f808000,0xbf808000,0x3f808000,0xbf353f35,0xbf80,0x3f353f35
.long 0x3f808000,0x3f80,0xbf808000,0xbf80,0x3f808000,0x3f353f35,0x3f80,0xbf353f35
.long 0x3f808000,0x3f808000,0x3f808000,0x3f808000,0xbf808000,0xbf353f35,0x3f80,0x3f353f35
.long 0x3f808000,0xbf80,0xbf808000,0x3f80,0xbf808000,0x3f353f35,0xbf80,0xbf353f35
.long 0x0,0x0,0x0,0x0,0x0,0x0,0x0,0x0
.long 0x0,0x0,0x0,0x0,0x0,0x0,0x0,0x0
.long 0x3f808000,0xbf808000,0x3f808000,0xbf808000,0xbf808000,0x3f35bf35,0x3f80,0xbf35bf35
.long 0x3f808000,0x3f80,0xbf808000,0xbf80,0xbf808000,0xbf35bf35,0xbf80,0x3f35bf35
.long 0x0,0x0,0x0,0x0,0x0,0x0,0x0,0x0
.long 0x0,0x0,0x0,0x0,0x0,0x0,0x0,0x0
.long 0x0,0x0,0x0,0x0,0x0,0x0,0x0,0x0
.long 0x0,0x0,0x0,0x0,0x0,0x0,0x0,0x0
.long 0x3f808000,0x3f808000,0x3f808000,0x3f808000,0xbf808000,0xbf353f35,0x3f80,0x3f353f35
.long 0x3f808000,0xbf80,0xbf808000,0x3f80,0xbf808000,0x3f353f35,0xbf80,0xbf353f35
.long 0x0,0x0,0x0,0x0,0x0,0x0,0x0,0x0
.long 0x0,0x0,0x0,0x0,0x0,0x0,0x0,0x0
.long 0x3f808000,0xbf808000,0x3f808000,0xbf808000,0xbf808000,0x3f35bf35,0x3f80,0xbf35bf35
.long 0x3f808000,0x3f80,0xbf808000,0xbf80,0xbf808000,0xbf35bf35,0xbf80,0x3f35bf35
.long 0x35e38e39,0x35e38e39,0x35e38e39,0x35e38e39,0x35e38e39,0x35e3480d,0x35e275b6,0x35e117b5
.long 0x35e38e39,0x35e275b6,0x35df2ee2,0x35d9c1d1,0x35e38e39,0x35e117b5,0x35d9c1d1,0x35cdb531
.long 0x35e38e39,0x35df2ee2,0x35d23be2,0x35bd349e,0x35e38e39,0x35dcbc6b,0x35c8afa3,0x35a89b88
.long 0x35e38e39,0x35d9c1d1,0x35bd349e,0x35905c16,0x35e38e39,0x35d640eb,0x35afe71f,0x3569f950
.long 0x35e38e39,0x35d23be2,0x35a0e7f5,0x352e29da,0x35e38e39,0x35cdb531,0x35905c16,0x34dd2a7c
.long 0x35e38e39,0x35c8afa3,0x357cd8a0,0x34326f4c,0x35e38e39,0x35c32e50,0x355689b3,0xb3b2a663
.long 0x35e38e39,0x35bd349e,0x352e29da,0xb4b19357,0x35e38e39,0x35b6c63b,0x35041c9e,0xb5195283
.long 0x35e38e39,0x35afe71f,0x34b19357,0xb55689b3,0x35e38e39,0x35a89b88,0x34326f4c,0xb5878e00
.long 0x35e38e39,0x35e38e39,0x35e38e39,0x35e38e39,0x35e38e39,0x35e3480d,0x35e275b6,0x35e117b5
.long 0x35e38e39,0x35e275b6,0x35df2ee2,0x35d9c1d1,0x35e38e39,0x35e117b5,0x35d9c1d1,0x35cdb531
.long 0x35e38e39,0x35df2ee2,0x35d23be2,0x35bd349e,0x35e38e39,0x35dcbc6b,0x35c8afa3,0x35a89b88
.long 0x35e38e39,0x35d9c1d1,0x35bd349e,0x35905c16,0x35e38e39,0x35d640eb,0x35afe71f,0x3569f950
.long 0x35e38e39,0x35d23be2,0x35a0e7f5,0x352e29da,0x35e38e39,0x35cdb531,0x35905c16,0x34dd2a7c
.long 0x35e38e39,0x35c8afa3,0x357cd8a0,0x34326f4c,0x35e38e39,0x35c32e50,0x355689b3,0xb3b2a663
.long 0x35e38e39,0x35bd349e,0x352e29da,0xb4b19357,0x35e38e39,0x35b6c63b,0x35041c9e,0xb5195283
.long 0x35e38e39,0x35afe71f,0x34b19357,0xb55689b3,0x35e38e39,0x35a89b88,0x34326f4c,0xb5878e00
.long 0x35e38e39,0x35e38e39,0x35e38e39,0x35e38e39,0x35df2ee2,0x35dcbc6b,0x35d9c1d1,0x35d640eb
.long 0x35d23be2,0x35c8afa3,0x35bd349e,0x35afe71f,0x35bd349e,0x35a89b88,0x35905c16,0x3569f950
.long 0x35a0e7f5,0x357cd8a0,0x352e29da,0x34b19357,0x357cd8a0,0x35195283,0x34326f4c,0xb4858eae
.long 0x352e29da,0x34326f4c,0xb4b19357,0xb55689b3,0x34b19357,0xb4858eae,0xb55689b3,0xb5a89b88
.long 0x0,0xb52e29da,0xb5a0e7f5,0xb5d23be2,0xb4b19357,0xb5878e00,0xb5c8afa3,0xb5e3480d
.long 0xb52e29da,0xb5afe71f,0xb5df2ee2,0xb5d9c1d1,0xb57cd8a0,0xb5cdb531,0xb5e275b6,0xb5b6c63b
.long 0xb5a0e7f5,0xb5df2ee2,0xb5d23be2,0xb57cd8a0,0xb5bd349e,0xb5e3480d,0xb5afe71f,0xb4dd2a7c
.long 0xb5d23be2,0xb5d9c1d1,0xb57cd8a0,0x34326f4c,0xb5df2ee2,0xb5c32e50,0xb5041c9e,0x354295c7
.long 0x35e38e39,0x35e38e39,0x35e38e39,0x35e38e39,0x35df2ee2,0x35dcbc6b,0x35d9c1d1,0x35d640eb
.long 0x35d23be2,0x35c8afa3,0x35bd349e,0x35afe71f,0x35bd349e,0x35a89b88,0x35905c16,0x3569f950
.long 0x35a0e7f5,0x357cd8a0,0x352e29da,0x34b19357,0x357cd8a0,0x35195283,0x34326f4c,0xb4858eae
.long 0x352e29da,0x34326f4c,0xb4b19357,0xb55689b3,0x34b19357,0xb4858eae,0xb55689b3,0xb5a89b88
.long 0x0,0xb52e29da,0xb5a0e7f5,0xb5d23be2,0xb4b19357,0xb5878e00,0xb5c8afa3,0xb5e3480d
.long 0xb52e29da,0xb5afe71f,0xb5df2ee2,0xb5d9c1d1,0xb57cd8a0,0xb5cdb531,0xb5e275b6,0xb5b6c63b
.long 0xb5a0e7f5,0xb5df2ee2,0xb5d23be2,0xb57cd8a0,0xb5bd349e,0xb5e3480d,0xb5afe71f,0xb4dd2a7c
.long 0xb5d23be2,0xb5d9c1d1,0xb57cd8a0,0x34326f4c,0xb5df2ee2,0xb5c32e50,0xb5041c9e,0x354295c7
.long 0x0,0x0,0x0,0x0,0x0,0xb3b2a663,0xb4326f4c,0xb4858eae
.long 0x0,0xb4326f4c,0xb4b19357,0xb5041c9e,0x0,0xb4858eae,0xb5041c9e,0xb54295c7
.long 0x0,0xb4b19357,0xb52e29da,0xb57cd8a0,0x0,0xb4dd2a7c,0xb55689b3,0xb598d125
.long 0x0,0xb5041c9e,0xb57cd8a0,0xb5afe71f,0x0,0xb5195283,0xb5905c16,0xb5c32e50
.long 0x0,0xb52e29da,0xb5a0e7f5,0xb5d23be2,0x0,0xb54295c7,0xb5afe71f,0xb5dcbc6b
.long 0x0,0xb55689b3,0xb5bd349e,0xb5e275b6,0x0,0xb569f950,0xb5c8afa3,0xb5e3480d
.long 0x0,0xb57cd8a0,0xb5d23be2,0xb5df2ee2,0x0,0xb5878e00,0xb5d9c1d1,0xb5d640eb
.long 0x0,0xb5905c16,0xb5df2ee2,0xb5c8afa3,0x0,0xb598d125,0xb5e275b6,0xb5b6c63b
.long 0x0,0x0,0x0,0x0,0x0,0xb3b2a663,0xb4326f4c,0xb4858eae
.long 0x0,0xb4326f4c,0xb4b19357,0xb5041c9e,0x0,0xb4858eae,0xb5041c9e,0xb54295c7
.long 0x0,0xb4b19357,0xb52e29da,0xb57cd8a0,0x0,0xb4dd2a7c,0xb55689b3,0xb598d125
.long 0x0,0xb5041c9e,0xb57cd8a0,0xb5afe71f,0x0,0xb5195283,0xb5905c16,0xb5c32e50
.long 0x0,0xb52e29da,0xb5a0e7f5,0xb5d23be2,0x0,0xb54295c7,0xb5afe71f,0xb5dcbc6b
.long 0x0,0xb55689b3,0xb5bd349e,0xb5e275b6,0x0,0xb569f950,0xb5c8afa3,0xb5e3480d
.long 0x0,0xb57cd8a0,0xb5d23be2,0xb5df2ee2,0x0,0xb5878e00,0xb5d9c1d1,0xb5d640eb
.long 0x0,0xb5905c16,0xb5df2ee2,0xb5c8afa3,0x0,0xb598d125,0xb5e275b6,0xb5b6c63b
.long 0x0,0x0,0x0,0x0,0xb4b19357,0xb4dd2a7c,0xb5041c9e,0xb5195283
.long 0xb52e29da,0xb55689b3,0xb57cd8a0,0xb5905c16,0xb57cd8a0,0xb598d125,0xb5afe71f,0xb5c32e50
.long 0xb5a0e7f5,0xb5bd349e,0xb5d23be2,0xb5df2ee2,0xb5bd349e,0xb5d640eb,0xb5e275b6,0xb5e117b5
.long 0xb5d23be2,0xb5e275b6,0xb5df2ee2,0xb5c8afa3,0xb5df2ee2,0xb5e117b5,0xb5c8afa3,0xb598d125
.long 0xb5e38e39,0xb5d23be2,0xb5a0e7f5,0xb52e29da,0xb5df2ee2,0xb5b6c63b,0xb55689b3,0xb3b2a663
.long 0xb5d23be2,0xb5905c16,0xb4b19357,0x35041c9e,0xb5bd349e,0xb54295c7,0x34326f4c,0x35878e00
.long 0xb5a0e7f5,0xb4b19357,0x352e29da,0x35bd349e,0xb57cd8a0,0x33b2a663,0x35905c16,0x35dcbc6b
.long 0xb52e29da,0x35041c9e,0x35bd349e,0x35e275b6,0xb4b19357,0x3569f950,0x35d9c1d1,0x35cdb531
.long 0x0,0x0,0x0,0x0,0xb4b19357,0xb4dd2a7c,0xb5041c9e,0xb5195283
.long 0xb52e29da,0xb55689b3,0xb57cd8a0,0xb5905c16,0xb57cd8a0,0xb598d125,0xb5afe71f,0xb5c32e50
.long 0xb5a0e7f5,0xb5bd349e,0xb5d23be2,0xb5df2ee2,0xb5bd349e,0xb5d640eb,0xb5e275b6,0xb5e117b5
.long 0xb5d23be2,0xb5e275b6,0xb5df2ee2,0xb5c8afa3,0xb5df2ee2,0xb5e117b5,0xb5c8afa3,0xb598d125
.long 0xb5e38e39,0xb5d23be2,0xb5a0e7f5,0xb52e29da,0xb5df2ee2,0xb5b6c63b,0xb55689b3,0xb3b2a663
.long 0xb5d23be2,0xb5905c16,0xb4b19357,0x35041c9e,0xb5bd349e,0xb54295c7,0x34326f4c,0x35878e00
.long 0xb5a0e7f5,0xb4b19357,0x352e29da,0x35bd349e,0xb57cd8a0,0x33b2a663,0x35905c16,0x35dcbc6b
.long 0xb52e29da,0x35041c9e,0x35bd349e,0x35e275b6,0xb4b19357,0x3569f950,0x35d9c1d1,0x35cdb531
.long 0x3f800000,0x3f800000,0x3f800000,0x3f800000,0x3f800000,0x3f7fb10f,0x3f7ec46d,0x3f7d3aac
.long 0x3f800000,0x3f7ec46d,0x3f7b14be,0x3f74fa0b,0x3f800000,0x3f7d3aac,0x3f74fa0b,0x3f676bd8
.long 0x3f800000,0x3f800000,0x3f800000,0x3f800000,0x3f800000,0x3f7fb10f,0x3f7ec46d,0x3f7d3aac
.long 0x3f800000,0x3f7ec46d,0x3f7b14be,0x3f74fa0b,0x3f800000,0x3f7d3aac,0x3f74fa0b,0x3f676bd8
.long 0x3f800000,0x3f7b14be,0x3f6c835e,0x3f54db31,0x3f800000,0x3f7853f8,0x3f61c598,0x3f3daef9
.long 0x3f800000,0x3f74fa0b,0x3f54db31,0x3f226799,0x3f800000,0x3f710908,0x3f45e403,0x3f039c3d
.long 0x3f800000,0x3f7b14be,0x3f6c835e,0x3f54db31,0x3f800000,0x3f7853f8,0x3f61c598,0x3f3daef9
.long 0x3f800000,0x3f74fa0b,0x3f54db31,0x3f226799,0x3f800000,0x3f710908,0x3f45e403,0x3f039c3d
.long 0x3f800000,0x3f800000,0x3f800000,0x3f800000,0x3f7b14be,0x3f7853f8,0x3f74fa0b,0x3f710908
.long 0x3f6c835e,0x3f61c598,0x3f54db31,0x3f45e403,0x3f54db31,0x3f3daef9,0x3f226799,0x3f039c3d
.long 0x3f800000,0x3f800000,0x3f800000,0x3f800000,0x3f7b14be,0x3f7853f8,0x3f74fa0b,0x3f710908
.long 0x3f6c835e,0x3f61c598,0x3f54db31,0x3f45e403,0x3f54db31,0x3f3daef9,0x3f226799,0x3f039c3d
.long 0x3f3504f3,0x3f0e39da,0x3ec3ef15,0x3e47c5c2,0x3f0e39da,0x3eac7cd4,0x3dc8bd36,0xbe164083
.long 0x3ec3ef15,0x3dc8bd36,0xbe47c5c2,0xbef15aea,0x3e47c5c2,0xbe164083,0xbef15aea,0xbf3daef9
.long 0x3f3504f3,0x3f0e39da,0x3ec3ef15,0x3e47c5c2,0x3f0e39da,0x3eac7cd4,0x3dc8bd36,0xbe164083
.long 0x3ec3ef15,0x3dc8bd36,0xbe47c5c2,0xbef15aea,0x3e47c5c2,0xbe164083,0xbef15aea,0xbf3daef9
.long 0x3f800000,0x3f800000,0x3f800000,0x3f800000,0x3f6c835e,0x3f676bd8,0x3f61c598,0x3f5b941a
.long 0x3f3504f3,0x3f226799,0x3f0e39da,0x3ef15aea,0x3ec3ef15,0x3e78cfcc,0x3dc8bd36,0xbd48fb30
.long 0x3f800000,0x3f800000,0x3f800000,0x3f800000,0x3f6c835e,0x3f676bd8,0x3f61c598,0x3f5b941a
.long 0x3f3504f3,0x3f226799,0x3f0e39da,0x3ef15aea,0x3ec3ef15,0x3e78cfcc,0x3dc8bd36,0xbd48fb30
.long 0x0,0xbe47c5c2,0xbec3ef15,0xbf0e39da,0xbec3ef15,0xbf187fc0,0xbf45e403,0xbf676bd8
.long 0xbf3504f3,0xbf61c598,0xbf7b14be,0xbf7ec46d,0xbf6c835e,0xbf7fb10f,0xbf74fa0b,0xbf4d9f02
.long 0x0,0xbe47c5c2,0xbec3ef15,0xbf0e39da,0xbec3ef15,0xbf187fc0,0xbf45e403,0xbf676bd8
.long 0xbf3504f3,0xbf61c598,0xbf7b14be,0xbf7ec46d,0xbf6c835e,0xbf7fb10f,0xbf74fa0b,0xbf4d9f02
.long 0x3f800000,0x3f800000,0x3f800000,0x3f800000,0x3f54db31,0x3f4d9f02,0x3f45e403,0x3f3daef9
.long 0x3ec3ef15,0x3e94a031,0x3e47c5c2,0x3dc8bd36,0xbe47c5c2,0xbeac7cd4,0xbef15aea,0xbf187fc0
.long 0x3f800000,0x3f800000,0x3f800000,0x3f800000,0x3f54db31,0x3f4d9f02,0x3f45e403,0x3f3daef9
.long 0x3ec3ef15,0x3e94a031,0x3e47c5c2,0x3dc8bd36,0xbe47c5c2,0xbeac7cd4,0xbef15aea,0xbf187fc0
.long 0xbf3504f3,0xbf54db31,0xbf6c835e,0xbf7b14be,0xbf7b14be,0xbf7fb10f,0xbf74fa0b,0xbf5b941a
.long 0xbf6c835e,0xbf45e403,0xbf0e39da,0xbe94a031,0xbf0e39da,0xbe78cfcc,0x3dc8bd36,0x3edae880
.long 0xbf3504f3,0xbf54db31,0xbf6c835e,0xbf7b14be,0xbf7b14be,0xbf7fb10f,0xbf74fa0b,0xbf5b941a
.long 0xbf6c835e,0xbf45e403,0xbf0e39da,0xbe94a031,0xbf0e39da,0xbe78cfcc,0x3dc8bd36,0x3edae880
.long 0x0,0x0,0x0,0x0,0x0,0xbd48fb30,0xbdc8bd36,0xbe164083
.long 0x0,0xbdc8bd36,0xbe47c5c2,0xbe94a031,0x0,0xbe164083,0xbe94a031,0xbedae880
.long 0x0,0x0,0x0,0x0,0x0,0xbd48fb30,0xbdc8bd36,0xbe164083
.long 0x0,0xbdc8bd36,0xbe47c5c2,0xbe94a031,0x0,0xbe164083,0xbe94a031,0xbedae880
.long 0x0,0xbe47c5c2,0xbec3ef15,0xbf0e39da,0x0,0xbe78cfcc,0xbef15aea,0xbf2beb4a
.long 0x0,0xbe94a031,0xbf0e39da,0xbf45e403,0x0,0xbeac7cd4,0xbf226799,0xbf5b941a
.long 0x0,0xbe47c5c2,0xbec3ef15,0xbf0e39da,0x0,0xbe78cfcc,0xbef15aea,0xbf2beb4a
.long 0x0,0xbe94a031,0xbf0e39da,0xbf45e403,0x0,0xbeac7cd4,0xbf226799,0xbf5b941a
.long 0x0,0x0,0x0,0x0,0xbe47c5c2,0xbe78cfcc,0xbe94a031,0xbeac7cd4
.long 0xbec3ef15,0xbef15aea,0xbf0e39da,0xbf226799,0xbf0e39da,0xbf2beb4a,0xbf45e403,0xbf5b941a
.long 0x0,0x0,0x0,0x0,0xbe47c5c2,0xbe78cfcc,0xbe94a031,0xbeac7cd4
.long 0xbec3ef15,0xbef15aea,0xbf0e39da,0xbf226799,0xbf0e39da,0xbf2beb4a,0xbf45e403,0xbf5b941a
.long 0xbf3504f3,0xbf54db31,0xbf6c835e,0xbf7b14be,0xbf54db31,0xbf710908,0xbf7ec46d,0xbf7d3aac
.long 0xbf6c835e,0xbf7ec46d,0xbf7b14be,0xbf61c598,0xbf7b14be,0xbf7d3aac,0xbf61c598,0xbf2beb4a
.long 0xbf3504f3,0xbf54db31,0xbf6c835e,0xbf7b14be,0xbf54db31,0xbf710908,0xbf7ec46d,0xbf7d3aac
.long 0xbf6c835e,0xbf7ec46d,0xbf7b14be,0xbf61c598,0xbf7b14be,0xbf7d3aac,0xbf61c598,0xbf2beb4a
.long 0x0,0x0,0x0,0x0,0xbec3ef15,0xbedae880,0xbef15aea,0xbf039c3d
.long 0xbf3504f3,0xbf45e403,0xbf54db31,0xbf61c598,0xbf6c835e,0xbf7853f8,0xbf7ec46d,0xbf7fb10f
.long 0x0,0x0,0x0,0x0,0xbec3ef15,0xbedae880,0xbef15aea,0xbf039c3d
.long 0xbf3504f3,0xbf45e403,0xbf54db31,0xbf61c598,0xbf6c835e,0xbf7853f8,0xbf7ec46d,0xbf7fb10f
.long 0xbf800000,0xbf7b14be,0xbf6c835e,0xbf54db31,0xbf6c835e,0xbf4d9f02,0xbf226799,0xbedae880
.long 0xbf3504f3,0xbef15aea,0xbe47c5c2,0x3dc8bd36,0xbec3ef15,0xbd48fb30,0x3e94a031,0x3f187fc0
.long 0xbf800000,0xbf7b14be,0xbf6c835e,0xbf54db31,0xbf6c835e,0xbf4d9f02,0xbf226799,0xbedae880
.long 0xbf3504f3,0xbef15aea,0xbe47c5c2,0x3dc8bd36,0xbec3ef15,0xbd48fb30,0x3e94a031,0x3f187fc0
.long 0x0,0x0,0x0,0x0,0xbf0e39da,0xbf187fc0,0xbf226799,0xbf2beb4a
.long 0xbf6c835e,0xbf74fa0b,0xbf7b14be,0xbf7ec46d,0xbf7b14be,0xbf710908,0xbf61c598,0xbf4d9f02
.long 0x0,0x0,0x0,0x0,0xbf0e39da,0xbf187fc0,0xbf226799,0xbf2beb4a
.long 0xbf6c835e,0xbf74fa0b,0xbf7b14be,0xbf7ec46d,0xbf7b14be,0xbf710908,0xbf61c598,0xbf4d9f02
.long 0xbf3504f3,0xbf0e39da,0xbec3ef15,0xbe47c5c2,0xbe47c5c2,0x3d48fb30,0x3e94a031,0x3f039c3d
.long 0x3ec3ef15,0x3f226799,0x3f54db31,0x3f74fa0b,0x3f54db31,0x3f7853f8,0x3f7ec46d,0x3f676bd8
.long 0xbf3504f3,0xbf0e39da,0xbec3ef15,0xbe47c5c2,0xbe47c5c2,0x3d48fb30,0x3e94a031,0x3f039c3d
.long 0x3ec3ef15,0x3f226799,0x3f54db31,0x3f74fa0b,0x3f54db31,0x3f7853f8,0x3f7ec46d,0x3f676bd8
.long 0x3f80,0x3f80,0x3f80,0x3f80,0x3f80,0x3ec43f6d,0x3f353f35,0x3f6d3ec4
.long 0x3f80,0x3f353f35,0x3f800000,0x3f35bf35,0x3f80,0x3f6d3ec4,0x3f35bf35,0xbec4bf6d
.long 0x3f80,0x3f800000,0xbf80,0xbf800000,0x3f80,0x3f6dbec4,0xbf35bf35,0xbec43f6d
.long 0x3f80,0x3f35bf35,0xbf800000,0x3f353f35,0x3f80,0x3ec4bf6d,0xbf353f35,0x3f6dbec4
.long 0x3f80,0xbf80,0x3f80,0xbf80,0x3f80,0xbec4bf6d,0x3f353f35,0xbf6dbec4
.long 0x3f80,0xbf35bf35,0x3f800000,0xbf353f35,0x3f80,0xbf6dbec4,0x3f35bf35,0x3ec43f6d
.long 0x3f80,0xbf800000,0xbf80,0x3f800000,0x3f80,0xbf6d3ec4,0xbf35bf35,0x3ec4bf6d
.long 0x3f80,0xbf353f35,0xbf800000,0xbf35bf35,0x3f80,0xbec43f6d,0xbf353f35,0xbf6d3ec4
.long 0x3f80,0x3f80,0x3f80,0x3f80,0x3f800000,0x3f6dbec4,0x3f35bf35,0x3ec4bf6d
.long 0xbf80,0xbf35bf35,0xbf800000,0xbf353f35,0xbf800000,0xbec43f6d,0x3f353f35,0x3f6dbec4
.long 0x3f80,0x3f800000,0xbf80,0xbf800000,0x3f800000,0xbec4bf6d,0xbf353f35,0x3f6d3ec4
.long 0xbf80,0xbf353f35,0x3f800000,0xbf35bf35,0xbf800000,0x3f6d3ec4,0xbf35bf35,0x3ec43f6d
.long 0x3f80,0xbf80,0x3f80,0xbf80,0x3f800000,0xbf6d3ec4,0x3f35bf35,0xbec43f6d
.long 0xbf80,0x3f353f35,0xbf800000,0x3f35bf35,0xbf800000,0x3ec4bf6d,0x3f353f35,0xbf6d3ec4
.long 0x3f80,0xbf800000,0xbf80,0x3f800000,0x3f800000,0x3ec43f6d,0xbf353f35,0xbf6dbec4
.long 0xbf80,0x3f35bf35,0x3f800000,0x3f353f35,0xbf800000,0xbf6dbec4,0xbf35bf35,0xbec4bf6d
.long 0x3f80,0x3f80,0x3f80,0x3f80,0xbf80,0xbec4bf6d,0xbf35bf35,0xbf6dbec4
.long 0x3f80,0x3f353f35,0x3f800000,0x3f35bf35,0xbf80,0xbf6dbec4,0xbf353f35,0x3ec43f6d
.long 0x3f80,0x3f800000,0xbf80,0xbf800000,0xbf80,0xbf6d3ec4,0x3f353f35,0x3ec4bf6d
.long 0x3f80,0x3f35bf35,0xbf800000,0x3f353f35,0xbf80,0xbec43f6d,0x3f35bf35,0xbf6d3ec4
.long 0x3f80,0xbf80,0x3f80,0xbf80,0xbf80,0x3ec43f6d,0xbf35bf35,0x3f6d3ec4
.long 0x3f80,0xbf35bf35,0x3f800000,0xbf353f35,0xbf80,0x3f6d3ec4,0xbf353f35,0xbec4bf6d
.long 0x3f80,0xbf800000,0xbf80,0x3f800000,0xbf80,0x3f6dbec4,0x3f353f35,0xbec43f6d
.long 0x3f80,0xbf353f35,0xbf800000,0xbf35bf35,0xbf80,0x3ec4bf6d,0x3f35bf35,0x3f6dbec4
.long 0x3f80,0x3f80,0x3f80,0x3f80,0xbf800000,0xbf6d3ec4,0xbf353f35,0xbec43f6d
.long 0xbf80,0xbf35bf35,0xbf800000,0xbf353f35,0x3f800000,0x3ec4bf6d,0xbf35bf35,0xbf6d3ec4
.long 0x3f80,0x3f800000,0xbf80,0xbf800000,0xbf800000,0x3ec43f6d,0x3f35bf35,0xbf6dbec4
.long 0xbf80,0xbf353f35,0x3f800000,0xbf35bf35,0x3f800000,0xbf6dbec4,0x3f353f35,0xbec4bf6d
.long 0x3f80,0xbf80,0x3f80,0xbf80,0xbf800000,0x3f6dbec4,0xbf353f35,0x3ec4bf6d
.long 0xbf80,0x3f353f35,0xbf800000,0x3f35bf35,0x3f800000,0xbec43f6d,0xbf35bf35,0x3f6dbec4
.long 0x3f80,0xbf800000,0xbf80,0x3f800000,0xbf800000,0xbec4bf6d,0x3f35bf35,0x3f6d3ec4
.long 0xbf80,0x3f35bf35,0x3f800000,0x3f353f35,0x3f800000,0x3f6d3ec4,0x3f353f35,0x3ec43f6d
.long 0x3f808000,0x3f808000,0x3f808000,0x3f808000,0x3f808000,0x3f6dbec4,0x3f35bf35,0x3ec4bf6d
.long 0x3f808000,0x3f35bf35,0xbf80,0xbf35bf35,0x3f808000,0x3ec4bf6d,0xbf35bf35,0xbf6d3ec4
.long 0x3f808000,0xbf80,0xbf808000,0x3f80,0x3f808000,0xbec4bf6d,0xbf353f35,0x3f6d3ec4
.long 0x3f808000,0xbf35bf35,0x3f80,0x3f35bf35,0x3f808000,0xbf6dbec4,0x3f353f35,0xbec4bf6d
.long 0x3f808000,0xbf808000,0x3f808000,0xbf808000,0x3f808000,0xbf6d3ec4,0x3f35bf35,0xbec43f6d
.long 0x3f808000,0xbf353f35,0xbf80,0x3f353f35,0x3f808000,0xbec43f6d,0xbf35bf35,0x3f6dbec4
.long 0x3f808000,0x3f80,0xbf808000,0xbf80,0x3f808000,0x3ec43f6d,0xbf353f35,0xbf6dbec4
.long 0x3f808000,0x3f353f35,0x3f80,0xbf353f35,0x3f808000,0x3f6d3ec4,0x3f353f35,0x3ec43f6d
.long 0x3f808000,0x3f808000,0x3f808000,0x3f808000,0xbf80,0xbec4bf6d,0xbf35bf35,0xbf6dbec4
.long 0xbf808000,0xbf353f35,0x3f80,0x3f353f35,0x3f80,0x3f6d3ec4,0x3f35bf35,0xbec4bf6d
.long 0x3f808000,0xbf80,0xbf808000,0x3f80,0xbf80,0xbf6d3ec4,0x3f353f35,0x3ec4bf6d
.long 0xbf808000,0x3f353f35,0xbf80,0xbf353f35,0x3f80,0x3ec4bf6d,0xbf353f35,0x3f6dbec4
.long 0x3f808000,0xbf808000,0x3f808000,0xbf808000,0xbf80,0x3ec43f6d,0xbf35bf35,0x3f6d3ec4
.long 0xbf808000,0x3f35bf35,0x3f80,0xbf35bf35,0x3f80,0xbf6dbec4,0x3f35bf35,0x3ec43f6d
.long 0x3f808000,0x3f80,0xbf808000,0xbf80,0xbf80,0x3f6dbec4,0x3f353f35,0xbec43f6d
.long 0xbf808000,0xbf35bf35,0xbf80,0x3f35bf35,0x3f80,0xbec43f6d,0xbf353f35,0xbf6d3ec4
.long 0x3f808000,0x3f808000,0x3f808000,0x3f808000,0xbf808000,0xbf6d3ec4,0xbf353f35,0xbec43f6d
.long 0x3f808000,0x3f35bf35,0xbf80,0xbf35bf35,0xbf808000,0xbec43f6d,0x3f353f35,0x3f6dbec4
.long 0x3f808000,0xbf80,0xbf808000,0x3f80,0xbf808000,0x3ec43f6d,0x3f35bf35,0xbf6dbec4
.long 0x3f808000,0xbf35bf35,0x3f80,0x3f35bf35,0xbf808000,0x3f6d3ec4,0xbf35bf35,0x3ec43f6d
.long 0x3f808000,0xbf808000,0x3f808000,0xbf808000,0xbf808000,0x3f6dbec4,0xbf353f35,0x3ec4bf6d
.long 0x3f808000,0xbf353f35,0xbf80,0x3f353f35,0xbf808000,0x3ec4bf6d,0x3f353f35,0xbf6d3ec4
.long 0x3f808000,0x3f80,0xbf808000,0xbf80,0xbf808000,0xbec4bf6d,0x3f35bf35,0x3f6d3ec4
.long 0x3f808000,0x3f353f35,0x3f80,0xbf353f35,0xbf808000,0xbf6dbec4,0xbf35bf35,0xbec4bf6d
.long 0x3f808000,0x3f808000,0x3f808000,0x3f808000,0x3f80,0x3ec43f6d,0x3f353f35,0x3f6d3ec4
.long 0xbf808000,0xbf353f35,0x3f80,0x3f353f35,0xbf80,0xbf6dbec4,0xbf353f35,0x3ec43f6d
.long 0x3f808000,0xbf80,0xbf808000,0x3f80,0x3f80,0x3f6dbec4,0xbf35bf35,0xbec43f6d
.long 0xbf808000,0x3f353f35,0xbf80,0xbf353f35,0xbf80,0xbec43f6d,0x3f35bf35,0xbf6d3ec4
.long 0x3f808000,0xbf808000,0x3f808000,0xbf808000,0x3f80,0xbec4bf6d,0x3f353f35,0xbf6dbec4
.long 0xbf808000,0x3f35bf35,0x3f80,0xbf35bf35,0xbf80,0x3f6d3ec4,0xbf353f35,0xbec4bf6d
.long 0x3f808000,0x3f80,0xbf808000,0xbf80,0x3f80,0xbf6d3ec4,0xbf35bf35,0x3ec4bf6d
.long 0xbf808000,0xbf35bf35,0xbf80,0x3f35bf35,0xbf80,0x3ec4bf6d,0x3f35bf35,0x3f6dbec4
.long 0x3f80,0x3e483f7b,0x3ec43f6d,0x3f0e3f55,0x3f80,0x3f0e3f55,0x3f6d3ec4,0x3f7bbe48
.long 0x3f80,0x3f553f0e,0x3f6dbec4,0x3e48bf7b,0x3f80,0x3f7b3e48,0x3ec4bf6d,0xbf55bf0e
.long 0x3f80,0x3f7bbe48,0xbec4bf6d,0xbf553f0e,0x3f80,0x3f55bf0e,0xbf6dbec4,0x3e483f7b
.long 0x3f80,0x3f0ebf55,0xbf6d3ec4,0x3f7b3e48,0x3f80,0x3e48bf7b,0xbec43f6d,0x3f0ebf55
.long 0x3f80,0xbe48bf7b,0x3ec43f6d,0xbf0ebf55,0x3f80,0xbf0ebf55,0x3f6d3ec4,0xbf7b3e48
.long 0x3f80,0xbf55bf0e,0x3f6dbec4,0xbe483f7b,0x3f80,0xbf7bbe48,0x3ec4bf6d,0x3f553f0e
.long 0x3f80,0xbf7b3e48,0xbec4bf6d,0x3f55bf0e,0x3f80,0xbf553f0e,0xbf6dbec4,0xbe48bf7b
.long 0x3f80,0xbf0e3f55,0xbf6d3ec4,0xbf7bbe48,0x3f80,0xbe483f7b,0xbec43f6d,0xbf0e3f55
.long 0x3f353f35,0x3f553f0e,0x3f6d3ec4,0x3f7b3e48,0x3f35bf35,0x3e48bf7b,0xbec4bf6d,0xbf55bf0e
.long 0xbf35bf35,0xbf7b3e48,0xbec43f6d,0x3f0e3f55,0xbf353f35,0x3f0e3f55,0x3f6dbec4,0xbe48bf7b
.long 0x3f353f35,0x3f0ebf55,0xbf6dbec4,0xbe483f7b,0x3f35bf35,0xbf7bbe48,0x3ec43f6d,0x3f0ebf55
.long 0xbf35bf35,0x3e483f7b,0x3ec4bf6d,0xbf553f0e,0xbf353f35,0x3f55bf0e,0xbf6d3ec4,0x3f7bbe48
.long 0x3f353f35,0xbf55bf0e,0x3f6d3ec4,0xbf7bbe48,0x3f35bf35,0xbe483f7b,0xbec4bf6d,0x3f553f0e
.long 0xbf35bf35,0x3f7bbe48,0xbec43f6d,0xbf0ebf55,0xbf353f35,0xbf0ebf55,0x3f6dbec4,0x3e483f7b
.long 0x3f353f35,0xbf0e3f55,0xbf6dbec4,0x3e48bf7b,0x3f35bf35,0x3f7b3e48,0x3ec43f6d,0xbf0e3f55
.long 0xbf35bf35,0xbe48bf7b,0x3ec4bf6d,0x3f55bf0e,0xbf353f35,0xbf553f0e,0xbf6d3ec4,0xbf7b3e48
.long 0x3f800000,0x3f7bbe48,0x3f6dbec4,0x3f55bf0e,0xbf800000,0xbf553f0e,0xbec43f6d,0x3e483f7b
.long 0x3f800000,0x3f0ebf55,0xbec4bf6d,0xbf7bbe48,0xbf800000,0xbe483f7b,0x3f6d3ec4,0x3f0ebf55
.long 0x3f800000,0xbe48bf7b,0xbf6d3ec4,0x3f0e3f55,0xbf800000,0x3f0e3f55,0x3ec4bf6d,0xbf7b3e48
.long 0x3f800000,0xbf55bf0e,0x3ec43f6d,0x3e48bf7b,0xbf800000,0x3f7b3e48,0xbf6dbec4,0x3f553f0e
.long 0x3f800000,0xbf7b3e48,0x3f6dbec4,0xbf553f0e,0xbf800000,0x3f55bf0e,0xbec43f6d,0xbe48bf7b
.long 0x3f800000,0xbf0e3f55,0xbec4bf6d,0x3f7b3e48,0xbf800000,0x3e48bf7b,0x3f6d3ec4,0xbf0e3f55
.long 0x3f800000,0x3e483f7b,0xbf6d3ec4,0xbf0ebf55,0xbf800000,0xbf0ebf55,0x3ec4bf6d,0x3f7bbe48
.long 0x3f800000,0x3f553f0e,0x3ec43f6d,0xbe483f7b,0xbf800000,0xbf7bbe48,0xbf6dbec4,0xbf55bf0e
.long 0x3f35bf35,0x3f0ebf55,0x3ec4bf6d,0x3e48bf7b,0x3f353f35,0x3f7b3e48,0x3f6dbec4,0x3f0ebf55
.long 0xbf353f35,0x3e483f7b,0x3f6d3ec4,0x3f55bf0e,0xbf35bf35,0xbf553f0e,0x3ec43f6d,0x3f7bbe48
.long 0x3f35bf35,0xbf55bf0e,0xbec43f6d,0x3f7b3e48,0x3f353f35,0x3e48bf7b,0xbf6d3ec4,0x3f553f0e
.long 0xbf353f35,0x3f7bbe48,0xbf6dbec4,0x3f0e3f55,0xbf35bf35,0x3f0e3f55,0xbec4bf6d,0x3e483f7b
.long 0x3f35bf35,0xbf0e3f55,0x3ec4bf6d,0xbe483f7b,0x3f353f35,0xbf7bbe48,0x3f6dbec4,0xbf0e3f55
.long 0xbf353f35,0xbe48bf7b,0x3f6d3ec4,0xbf553f0e,0xbf35bf35,0x3f55bf0e,0x3ec43f6d,0xbf7b3e48
.long 0x3f35bf35,0x3f553f0e,0xbec43f6d,0xbf7bbe48,0x3f353f35,0xbe483f7b,0xbf6d3ec4,0xbf55bf0e
.long 0xbf353f35,0xbf7b3e48,0xbf6dbec4,0xbf0ebf55,0xbf35bf35,0xbf0ebf55,0xbec4bf6d,0xbe48bf7b
.long 0x3f808000,0x3f7bbe48,0x3f6dbec4,0x3f55bf0e,0x3f808000,0x3f55bf0e,0x3ec4bf6d,0xbe48bf7b
.long 0x3f808000,0x3f0ebf55,0xbec4bf6d,0xbf7bbe48,0x3f808000,0x3e48bf7b,0xbf6dbec4,0xbf0e3f55
.long 0x3f808000,0xbe48bf7b,0xbf6d3ec4,0x3f0e3f55,0x3f808000,0xbf0ebf55,0xbec43f6d,0x3f7bbe48
.long 0x3f808000,0xbf55bf0e,0x3ec43f6d,0x3e48bf7b,0x3f808000,0xbf7bbe48,0x3f6d3ec4,0xbf55bf0e
.long 0x3f808000,0xbf7b3e48,0x3f6dbec4,0xbf553f0e,0x3f808000,0xbf553f0e,0x3ec4bf6d,0x3e483f7b
.long 0x3f808000,0xbf0e3f55,0xbec4bf6d,0x3f7b3e48,0x3f808000,0xbe483f7b,0xbf6dbec4,0x3f0ebf55
.long 0x3f808000,0x3e483f7b,0xbf6d3ec4,0xbf0ebf55,0x3f808000,0x3f0e3f55,0xbec43f6d,0xbf7b3e48
.long 0x3f808000,0x3f553f0e,0x3ec43f6d,0xbe483f7b,0x3f808000,0x3f7b3e48,0x3f6d3ec4,0x3f553f0e
.long 0x3f35bf35,0x3f0ebf55,0x3ec4bf6d,0x3e48bf7b,0xbf35bf35,0xbf7bbe48,0xbf6d3ec4,0xbf0e3f55
.long 0xbf353f35,0x3e483f7b,0x3f6d3ec4,0x3f55bf0e,0x3f353f35,0x3f55bf0e,0xbec4bf6d,0xbf7b3e48
.long 0x3f35bf35,0xbf55bf0e,0xbec43f6d,0x3f7b3e48,0xbf35bf35,0xbe483f7b,0x3f6dbec4,0xbf55bf0e
.long 0xbf353f35,0x3f7bbe48,0xbf6dbec4,0x3f0e3f55,0x3f353f35,0xbf0ebf55,0x3ec43f6d,0xbe48bf7b
.long 0x3f35bf35,0xbf0e3f55,0x3ec4bf6d,0xbe483f7b,0xbf35bf35,0x3f7b3e48,0xbf6d3ec4,0x3f0ebf55
.long 0xbf353f35,0xbe48bf7b,0x3f6d3ec4,0xbf553f0e,0x3f353f35,0xbf553f0e,0xbec4bf6d,0x3f7bbe48
.long 0x3f35bf35,0x3f553f0e,0xbec43f6d,0xbf7bbe48,0xbf35bf35,0x3e48bf7b,0x3f6dbec4,0x3f553f0e
.long 0xbf353f35,0xbf7b3e48,0xbf6dbec4,0xbf0ebf55,0x3f353f35,0x3f0e3f55,0x3ec43f6d,0x3e483f7b
.long 0xbf80,0xbe48bf7b,0xbec4bf6d,0xbf0ebf55,0x3f80,0x3f0e3f55,0x3f6d3ec4,0x3f7bbe48
.long 0xbf80,0xbf55bf0e,0xbf6d3ec4,0xbe483f7b,0x3f80,0x3f7b3e48,0x3ec4bf6d,0xbf55bf0e
.long 0xbf80,0xbf7b3e48,0x3ec43f6d,0x3f55bf0e,0x3f80,0x3f55bf0e,0xbf6dbec4,0x3e483f7b
.long 0xbf80,0xbf0e3f55,0x3f6dbec4,0xbf7bbe48,0x3f80,0x3e48bf7b,0xbec43f6d,0x3f0ebf55
.long 0xbf80,0x3e483f7b,0xbec4bf6d,0x3f0e3f55,0x3f80,0xbf0ebf55,0x3f6d3ec4,0xbf7b3e48
.long 0xbf80,0x3f553f0e,0xbf6d3ec4,0x3e48bf7b,0x3f80,0xbf7bbe48,0x3ec4bf6d,0x3f553f0e
.long 0xbf80,0x3f7bbe48,0x3ec43f6d,0xbf553f0e,0x3f80,0xbf553f0e,0xbf6dbec4,0xbe48bf7b
.long 0xbf80,0x3f0ebf55,0x3f6dbec4,0x3f7b3e48,0x3f80,0xbe483f7b,0xbec43f6d,0xbf0e3f55
.long 0xbf35bf35,0xbf55bf0e,0xbf6dbec4,0xbf7bbe48,0x3f35bf35,0x3e48bf7b,0xbec4bf6d,0xbf55bf0e
.long 0x3f353f35,0x3f7bbe48,0x3ec4bf6d,0xbf0ebf55,0xbf353f35,0x3f0e3f55,0x3f6dbec4,0xbe48bf7b
.long 0xbf35bf35,0xbf0e3f55,0x3f6d3ec4,0x3e48bf7b,0x3f35bf35,0xbf7bbe48,0x3ec43f6d,0x3f0ebf55
.long 0x3f353f35,0xbe48bf7b,0xbec43f6d,0x3f55bf0e,0xbf353f35,0x3f55bf0e,0xbf6d3ec4,0x3f7bbe48
.long 0xbf35bf35,0x3f553f0e,0xbf6dbec4,0x3f7b3e48,0x3f35bf35,0xbe483f7b,0xbec4bf6d,0x3f553f0e
.long 0x3f353f35,0xbf7b3e48,0x3ec4bf6d,0x3f0e3f55,0xbf353f35,0xbf0ebf55,0x3f6dbec4,0x3e483f7b
.long 0xbf35bf35,0x3f0ebf55,0x3f6d3ec4,0xbe483f7b,0x3f35bf35,0x3f7b3e48,0x3ec43f6d,0xbf0e3f55
.long 0x3f353f35,0x3e483f7b,0xbec43f6d,0xbf553f0e,0xbf353f35,0xbf553f0e,0xbf6d3ec4,0xbf7b3e48
.long 0x3f80,0x3f80,0x3f80,0x3f80,0x3f80,0x3f353f35,0x3f800000,0x3f35bf35
.long 0x3f80,0x3f800000,0xbf80,0xbf800000,0x3f80,0x3f35bf35,0xbf800000,0x3f353f35
.long 0x0,0x0,0x0,0x0,0x0,0x0,0x0,0x0
.long 0x0,0x0,0x0,0x0,0x0,0x0,0x0,0x0
.long 0x3f80,0xbf80,0x3f80,0xbf80,0x3f80,0xbf35bf35,0x3f800000,0xbf353f35
.long 0x3f80,0xbf800000,0xbf80,0x3f800000,0x3f80,0xbf353f35,0xbf800000,0xbf35bf35
.long 0x0,0x0,0x0,0x0,0x0,0x0,0x0,0x0
.long 0x0,0x0,0x0,0x0,0x0,0x0,0x0,0x0
.long 0x0,0x0,0x0,0x0,0x0,0x0,0x0,0x0
.long 0x0,0x0,0x0,0x0,0x0,0x0,0x0,0x0
.long 0x3f80,0x3f80,0x3f80,0x3f80,0x3f80,0x3f353f35,0x3f800000,0x3f35bf35
.long 0x3f80,0x3f800000,0xbf80,0xbf800000,0x3f80,0x3f35bf35,0xbf800000,0x3f353f35
.long 0x0,0x0,0x0,0x0,0x0,0x0,0x0,0x0
.long 0x0,0x0,0x0,0x0,0x0,0x0,0x0,0x0
.long 0x3f80,0xbf80,0x3f80,0xbf80,0x3f80,0xbf35bf35,0x3f800000,0xbf353f35
.long 0x3f80,0xbf800000,0xbf80,0x3f800000,0x3f80,0xbf353f35,0xbf800000,0xbf35bf35
.long 0x3f80,0x3f80,0x3f80,0x3f80,0xbf80,0xbf35bf35,0xbf800000,0xbf353f35
.long 0x3f80,0x3f800000,0xbf80,0xbf800000,0xbf80,0xbf353f35,0x3f800000,0xbf35bf35
.long 0x0,0x0,0x0,0x0,0x0,0x0,0x0,0x0
.long 0x0,0x0,0x0,0x0,0x0,0x0,0x0,0x0
.long 0x3f80,0xbf80,0x3f80,0xbf80,0xbf80,0x3f353f35,0xbf800000,0x3f35bf35
.long 0x3f80,0xbf800000,0xbf80,0x3f800000,0xbf80,0x3f35bf35,0x3f800000,0x3f353f35
.long 0x0,0x0,0x0,0x0,0x0,0x0,0x0,0x0
.long 0x0,0x0,0x0,0x0,0x0,0x0,0x0,0x0
.long 0x0,0x0,0x0,0x0,0x0,0x0,0x0,0x0
.long 0x0,0x0,0x0,0x0,0x0,0x0,0x0,0x0
.long 0x3f80,0x3f80,0x3f80,0x3f80,0xbf80,0xbf35bf35,0xbf800000,0xbf353f35
.long 0x3f80,0x3f800000,0xbf80,0xbf800000,0xbf80,0xbf353f35,0x3f800000,0xbf35bf35
.long 0x0,0x0,0x0,0x0,0x0,0x0,0x0,0x0
.long 0x0,0x0,0x0,0x0,0x0,0x0,0x0,0x0
.long 0x3f80,0xbf80,0x3f80,0xbf80,0xbf80,0x3f353f35,0xbf800000,0x3f35bf35
.long 0x3f80,0xbf800000,0xbf80,0x3f800000,0xbf80,0x3f35bf35,0x3f800000,0x3f353f35
.long 0x3f808000,0x3f808000,0x3f808000,0x3f808000,0x3f808000,0x3f35bf35,0xbf80,0xbf35bf35
.long 0x3f808000,0xbf80,0xbf808000,0x3f80,0x3f808000,0xbf35bf35,0x3f80,0x3f35bf35
.long 0x0,0x0,0x0,0x0,0x0,0x0,0x0,0x0
.long 0x0,0x0,0x0,0x0,0x0,0x0,0x0,0x0
.long 0x3f808000,0xbf808000,0x3f808000,0xbf808000,0x3f808000,0xbf353f35,0xbf80,0x3f353f35
.long 0x3f808000,0x3f80,0xbf808000,0xbf80,0x3f808000,0x3f353f35,0x3f80,0xbf353f35
.long 0x0,0x0,0x0,0x0,0x0,0x0,0x0,0x0
.long 0x0,0x0,0x0,0x0,0x0,0x0,0x0,0x0
.long 0x0,0x0,0x0,0x0,0x0,0x0,0x0,0x0
.long 0x0,0x0,0x0,0x0,0x0,0x0,0x0,0x0
.long 0x3f808000,0x3f808000,0x3f808000,0x3f808000,0x3f808000,0x3f35bf35,0xbf80,0xbf35bf35
.long 0x3f808000,0xbf80,0xbf808000,0x3f80,0x3f808000,0xbf35bf35,0x3f80,0x3f35bf35
.long 0x0,0x0,0x0,0x0,0x0,0x0,0x0,0x0
.long 0x0,0x0,0x0,0x0,0x0,0x0,0x0,0x0
.long 0x3f808000,0xbf808000,0x3f808000,0xbf808000,0x3f808000,0xbf353f35,0xbf80,0x3f353f35
.long 0x3f808000,0x3f80,0xbf808000,0xbf80,0x3f808000,0x3f353f35,0x3f80,0xbf353f35
.long 0x3f808000,0x3f808000,0x3f808000,0x3f808000,0xbf808000,0xbf353f35,0x3f80,0x3f353f35
.long 0x3f808000,0xbf80,0xbf808000,0x3f80,0xbf808000,0x3f353f35,0xbf80,0xbf353f35
.long 0x0,0x0,0x0,0x0,0x0,0x0,0x0,0x0
.long 0x0,0x0,0x0,0x0,0x0,0x0,0x0,0x0
.long 0x3f808000,0xbf808000,0x3f808000,0xbf808000,0xbf808000,0x3f35bf35,0x3f80,0xbf35bf35
.long 0x3f808000,0x3f80,0xbf808000,0xbf80,0xbf808000,0xbf35bf35,0xbf80,0x3f35bf35
.long 0x0,0x0,0x0,0x0,0x0,0x0,0x0,0x0
.long 0x0,0x0,0x0,0x0,0x0,0x0,0x0,0x0
.long 0x0,0x0,0x0,0x0,0x0,0x0,0x0,0x0
.long 0x0,0x0,0x0,0x0,0x0,0x0,0x0,0x0
.long 0x3f808000,0x3f808000,0x3f808000,0x3f808000,0xbf808000,0xbf353f35,0x3f80,0x3f353f35
.long 0x3f808000,0xbf80,0xbf808000,0x3f80,0xbf808000,0x3f353f35,0xbf80,0xbf353f35
.long 0x0,0x0,0x0,0x0,0x0,0x0,0x0,0x0
.long 0x0,0x0,0x0,0x0,0x0,0x0,0x0,0x0
.long 0x3f808000,0xbf808000,0x3f808000,0xbf808000,0xbf808000,0x3f35bf35,0x3f80,0xbf35bf35
.long 0x3f808000,0x3f80,0xbf808000,0xbf80,0xbf808000,0xbf35bf35,0xbf80,0x3f35bf35
.long 0x35e38e39,0x35e37cad,0x35e3480d,0x35e2f061,0x35e38e39,0x35e2f061,0x35e117b5,0x35de06c5
.long 0x35e38e39,0x35e1d820,0x35dcbc6b,0x35d44ec5,0x35e38e39,0x35e03495,0x35d640eb,0x35c5fe3e
.long 0x35e38e39,0x35de06c5,0x35cdb531,0x35b36482,0x35e38e39,0x35db5006,0x35c32e50,0x359ce8a6
.long 0x35e38e39,0x35d81207,0x35b6c63b,0x35830742,0x35e38e39,0x35d44ec5,0x35a89b88,0x354c9f84
.long 0x35e38e39,0x35d00894,0x3598d125,0x350ec292,0x35e38e39,0x35cb4216,0x35878e00,0x349b9d02
.long 0x35e38e39,0x35c5fe3e,0x3569f950,0x3332b42a,0x35e38e39,0x35c0404a,0x354295c7,0xb45ed782
.long 0x35e38e39,0x35ba0bc4,0x35195283,0xb4f2c494,0x35e38e39,0x35b36482,0x34dd2a7c,0xb5386e09
.long 0x35e38e39,0x35ac4e9d,0x34858eae,0xb5737bbe,0x35e38e39,0x35a4ce73,0x33b2a663,0xb594a213
.long 0x35e38e39,0x35e37cad,0x35e3480d,0x35e2f061,0x35e38e39,0x35e2f061,0x35e117b5,0x35de06c5
.long 0x35e38e39,0x35e1d820,0x35dcbc6b,0x35d44ec5,0x35e38e39,0x35e03495,0x35d640eb,0x35c5fe3e
.long 0x35e38e39,0x35de06c5,0x35cdb531,0x35b36482,0x35e38e39,0x35db5006,0x35c32e50,0x359ce8a6
.long 0x35e38e39,0x35d81207,0x35b6c63b,0x35830742,0x35e38e39,0x35d44ec5,0x35a89b88,0x354c9f84
.long 0x35e38e39,0x35d00894,0x3598d125,0x350ec292,0x35e38e39,0x35cb4216,0x35878e00,0x349b9d02
.long 0x35e38e39,0x35c5fe3e,0x3569f950,0x3332b42a,0x35e38e39,0x35c0404a,0x354295c7,0xb45ed782
.long 0x35e38e39,0x35ba0bc4,0x35195283,0xb4f2c494,0x35e38e39,0x35b36482,0x34dd2a7c,0xb5386e09
.long 0x35e38e39,0x35ac4e9d,0x34858eae,0xb5737bbe,0x35e38e39,0x35a4ce73,0x33b2a663,0xb594a213
.long 0x35e275b6,0x35e1d820,0x35e117b5,0x35e03495,0x35d9c1d1,0x35d44ec5,0x35cdb531,0x35c5fe3e
.long 0x35c8afa3,0x35ba0bc4,0x35a89b88,0x3594a213,0x35afe71f,0x3594a213,0x3569f950,0x3523cad0
.long 0x35905c16,0x354c9f84,0x34dd2a7c,0x3332b42a,0x355689b3,0x34c76e4a,0xb3b2a663,0xb50ec292
.long 0x35041c9e,0xb332b42a,0xb5195283,0xb58bffd6,0x34326f4c,0xb4f2c494,0xb5878e00,0xb5c0404a
.long 0xb4326f4c,0xb56052cd,0xb5b6c63b,0xb5de06c5,0xb5041c9e,0xb59ce8a6,0xb5d640eb,0xb5e1d820
.long 0xb55689b3,0xb5c0404a,0xb5e3480d,0xb5cb4216,0xb5905c16,0xb5d81207,0xb5dcbc6b,0xb59ce8a6
.long 0xb5afe71f,0xb5e2f061,0xb5c32e50,0xb5386e09,0xb5c8afa3,0xb5e03495,0xb598d125,0xb405eb92
.long 0xb5d9c1d1,0xb5d00894,0xb54295c7,0x34f2c494,0xb5e275b6,0xb5b36482,0xb4858eae,0x35830742
.long 0x35e275b6,0x35e1d820,0x35e117b5,0x35e03495,0x35d9c1d1,0x35d44ec5,0x35cdb531,0x35c5fe3e
.long 0x35c8afa3,0x35ba0bc4,0x35a89b88,0x3594a213,0x35afe71f,0x3594a213,0x3569f950,0x3523cad0
.long 0x35905c16,0x354c9f84,0x34dd2a7c,0x3332b42a,0x355689b3,0x34c76e4a,0xb3b2a663,0xb50ec292
.long 0x35041c9e,0xb332b42a,0xb5195283,0xb58bffd6,0x34326f4c,0xb4f2c494,0xb5878e00,0xb5c0404a
.long 0xb4326f4c,0xb56052cd,0xb5b6c63b,0xb5de06c5,0xb5041c9e,0xb59ce8a6,0xb5d640eb,0xb5e1d820
.long 0xb55689b3,0xb5c0404a,0xb5e3480d,0xb5cb4216,0xb5905c16,0xb5d81207,0xb5dcbc6b,0xb59ce8a6
.long 0xb5afe71f,0xb5e2f061,0xb5c32e50,0xb5386e09,0xb5c8afa3,0xb5e03495,0xb598d125,0xb405eb92
.long 0xb5d9c1d1,0xb5d00894,0xb54295c7,0x34f2c494,0xb5e275b6,0xb5b36482,0xb4858eae,0x35830742
.long 0x0,0xb332b42a,0xb3b2a663,0xb405eb92,0x0,0xb405eb92,0xb4858eae,0xb4c76e4a
.long 0x0,0xb45ed782,0xb4dd2a7c,0xb523cad0,0x0,0xb49b9d02,0xb5195283,0xb56052cd
.long 0x0,0xb4c76e4a,0xb54295c7,0xb58bffd6,0x0,0xb4f2c494,0xb569f950,0xb5a4ce73
.long 0x0,0xb50ec292,0xb5878e00,0xb5ba0bc4,0x0,0xb523cad0,0xb598d125,0xb5cb4216
.long 0x0,0xb5386e09,0xb5a89b88,0xb5d81207,0x0,0xb54c9f84,0xb5b6c63b,0xb5e03495
.long 0x0,0xb56052cd,0xb5c32e50,0xb5e37cad,0x0,0xb5737bbe,0xb5cdb531,0xb5e1d820
.long 0x0,0xb5830742,0xb5d640eb,0xb5db5006,0x0,0xb58bffd6,0xb5dcbc6b,0xb5d00894
.long 0x0,0xb594a213,0xb5e117b5,0xb5c0404a,0x0,0xb59ce8a6,0xb5e3480d,0xb5ac4e9d
.long 0x0,0xb332b42a,0xb3b2a663,0xb405eb92,0x0,0xb405eb92,0xb4858eae,0xb4c76e4a
.long 0x0,0xb45ed782,0xb4dd2a7c,0xb523cad0,0x0,0xb49b9d02,0xb5195283,0xb56052cd
.long 0x0,0xb4c76e4a,0xb54295c7,0xb58bffd6,0x0,0xb4f2c494,0xb569f950,0xb5a4ce73
.long 0x0,0xb50ec292,0xb5878e00,0xb5ba0bc4,0x0,0xb523cad0,0xb598d125,0xb5cb4216
.long 0x0,0xb5386e09,0xb5a89b88,0xb5d81207,0x0,0xb54c9f84,0xb5b6c63b,0xb5e03495
.long 0x0,0xb56052cd,0xb5c32e50,0xb5e37cad,0x0,0xb5737bbe,0xb5cdb531,0xb5e1d820
.long 0x0,0xb5830742,0xb5d640eb,0xb5db5006,0x0,0xb58bffd6,0xb5dcbc6b,0xb5d00894
.long 0x0,0xb594a213,0xb5e117b5,0xb5c0404a,0x0,0xb59ce8a6,0xb5e3480d,0xb5ac4e9d
.long 0xb4326f4c,0xb45ed782,0xb4858eae,0xb49b9d02,0xb5041c9e,0xb523cad0,0xb54295c7,0xb56052cd
.long 0xb55689b3,0xb5830742,0xb598d125,0xb5ac4e9d,0xb5905c16,0xb5ac4e9d,0xb5c32e50,0xb5d44ec5
.long 0xb5afe71f,0xb5cb4216,0xb5dcbc6b,0xb5e37cad,0xb5c8afa3,0xb5de06c5,0xb5e3480d,0xb5d81207
.long 0xb5d9c1d1,0xb5e37cad,0xb5d640eb,0xb5b36482,0xb5e275b6,0xb5db5006,0xb5b6c63b,0xb5737bbe
.long 0xb5e275b6,0xb5c5fe3e,0xb5878e00,0xb4c76e4a,0xb5d9c1d1,0xb5a4ce73,0xb5195283,0x345ed782
.long 0xb5c8afa3,0xb5737bbe,0xb3b2a663,0x354c9f84,0xb5afe71f,0xb50ec292,0x34dd2a7c,0x35a4ce73
.long 0xb5905c16,0xb405eb92,0x3569f950,0x35d00894,0xb55689b3,0x349b9d02,0x35a89b88,0x35e2f061
.long 0xb5041c9e,0x35386e09,0x35cdb531,0x35db5006,0xb4326f4c,0x358bffd6,0x35e117b5,0x35ba0bc4
.long 0xb4326f4c,0xb45ed782,0xb4858eae,0xb49b9d02,0xb5041c9e,0xb523cad0,0xb54295c7,0xb56052cd
.long 0xb55689b3,0xb5830742,0xb598d125,0xb5ac4e9d,0xb5905c16,0xb5ac4e9d,0xb5c32e50,0xb5d44ec5
.long 0xb5afe71f,0xb5cb4216,0xb5dcbc6b,0xb5e37cad,0xb5c8afa3,0xb5de06c5,0xb5e3480d,0xb5d81207
.long 0xb5d9c1d1,0xb5e37cad,0xb5d640eb,0xb5b36482,0xb5e275b6,0xb5db5006,0xb5b6c63b,0xb5737bbe
.long 0xb5e275b6,0xb5c5fe3e,0xb5878e00,0xb4c76e4a,0xb5d9c1d1,0xb5a4ce73,0xb5195283,0x345ed782
.long 0xb5c8afa3,0xb5737bbe,0xb3b2a663,0x354c9f84,0xb5afe71f,0xb50ec292,0x34dd2a7c,0x35a4ce73
.long 0xb5905c16,0xb405eb92,0x3569f950,0x35d00894,0xb55689b3,0x349b9d02,0x35a89b88,0x35e2f061
.long 0xb5041c9e,0x35386e09,0x35cdb531,0x35db5006,0xb4326f4c,0x358bffd6,0x35e117b5,0x35ba0bc4
.long 0x3f800000,0x3f800000,0x3f800000,0x3f800000,0x3f7fec43,0x3f7f4e6d,0x3f7e1324,0x3f7c3b28
.long 0x3f7fb10f,0x3f7d3aac,0x3f7853f8,0x3f710908,0x3f7f4e6d,0x3f79c79d,0x3f6ed89e,0x3f5ebe05
.long 0x3f800000,0x3f800000,0x3f800000,0x3f800000,0x3f7fec43,0x3f7f4e6d,0x3f7e1324,0x3f7c3b28
.long 0x3f7fb10f,0x3f7d3aac,0x3f7853f8,0x3f710908,0x3f7f4e6d,0x3f79c79d,0x3f6ed89e,0x3f5ebe05
.long 0x3f7ec46d,0x3f74fa0b,0x3f61c598,0x3f45e403,0x3f7e1324,0x3f6ed89e,0x3f514d3d,0x3f273656
.long 0x3f7d3aac,0x3f676bd8,0x3f3daef9,0x3f039c3d,0x3f7c3b28,0x3f5ebe05,0x3f273656,0x3eb8442a
.long 0x3f7ec46d,0x3f74fa0b,0x3f61c598,0x3f45e403,0x3f7e1324,0x3f6ed89e,0x3f514d3d,0x3f273656
.long 0x3f7d3aac,0x3f676bd8,0x3f3daef9,0x3f039c3d,0x3f7c3b28,0x3f5ebe05,0x3f273656,0x3eb8442a
.long 0x3f800000,0x3f800000,0x3f800000,0x3f800000,0x3f79c79d,0x3f76ba07,0x3f731447,0x3f6ed89e
.long 0x3f676bd8,0x3f5b941a,0x3f4d9f02,0x3f3daef9,0x3f49d112,0x3f3085bb,0x3f13682a,0x3ee63375
.long 0x3f800000,0x3f800000,0x3f800000,0x3f800000,0x3f79c79d,0x3f76ba07,0x3f731447,0x3f6ed89e
.long 0x3f676bd8,0x3f5b941a,0x3f4d9f02,0x3f3daef9,0x3f49d112,0x3f3085bb,0x3f13682a,0x3ee63375
.long 0x3f226799,0x3ef15aea,0x3e94a031,0x3dc8bd36,0x3ee63375,0x3e605c13,0xbcc90ab0,0xbe888e93
.long 0x3e78cfcc,0xbd48fb30,0xbeac7cd4,0xbf187fc0,0x3cc90ab0,0xbea09ae5,0xbf1d7fd1,0xbf584853
.long 0x3f226799,0x3ef15aea,0x3e94a031,0x3dc8bd36,0x3ee63375,0x3e605c13,0xbcc90ab0,0xbe888e93
.long 0x3e78cfcc,0xbd48fb30,0xbeac7cd4,0xbf187fc0,0x3cc90ab0,0xbea09ae5,0xbf1d7fd1,0xbf584853
.long 0x3f800000,0x3f800000,0x3f800000,0x3f800000,0x3f6a09a7,0x3f64aa59,0x3f5ebe05,0x3f584853
.long 0x3f2beb4a,0x3f187fc0,0x3f039c3d,0x3edae880,0x3ea09ae5,0x3e2f10a2,0x3cc90ab0,0xbdfab273
.long 0x3f800000,0x3f800000,0x3f800000,0x3f800000,0x3f6a09a7,0x3f64aa59,0x3f5ebe05,0x3f584853
.long 0x3f2beb4a,0x3f187fc0,0x3f039c3d,0x3edae880,0x3ea09ae5,0x3e2f10a2,0x3cc90ab0,0xbdfab273
.long 0xbdc8bd36,0xbe94a031,0xbef15aea,0xbf226799,0xbefc5d27,0xbf3085bb,0xbf584853,0xbf731447
.long 0xbf4d9f02,0xbf710908,0xbf7fb10f,0xbf7853f8,0xbf79c79d,0xbf7e1324,0xbf64aa59,0xbf3085bb
.long 0xbdc8bd36,0xbe94a031,0xbef15aea,0xbf226799,0xbefc5d27,0xbf3085bb,0xbf584853,0xbf731447
.long 0xbf4d9f02,0xbf710908,0xbf7fb10f,0xbf7853f8,0xbf79c79d,0xbf7e1324,0xbf64aa59,0xbf3085bb
.long 0x3f800000,0x3f800000,0x3f800000,0x3f800000,0x3f514d3d,0x3f49d112,0x3f41d870,0x3f396842
.long 0x3eac7cd4,0x3e78cfcc,0x3e164083,0x3d48fb30,0xbe888e93,0xbecf7bca,0xbf08f59b,0xbf273656
.long 0x3f800000,0x3f800000,0x3f800000,0x3f800000,0x3f514d3d,0x3f49d112,0x3f41d870,0x3f396842
.long 0x3eac7cd4,0x3e78cfcc,0x3e164083,0x3d48fb30,0xbe888e93,0xbecf7bca,0xbf08f59b,0xbf273656
.long 0xbf45e403,0xbf61c598,0xbf74fa0b,0xbf7ec46d,0xbf7f4e6d,0xbf7c3b28,0xbf6a09a7,0xbf49d112
.long 0xbf5b941a,0xbf2beb4a,0xbedae880,0xbe164083,0xbecf7bca,0xbd96a905,0x3e888e93,0x3f13682a
.long 0xbf45e403,0xbf61c598,0xbf74fa0b,0xbf7ec46d,0xbf7f4e6d,0xbf7c3b28,0xbf6a09a7,0xbf49d112
.long 0xbf5b941a,0xbf2beb4a,0xbedae880,0xbe164083,0xbecf7bca,0xbd96a905,0x3e888e93,0x3f13682a
.long 0x0,0x0,0x0,0x0,0xbcc90ab0,0xbd96a905,0xbdfab273,0xbe2f10a2
.long 0xbd48fb30,0xbe164083,0xbe78cfcc,0xbeac7cd4,0xbd96a905,0xbe605c13,0xbeb8442a,0xbefc5d27
.long 0x0,0x0,0x0,0x0,0xbcc90ab0,0xbd96a905,0xbdfab273,0xbe2f10a2
.long 0xbd48fb30,0xbe164083,0xbe78cfcc,0xbeac7cd4,0xbd96a905,0xbe605c13,0xbeb8442a,0xbefc5d27
.long 0xbdc8bd36,0xbe94a031,0xbef15aea,0xbf226799,0xbdfab273,0xbeb8442a,0xbf13682a,0xbf41d870
.long 0xbe164083,0xbedae880,0xbf2beb4a,0xbf5b941a,0xbe2f10a2,0xbefc5d27,0xbf41d870,0xbf6ed89e
.long 0xbdc8bd36,0xbe94a031,0xbef15aea,0xbf226799,0xbdfab273,0xbeb8442a,0xbf13682a,0xbf41d870
.long 0xbe164083,0xbedae880,0xbf2beb4a,0xbf5b941a,0xbe2f10a2,0xbefc5d27,0xbf41d870,0xbf6ed89e
.long 0x0,0x0,0x0,0x0,0xbe605c13,0xbe888e93,0xbea09ae5,0xbeb8442a
.long 0xbedae880,0xbf039c3d,0xbf187fc0,0xbf2beb4a,0xbf1d7fd1,0xbf396842,0xbf514d3d,0xbf64aa59
.long 0x0,0x0,0x0,0x0,0xbe605c13,0xbe888e93,0xbea09ae5,0xbeb8442a
.long 0xbedae880,0xbf039c3d,0xbf187fc0,0xbf2beb4a,0xbf1d7fd1,0xbf396842,0xbf514d3d,0xbf64aa59
.long 0xbf45e403,0xbf61c598,0xbf74fa0b,0xbf7ec46d,0xbf64aa59,0xbf79c79d,0xbf7fec43,0xbf76ba07
.long 0xbf7853f8,0xbf7fb10f,0xbf710908,0xbf4d9f02,0xbf7fec43,0xbf731447,0xbf49d112,0xbf08f59b
.long 0xbf45e403,0xbf61c598,0xbf74fa0b,0xbf7ec46d,0xbf64aa59,0xbf79c79d,0xbf7fec43,0xbf76ba07
.long 0xbf7853f8,0xbf7fb10f,0xbf710908,0xbf4d9f02,0xbf7fec43,0xbf731447,0xbf49d112,0xbf08f59b
.long 0x0,0x0,0x0,0x0,0xbecf7bca,0xbee63375,0xbefc5d27,0xbf08f59b
.long 0xbf3daef9,0xbf4d9f02,0xbf5b941a,0xbf676bd8,0xbf731447,0xbf7c3b28,0xbf7fec43,0xbf7e1324
.long 0x0,0x0,0x0,0x0,0xbecf7bca,0xbee63375,0xbefc5d27,0xbf08f59b
.long 0xbf3daef9,0xbf4d9f02,0xbf5b941a,0xbf676bd8,0xbf731447,0xbf7c3b28,0xbf7fec43,0xbf7e1324
.long 0xbf7ec46d,0xbf74fa0b,0xbf61c598,0xbf45e403,0xbf5ebe05,0xbf396842,0xbf08f59b,0xbea09ae5
.long 0xbf187fc0,0xbeac7cd4,0xbd48fb30,0x3e78cfcc,0xbe605c13,0x3dfab273,0x3ee63375,0x3f396842
.long 0xbf7ec46d,0xbf74fa0b,0xbf61c598,0xbf45e403,0xbf5ebe05,0xbf396842,0xbf08f59b,0xbea09ae5
.long 0xbf187fc0,0xbeac7cd4,0xbd48fb30,0x3e78cfcc,0xbe605c13,0x3dfab273,0x3ee63375,0x3f396842
.long 0x0,0x0,0x0,0x0,0xbf13682a,0xbf1d7fd1,0xbf273656,0xbf3085bb
.long 0xbf710908,0xbf7853f8,0xbf7d3aac,0xbf7fb10f,0xbf76ba07,0xbf6a09a7,0xbf584853,0xbf41d870
.long 0x0,0x0,0x0,0x0,0xbf13682a,0xbf1d7fd1,0xbf273656,0xbf3085bb
.long 0xbf710908,0xbf7853f8,0xbf7d3aac,0xbf7fb10f,0xbf76ba07,0xbf6a09a7,0xbf584853,0xbf41d870
.long 0xbf226799,0xbef15aea,0xbe94a031,0xbdc8bd36,0xbd96a905,0x3e2f10a2,0x3ecf7bca,0x3f1d7fd1
.long 0x3f039c3d,0x3f3daef9,0x3f676bd8,0x3f7d3aac,0x3f6a09a7,0x3f7f4e6d,0x3f76ba07,0x3f514d3d
.long 0xbf226799,0xbef15aea,0xbe94a031,0xbdc8bd36,0xbd96a905,0x3e2f10a2,0x3ecf7bca,0x3f1d7fd1
.long 0x3f039c3d,0x3f3daef9,0x3f676bd8,0x3f7d3aac,0x3f6a09a7,0x3f7f4e6d,0x3f76ba07,0x3f514d3d
.long 0x3f80,0x3f80,0x3f80,0x3f80,0x3e483f7b,0x3f0e3f55,0x3f553f0e,0x3f7b3e48
.long 0x3ec43f6d,0x3f6d3ec4,0x3f6dbec4,0x3ec4bf6d,0x3f0e3f55,0x3f7bbe48,0x3e48bf7b,0xbf55bf0e
.long 0x3f353f35,0x3f35bf35,0xbf35bf35,0xbf353f35,0x3f553f0e,0x3e48bf7b,0xbf7b3e48,0x3f0e3f55
.long 0x3f6d3ec4,0xbec4bf6d,0xbec43f6d,0x3f6dbec4,0x3f7b3e48,0xbf55bf0e,0x3f0e3f55,0xbe48bf7b
.long 0x3f800000,0xbf800000,0x3f800000,0xbf800000,0x3f7bbe48,0xbf553f0e,0x3f0ebf55,0xbe483f7b
.long 0x3f6dbec4,0xbec43f6d,0xbec4bf6d,0x3f6d3ec4,0x3f55bf0e,0x3e483f7b,0xbf7bbe48,0x3f0ebf55
.long 0x3f35bf35,0x3f353f35,0xbf353f35,0xbf35bf35,0x3f0ebf55,0x3f7b3e48,0x3e483f7b,0xbf553f0e
.long 0x3ec4bf6d,0x3f6dbec4,0x3f6d3ec4,0x3ec43f6d,0x3e48bf7b,0x3f0ebf55,0x3f55bf0e,0x3f7bbe48
.long 0x3f80,0x3f80,0x3f80,0x3f80,0x3f7bbe48,0x3f55bf0e,0x3f0ebf55,0x3e48bf7b
.long 0xbec4bf6d,0xbf6dbec4,0xbf6d3ec4,0xbec43f6d,0xbf553f0e,0x3e483f7b,0x3f7b3e48,0x3f0ebf55
.long 0x3f353f35,0x3f35bf35,0xbf35bf35,0xbf353f35,0x3f0ebf55,0xbf7bbe48,0x3e483f7b,0x3f55bf0e
.long 0xbf6dbec4,0x3ec43f6d,0x3ec4bf6d,0xbf6d3ec4,0xbe483f7b,0x3f0ebf55,0xbf553f0e,0x3f7bbe48
.long 0x3f800000,0xbf800000,0x3f800000,0xbf800000,0xbe48bf7b,0x3f0e3f55,0xbf55bf0e,0x3f7b3e48
.long 0xbf6d3ec4,0x3ec4bf6d,0x3ec43f6d,0xbf6dbec4,0x3f0e3f55,0xbf7b3e48,0x3e48bf7b,0x3f553f0e
.long 0x3f35bf35,0x3f353f35,0xbf353f35,0xbf35bf35,0xbf55bf0e,0x3e48bf7b,0x3f7bbe48,0x3f0e3f55
.long 0xbec43f6d,0xbf6d3ec4,0xbf6dbec4,0xbec4bf6d,0x3f7b3e48,0x3f553f0e,0x3f0e3f55,0x3e483f7b
.long 0x3f80,0x3f80,0x3f80,0x3f80,0xbe48bf7b,0xbf0ebf55,0xbf55bf0e,0xbf7bbe48
.long 0x3ec43f6d,0x3f6d3ec4,0x3f6dbec4,0x3ec4bf6d,0xbf0ebf55,0xbf7b3e48,0xbe483f7b,0x3f553f0e
.long 0x3f353f35,0x3f35bf35,0xbf35bf35,0xbf353f35,0xbf55bf0e,0xbe483f7b,0x3f7bbe48,0xbf0ebf55
.long 0x3f6d3ec4,0xbec4bf6d,0xbec43f6d,0x3f6dbec4,0xbf7bbe48,0x3f553f0e,0xbf0ebf55,0x3e483f7b
.long 0x3f800000,0xbf800000,0x3f800000,0xbf800000,0xbf7b3e48,0x3f55bf0e,0xbf0e3f55,0x3e48bf7b
.long 0x3f6dbec4,0xbec43f6d,0xbec4bf6d,0x3f6d3ec4,0xbf553f0e,0xbe48bf7b,0x3f7b3e48,0xbf0e3f55
.long 0x3f35bf35,0x3f353f35,0xbf353f35,0xbf35bf35,0xbf0e3f55,0xbf7bbe48,0xbe48bf7b,0x3f55bf0e
.long 0x3ec4bf6d,0x3f6dbec4,0x3f6d3ec4,0x3ec43f6d,0xbe483f7b,0xbf0e3f55,0xbf553f0e,0xbf7b3e48
.long 0x3f80,0x3f80,0x3f80,0x3f80,0xbf7b3e48,0xbf553f0e,0xbf0e3f55,0xbe483f7b
.long 0xbec4bf6d,0xbf6dbec4,0xbf6d3ec4,0xbec43f6d,0x3f55bf0e,0xbe48bf7b,0xbf7bbe48,0xbf0e3f55
.long 0x3f353f35,0x3f35bf35,0xbf35bf35,0xbf353f35,0xbf0e3f55,0x3f7b3e48,0xbe48bf7b,0xbf553f0e
.long 0xbf6dbec4,0x3ec43f6d,0x3ec4bf6d,0xbf6d3ec4,0x3e48bf7b,0xbf0e3f55,0x3f55bf0e,0xbf7b3e48
.long 0x3f800000,0xbf800000,0x3f800000,0xbf800000,0x3e483f7b,0xbf0ebf55,0x3f553f0e,0xbf7bbe48
.long 0xbf6d3ec4,0x3ec4bf6d,0x3ec43f6d,0xbf6dbec4,0xbf0ebf55,0x3f7bbe48,0xbe483f7b,0xbf55bf0e
.long 0x3f35bf35,0x3f353f35,0xbf353f35,0xbf35bf35,0x3f553f0e,0xbe483f7b,0xbf7b3e48,0xbf0ebf55
.long 0xbec43f6d,0xbf6d3ec4,0xbf6dbec4,0xbec4bf6d,0xbf7bbe48,0xbf55bf0e,0xbf0ebf55,0xbe48bf7b
.long 0x3f808000,0x3f808000,0x3f808000,0x3f808000,0x3f7bbe48,0x3f55bf0e,0x3f0ebf55,0x3e48bf7b
.long 0x3f6dbec4,0x3ec4bf6d,0xbec4bf6d,0xbf6dbec4,0x3f55bf0e,0xbe48bf7b,0xbf7bbe48,0xbf0e3f55
.long 0x3f35bf35,0xbf35bf35,0xbf353f35,0x3f353f35,0x3f0ebf55,0xbf7bbe48,0x3e483f7b,0x3f55bf0e
.long 0x3ec4bf6d,0xbf6d3ec4,0x3f6d3ec4,0xbec4bf6d,0x3e48bf7b,0xbf0e3f55,0x3f55bf0e,0xbf7b3e48
.long 0xbf80,0x3f80,0xbf80,0x3f80,0xbe48bf7b,0x3f0e3f55,0xbf55bf0e,0x3f7b3e48
.long 0xbec4bf6d,0x3f6d3ec4,0xbf6d3ec4,0x3ec4bf6d,0xbf0ebf55,0x3f7bbe48,0xbe483f7b,0xbf55bf0e
.long 0xbf35bf35,0x3f35bf35,0x3f353f35,0xbf353f35,0xbf55bf0e,0x3e48bf7b,0x3f7bbe48,0x3f0e3f55
.long 0xbf6dbec4,0xbec4bf6d,0x3ec4bf6d,0x3f6dbec4,0xbf7bbe48,0xbf55bf0e,0xbf0ebf55,0xbe48bf7b
.long 0x3f808000,0x3f808000,0x3f808000,0x3f808000,0xbe48bf7b,0xbf0ebf55,0xbf55bf0e,0xbf7bbe48
.long 0xbf6d3ec4,0xbec43f6d,0x3ec43f6d,0x3f6d3ec4,0x3f0e3f55,0x3f7bbe48,0x3e48bf7b,0xbf55bf0e
.long 0x3f35bf35,0xbf35bf35,0xbf353f35,0x3f353f35,0xbf55bf0e,0xbe483f7b,0x3f7bbe48,0xbf0ebf55
.long 0xbec43f6d,0x3f6dbec4,0xbf6dbec4,0x3ec43f6d,0x3f7b3e48,0xbf55bf0e,0x3f0e3f55,0xbe48bf7b
.long 0xbf80,0x3f80,0xbf80,0x3f80,0xbf7b3e48,0x3f55bf0e,0xbf0e3f55,0x3e48bf7b
.long 0x3ec43f6d,0xbf6dbec4,0x3f6dbec4,0xbec43f6d,0x3f55bf0e,0x3e483f7b,0xbf7bbe48,0x3f0ebf55
.long 0xbf35bf35,0x3f35bf35,0x3f353f35,0xbf353f35,0xbf0e3f55,0xbf7bbe48,0xbe48bf7b,0x3f55bf0e
.long 0x3f6d3ec4,0x3ec43f6d,0xbec43f6d,0xbf6d3ec4,0x3e48bf7b,0x3f0ebf55,0x3f55bf0e,0x3f7bbe48
.long 0x3f808000,0x3f808000,0x3f808000,0x3f808000,0xbf7b3e48,0xbf553f0e,0xbf0e3f55,0xbe483f7b
.long 0x3f6dbec4,0x3ec4bf6d,0xbec4bf6d,0xbf6dbec4,0xbf553f0e,0x3e483f7b,0x3f7b3e48,0x3f0ebf55
.long 0x3f35bf35,0xbf35bf35,0xbf353f35,0x3f353f35,0xbf0e3f55,0x3f7b3e48,0xbe48bf7b,0xbf553f0e
.long 0x3ec4bf6d,0xbf6d3ec4,0x3f6d3ec4,0xbec4bf6d,0xbe483f7b,0x3f0ebf55,0xbf553f0e,0x3f7bbe48
.long 0xbf80,0x3f80,0xbf80,0x3f80,0x3e483f7b,0xbf0ebf55,0x3f553f0e,0xbf7bbe48
.long 0xbec4bf6d,0x3f6d3ec4,0xbf6d3ec4,0x3ec4bf6d,0x3f0e3f55,0xbf7b3e48,0x3e48bf7b,0x3f553f0e
.long 0xbf35bf35,0x3f35bf35,0x3f353f35,0xbf353f35,0x3f553f0e,0xbe483f7b,0xbf7b3e48,0xbf0ebf55
.long 0xbf6dbec4,0xbec4bf6d,0x3ec4bf6d,0x3f6dbec4,0x3f7b3e48,0x3f553f0e,0x3f0e3f55,0x3e483f7b
.long 0x3f808000,0x3f808000,0x3f808000,0x3f808000,0x3e483f7b,0x3f0e3f55,0x3f553f0e,0x3f7b3e48
.long 0xbf6d3ec4,0xbec43f6d,0x3ec43f6d,0x3f6d3ec4,0xbf0ebf55,0xbf7b3e48,0xbe483f7b,0x3f553f0e
.long 0x3f35bf35,0xbf35bf35,0xbf353f35,0x3f353f35,0x3f553f0e,0x3e48bf7b,0xbf7b3e48,0x3f0e3f55
.long 0xbec43f6d,0x3f6dbec4,0xbf6dbec4,0x3ec43f6d,0xbf7bbe48,0x3f553f0e,0xbf0ebf55,0x3e483f7b
.long 0xbf80,0x3f80,0xbf80,0x3f80,0x3f7bbe48,0xbf553f0e,0x3f0ebf55,0xbe483f7b
.long 0x3ec43f6d,0xbf6dbec4,0x3f6dbec4,0xbec43f6d,0xbf553f0e,0xbe48bf7b,0x3f7b3e48,0xbf0e3f55
.long 0xbf35bf35,0x3f35bf35,0x3f353f35,0xbf353f35,0x3f0ebf55,0x3f7b3e48,0x3e483f7b,0xbf553f0e
.long 0x3f6d3ec4,0x3ec43f6d,0xbec43f6d,0xbf6d3ec4,0xbe483f7b,0xbf0e3f55,0xbf553f0e,0xbf7b3e48
.long 0x80008000,0x80008000,0x80008000,0x80008000,0xbe858000,0xbf35bf00,0xbf77bf5e,0xbf77bf80
.long 0xbf008000,0xbf80bf5e,0xbf00bf5e,0x3f008000,0xbf358000,0xbf35bf80,0x3f358000,0x3f353f80
.long 0x80008000,0x80008000,0x80008000,0x80008000,0x3e858000,0x3f35bf00,0x3f77bf5e,0x3f77bf80
.long 0x3f008000,0x3f80bf5e,0x3f00bf5e,0xbf008000,0x3f358000,0x3f35bf80,0xbf358000,0xbf353f80
.long 0xbf5e8000,0x8000bf5e,0x3f5e3f5e,0xbf5e8000,0xbf778000,0x3f35bf00,0xbe853f5e,0xbe85bf80
.long 0xbf808000,0x3f808000,0xbf808000,0x3f808000,0xbf778000,0x3f353f00,0xbe85bf5e,0xbe853f80
.long 0x3f5e8000,0x8000bf5e,0xbf5e3f5e,0x3f5e8000,0x3f778000,0xbf35bf00,0x3e853f5e,0x3e85bf80
.long 0x3f808000,0xbf808000,0x3f808000,0xbf808000,0x3f778000,0xbf353f00,0x3e85bf5e,0x3e853f80
.long 0xbf5e8000,0x80003f5e,0x3f5ebf5e,0xbf5e8000,0xbf358000,0xbf353f80,0x3f358000,0x3f35bf80
.long 0xbf008000,0xbf803f5e,0xbf003f5e,0x3f008000,0xbe858000,0xbf353f00,0xbf773f5e,0xbf773f80
.long 0x3f5e8000,0x80003f5e,0xbf5ebf5e,0x3f5e8000,0x3f358000,0x3f353f80,0xbf358000,0xbf35bf80
.long 0x3f008000,0x3f803f5e,0x3f003f5e,0xbf008000,0x3e858000,0x3f353f00,0x3f773f5e,0x3f773f80
.long 0x80008000,0x80008000,0x80008000,0x80008000,0x3e858000,0x3f35bf00,0x3f77bf5e,0x3f77bf80
.long 0x3f008000,0x3f80bf5e,0x3f00bf5e,0xbf008000,0x3f358000,0x3f35bf80,0xbf358000,0xbf353f80
.long 0x80008000,0x80008000,0x80008000,0x80008000,0xbe858000,0xbf35bf00,0xbf77bf5e,0xbf77bf80
.long 0xbf008000,0xbf80bf5e,0xbf00bf5e,0x3f008000,0xbf358000,0xbf35bf80,0x3f358000,0x3f353f80
.long 0x80008000,0x80008000,0x80008000,0x80008000,0x3e858000,0x3f353f00,0x3f773f5e,0x3f773f80
.long 0xbf008000,0xbf80bf5e,0xbf00bf5e,0x3f008000,0x3f358000,0x3f353f80,0xbf358000,0xbf35bf80
.long 0x80008000,0x80008000,0x80008000,0x80008000,0xbe858000,0xbf353f00,0xbf773f5e,0xbf773f80
.long 0x3f008000,0x3f80bf5e,0x3f00bf5e,0xbf008000,0xbf358000,0xbf353f80,0x3f358000,0x3f35bf80
.long 0xbf5e8000,0x8000bf5e,0x3f5e3f5e,0xbf5e8000,0x3f778000,0xbf353f00,0x3e85bf5e,0x3e853f80
.long 0xbf808000,0x3f808000,0xbf808000,0x3f808000,0x3f778000,0xbf35bf00,0x3e853f5e,0x3e85bf80
.long 0x3f5e8000,0x8000bf5e,0xbf5e3f5e,0x3f5e8000,0xbf778000,0x3f353f00,0xbe85bf5e,0xbe853f80
.long 0x3f808000,0xbf808000,0x3f808000,0xbf808000,0xbf778000,0x3f35bf00,0xbe853f5e,0xbe85bf80
.long 0xbf5e8000,0x80003f5e,0x3f5ebf5e,0xbf5e8000,0x3f358000,0x3f35bf80,0xbf358000,0xbf353f80
.long 0xbf008000,0xbf803f5e,0xbf003f5e,0x3f008000,0x3e858000,0x3f35bf00,0x3f77bf5e,0x3f77bf80
.long 0x3f5e8000,0x80003f5e,0xbf5ebf5e,0x3f5e8000,0xbf358000,0xbf35bf80,0x3f358000,0x3f353f80
.long 0x3f008000,0x3f803f5e,0x3f003f5e,0xbf008000,0xbe858000,0xbf35bf00,0xbf77bf5e,0xbf77bf80
.long 0x80008000,0x80008000,0x80008000,0x80008000,0xbe858000,0xbf353f00,0xbf773f5e,0xbf773f80
.long 0x3f008000,0x3f80bf5e,0x3f00bf5e,0xbf008000,0xbf358000,0xbf353f80,0x3f358000,0x3f35bf80
.long 0x80008000,0x80008000,0x80008000,0x80008000,0x3e858000,0x3f353f00,0x3f773f5e,0x3f773f80
.long 0xbf008000,0xbf80bf5e,0xbf00bf5e,0x3f008000,0x3f358000,0x3f353f80,0xbf358000,0xbf35bf80
.long 0x80008000,0x80008000,0x3f803f80,0x3f803f80,0xbf35bf5e,0xbe85bf00,0x3f773f80,0x3f353f5e
.long 0x3f803f5e,0x3f003f5e,0x3f5e3f80,0x3f00,0xbf358000,0xbf35bf80,0x3f353f80,0xbf350000
.long 0x80008000,0x80008000,0xbf803f80,0xbf803f80,0x3f35bf5e,0x3e85bf00,0xbf773f80,0xbf353f5e
.long 0xbf803f5e,0xbf003f5e,0xbf5e3f80,0x3f00,0x3f358000,0x3f35bf80,0xbf353f80,0x3f350000
.long 0x8000bf5e,0x3f5e3f5e,0x3f003f80,0xbf80bf00,0x3f353f5e,0xbf77bf00,0x3e853f80,0xbf35bf5e
.long 0xbf808000,0x3f808000,0x3f80,0xbf80,0x3f35bf5e,0xbf773f00,0xbe853f80,0x3f35bf5e
.long 0x8000bf5e,0xbf5e3f5e,0xbf003f80,0x3f80bf00,0xbf353f5e,0x3f77bf00,0xbe853f80,0x3f35bf5e
.long 0x3f808000,0xbf808000,0x3f80,0xbf80,0xbf35bf5e,0x3f773f00,0x3e853f80,0xbf35bf5e
.long 0x80003f5e,0x3f5ebf5e,0xbf003f80,0x3f80bf00,0xbf358000,0xbf353f80,0xbf353f80,0x3f350000
.long 0x3f80bf5e,0x3f00bf5e,0xbf5e3f80,0x3f00,0xbf353f5e,0xbe853f00,0xbf773f80,0xbf353f5e
.long 0x80003f5e,0xbf5ebf5e,0x3f003f80,0xbf80bf00,0x3f358000,0x3f353f80,0x3f353f80,0xbf350000
.long 0xbf80bf5e,0xbf00bf5e,0x3f5e3f80,0x3f00,0x3f353f5e,0x3e853f00,0x3f773f80,0x3f353f5e
.long 0x80008000,0x80008000,0xbf803f80,0xbf803f80,0x3f35bf5e,0x3e85bf00,0xbf773f80,0xbf353f5e
.long 0xbf803f5e,0xbf003f5e,0xbf5e3f80,0x3f00,0x3f358000,0x3f35bf80,0xbf353f80,0x3f350000
.long 0x80008000,0x80008000,0x3f803f80,0x3f803f80,0xbf35bf5e,0xbe85bf00,0x3f773f80,0x3f353f5e
.long 0x3f803f5e,0x3f003f5e,0x3f5e3f80,0x3f00,0xbf358000,0xbf35bf80,0x3f353f80,0xbf350000
.long 0x80008000,0x80008000,0x3f803f80,0x3f803f80,0x3f353f5e,0x3e853f00,0xbf77bf80,0xbf35bf5e
.long 0x3f803f5e,0x3f003f5e,0x3f5e3f80,0x3f00,0x3f358000,0x3f353f80,0xbf35bf80,0x3f350000
.long 0x80008000,0x80008000,0xbf803f80,0xbf803f80,0xbf353f5e,0xbe853f00,0x3f77bf80,0x3f35bf5e
.long 0xbf803f5e,0xbf003f5e,0xbf5e3f80,0x3f00,0xbf358000,0xbf353f80,0x3f35bf80,0xbf350000
.long 0x8000bf5e,0x3f5e3f5e,0x3f003f80,0xbf80bf00,0xbf35bf5e,0x3f773f00,0xbe85bf80,0x3f353f5e
.long 0xbf808000,0x3f808000,0x3f80,0xbf80,0xbf353f5e,0x3f77bf00,0x3e85bf80,0xbf353f5e
.long 0x8000bf5e,0xbf5e3f5e,0xbf003f80,0x3f80bf00,0x3f35bf5e,0xbf773f00,0x3e85bf80,0xbf353f5e
.long 0x3f808000,0xbf808000,0x3f80,0xbf80,0x3f353f5e,0xbf77bf00,0xbe85bf80,0x3f353f5e
.long 0x80003f5e,0x3f5ebf5e,0xbf003f80,0x3f80bf00,0x3f358000,0x3f35bf80,0x3f35bf80,0xbf350000
.long 0x3f80bf5e,0x3f00bf5e,0xbf5e3f80,0x3f00,0x3f35bf5e,0x3e85bf00,0x3f77bf80,0x3f35bf5e
.long 0x80003f5e,0xbf5ebf5e,0x3f003f80,0xbf80bf00,0xbf358000,0xbf35bf80,0xbf35bf80,0x3f350000
.long 0xbf80bf5e,0xbf00bf5e,0x3f5e3f80,0x3f00,0xbf35bf5e,0xbe85bf00,0xbf77bf80,0xbf35bf5e
.long 0x80008000,0x80008000,0xbf803f80,0xbf803f80,0xbf353f5e,0xbe853f00,0x3f77bf80,0x3f35bf5e
.long 0xbf803f5e,0xbf003f5e,0xbf5e3f80,0x3f00,0xbf358000,0xbf353f80,0x3f35bf80,0xbf350000
.long 0x80008000,0x80008000,0x3f803f80,0x3f803f80,0x3f353f5e,0x3e853f00,0xbf77bf80,0xbf35bf5e
.long 0x3f803f5e,0x3f003f5e,0x3f5e3f80,0x3f00,0x3f358000,0x3f353f80,0xbf35bf80,0x3f350000
.long 0x3f803f80,0x3f803f80,0x3f803f80,0x3f803f80,0x3e853f00,0xbe850000,0xbf35bf00,0xbf77bf5e
.long 0xbf5ebf00,0xbf5ebf80,0xbf00,0x3f5e3f00,0xbf35bf80,0x3f350000,0x3f353f80,0xbf350000
.long 0xbf803f80,0xbf803f80,0xbf803f80,0xbf803f80,0xbe853f00,0x3e850000,0x3f35bf00,0x3f77bf5e
.long 0x3f5ebf00,0x3f5ebf80,0xbf00,0xbf5e3f00,0x3f35bf80,0xbf350000,0xbf353f80,0x3f350000
.long 0x3f00bf00,0x3f003f80,0xbf80bf00,0x3f00bf00,0x3f773f00,0xbf770000,0x3f35bf00,0xbe853f5e
.long 0x3f80,0xbf80,0x3f80,0xbf80,0xbf773f00,0x3f770000,0xbf35bf00,0x3e853f5e
.long 0xbf00bf00,0xbf003f80,0x3f80bf00,0xbf00bf00,0xbf773f00,0x3f770000,0xbf35bf00,0x3e853f5e
.long 0x3f80,0xbf80,0x3f80,0xbf80,0x3f773f00,0xbf770000,0x3f35bf00,0xbe853f5e
.long 0xbf00bf00,0xbf003f80,0x3f80bf00,0xbf00bf00,0x3f35bf80,0xbf350000,0xbf353f80,0x3f350000
.long 0x3f5ebf00,0x3f5ebf80,0xbf00,0xbf5e3f00,0xbe853f00,0x3e850000,0x3f35bf00,0x3f77bf5e
.long 0x3f00bf00,0x3f003f80,0xbf80bf00,0x3f00bf00,0xbf35bf80,0x3f350000,0x3f353f80,0xbf350000
.long 0xbf5ebf00,0xbf5ebf80,0xbf00,0x3f5e3f00,0x3e853f00,0xbe850000,0xbf35bf00,0xbf77bf5e
.long 0xbf803f80,0xbf803f80,0xbf803f80,0xbf803f80,0xbe853f00,0x3e850000,0x3f35bf00,0x3f77bf5e
.long 0x3f5ebf00,0x3f5ebf80,0xbf00,0xbf5e3f00,0x3f35bf80,0xbf350000,0xbf353f80,0x3f350000
.long 0x3f803f80,0x3f803f80,0x3f803f80,0x3f803f80,0x3e853f00,0xbe850000,0xbf35bf00,0xbf77bf5e
.long 0xbf5ebf00,0xbf5ebf80,0xbf00,0x3f5e3f00,0xbf35bf80,0x3f350000,0x3f353f80,0xbf350000
.long 0x3f803f80,0x3f803f80,0x3f803f80,0x3f803f80,0xbe85bf00,0x3e850000,0x3f353f00,0x3f773f5e
.long 0xbf5ebf00,0xbf5ebf80,0xbf00,0x3f5e3f00,0x3f353f80,0xbf350000,0xbf35bf80,0x3f350000
.long 0xbf803f80,0xbf803f80,0xbf803f80,0xbf803f80,0x3e85bf00,0xbe850000,0xbf353f00,0xbf773f5e
.long 0x3f5ebf00,0x3f5ebf80,0xbf00,0xbf5e3f00,0xbf353f80,0x3f350000,0x3f35bf80,0xbf350000
.long 0x3f00bf00,0x3f003f80,0xbf80bf00,0x3f00bf00,0xbf77bf00,0x3f770000,0xbf353f00,0x3e85bf5e
.long 0x3f80,0xbf80,0x3f80,0xbf80,0x3f77bf00,0xbf770000,0x3f353f00,0xbe85bf5e
.long 0xbf00bf00,0xbf003f80,0x3f80bf00,0xbf00bf00,0x3f77bf00,0xbf770000,0x3f353f00,0xbe85bf5e
.long 0x3f80,0xbf80,0x3f80,0xbf80,0xbf77bf00,0x3f770000,0xbf353f00,0x3e85bf5e
.long 0xbf00bf00,0xbf003f80,0x3f80bf00,0xbf00bf00,0xbf353f80,0x3f350000,0x3f35bf80,0xbf350000
.long 0x3f5ebf00,0x3f5ebf80,0xbf00,0xbf5e3f00,0x3e85bf00,0xbe850000,0xbf353f00,0xbf773f5e
.long 0x3f00bf00,0x3f003f80,0xbf80bf00,0x3f00bf00,0x3f353f80,0xbf350000,0xbf35bf80,0x3f350000
.long 0xbf5ebf00,0xbf5ebf80,0xbf00,0x3f5e3f00,0xbe85bf00,0x3e850000,0x3f353f00,0x3f773f5e
.long 0xbf803f80,0xbf803f80,0xbf803f80,0xbf803f80,0x3e85bf00,0xbe850000,0xbf353f00,0xbf773f5e
.long 0x3f5ebf00,0x3f5ebf80,0xbf00,0xbf5e3f00,0xbf353f80,0x3f350000,0x3f35bf80,0xbf350000
.long 0x3f803f80,0x3f803f80,0x3f803f80,0x3f803f80,0xbe85bf00,0x3e850000,0x3f353f00,0x3f773f5e
.long 0xbf5ebf00,0xbf5ebf80,0xbf00,0x3f5e3f00,0x3f353f80,0xbf350000,0xbf35bf80,0x3f350000
.long 0x0,0x0,0x0,0x0,0x3e850000,0x3f353f00,0x3f773f5e,0x3f773f80
.long 0x3f000000,0x3f803f5e,0x3f003f5e,0xbf000000,0x3f350000,0x3f353f80,0xbf350000,0xbf35bf80
.long 0x0,0x0,0x0,0x0,0xbe850000,0xbf353f00,0xbf773f5e,0xbf773f80
.long 0xbf000000,0xbf803f5e,0xbf003f5e,0x3f000000,0xbf350000,0xbf353f80,0x3f350000,0x3f35bf80
.long 0x3f5e0000,0x3f5e,0xbf5ebf5e,0x3f5e0000,0x3f770000,0xbf353f00,0x3e85bf5e,0x3e853f80
.long 0x3f800000,0xbf800000,0x3f800000,0xbf800000,0x3f770000,0xbf35bf00,0x3e853f5e,0x3e85bf80
.long 0xbf5e0000,0x3f5e,0x3f5ebf5e,0xbf5e0000,0xbf770000,0x3f353f00,0xbe85bf5e,0xbe853f80
.long 0xbf800000,0x3f800000,0xbf800000,0x3f800000,0xbf770000,0x3f35bf00,0xbe853f5e,0xbe85bf80
.long 0x3f5e0000,0xbf5e,0xbf5e3f5e,0x3f5e0000,0x3f350000,0x3f35bf80,0xbf350000,0xbf353f80
.long 0x3f000000,0x3f80bf5e,0x3f00bf5e,0xbf000000,0x3e850000,0x3f35bf00,0x3f77bf5e,0x3f77bf80
.long 0xbf5e0000,0xbf5e,0x3f5e3f5e,0xbf5e0000,0xbf350000,0xbf35bf80,0x3f350000,0x3f353f80
.long 0xbf000000,0xbf80bf5e,0xbf00bf5e,0x3f000000,0xbe850000,0xbf35bf00,0xbf77bf5e,0xbf77bf80
.long 0x0,0x0,0x0,0x0,0xbe850000,0xbf353f00,0xbf773f5e,0xbf773f80
.long 0xbf000000,0xbf803f5e,0xbf003f5e,0x3f000000,0xbf350000,0xbf353f80,0x3f350000,0x3f35bf80
.long 0x0,0x0,0x0,0x0,0x3e850000,0x3f353f00,0x3f773f5e,0x3f773f80
.long 0x3f000000,0x3f803f5e,0x3f003f5e,0xbf000000,0x3f350000,0x3f353f80,0xbf350000,0xbf35bf80
.long 0x0,0x0,0x0,0x0,0xbe850000,0xbf35bf00,0xbf77bf5e,0xbf77bf80
.long 0x3f000000,0x3f803f5e,0x3f003f5e,0xbf000000,0xbf350000,0xbf35bf80,0x3f350000,0x3f353f80
.long 0x0,0x0,0x0,0x0,0x3e850000,0x3f35bf00,0x3f77bf5e,0x3f77bf80
.long 0xbf000000,0xbf803f5e,0xbf003f5e,0x3f000000,0x3f350000,0x3f35bf80,0xbf350000,0xbf353f80
.long 0x3f5e0000,0x3f5e,0xbf5ebf5e,0x3f5e0000,0xbf770000,0x3f35bf00,0xbe853f5e,0xbe85bf80
.long 0x3f800000,0xbf800000,0x3f800000,0xbf800000,0xbf770000,0x3f353f00,0xbe85bf5e,0xbe853f80
.long 0xbf5e0000,0x3f5e,0x3f5ebf5e,0xbf5e0000,0x3f770000,0xbf35bf00,0x3e853f5e,0x3e85bf80
.long 0xbf800000,0x3f800000,0xbf800000,0x3f800000,0x3f770000,0xbf353f00,0x3e85bf5e,0x3e853f80
.long 0x3f5e0000,0xbf5e,0xbf5e3f5e,0x3f5e0000,0xbf350000,0xbf353f80,0x3f350000,0x3f35bf80
.long 0x3f000000,0x3f80bf5e,0x3f00bf5e,0xbf000000,0xbe850000,0xbf353f00,0xbf773f5e,0xbf773f80
.long 0xbf5e0000,0xbf5e,0x3f5e3f5e,0xbf5e0000,0x3f350000,0x3f353f80,0xbf350000,0xbf35bf80
.long 0xbf000000,0xbf80bf5e,0xbf00bf5e,0x3f000000,0x3e850000,0x3f353f00,0x3f773f5e,0x3f773f80
.long 0x0,0x0,0x0,0x0,0x3e850000,0x3f35bf00,0x3f77bf5e,0x3f77bf80
.long 0xbf000000,0xbf803f5e,0xbf003f5e,0x3f000000,0x3f350000,0x3f35bf80,0xbf350000,0xbf353f80
.long 0x0,0x0,0x0,0x0,0xbe850000,0xbf35bf00,0xbf77bf5e,0xbf77bf80
.long 0x3f000000,0x3f803f5e,0x3f003f5e,0xbf000000,0xbf350000,0xbf35bf80,0x3f350000,0x3f353f80
.long 0x0,0x0,0x3f800000,0x3f800000,0x3f353f5e,0x3e853f00,0x3f800000,0x3f7ffc1a
.long 0xbf80bf5e,0xbf00bf5e,0x3f800000,0x3f7ff067,0x3f350000,0x3f353f80,0x3f800000,0x3f7fdce9
.long 0x0,0x0,0x3f800000,0x3f7dcf55,0xbf353f5e,0xbe853f00,0x3f800000,0x3f7d6e28
.long 0x3f80bf5e,0x3f00bf5e,0x3f800000,0x3f7d0543,0xbf350000,0xbf353f80,0x3f800000,0x3f7c94a8
.long 0x3f5e,0xbf5ebf5e,0x3f800000,0x3f7fc1a0,0xbf35bf5e,0x3f773f00,0x3f800000,0x3f7f9e8c
.long 0x3f800000,0xbf800000,0x3f800000,0x3f7f73af,0xbf353f5e,0x3f77bf00,0x3f800000,0x3f7f4109
.long 0x3f5e,0x3f5ebf5e,0x3f800000,0x3f7c1c5c,0x3f35bf5e,0xbf773f00,0x3f800000,0x3f7b9c62
.long 0xbf800000,0x3f800000,0x3f800000,0x3f7b14be,0x3f353f5e,0xbf77bf00,0x3f800000,0x3f7a8575
.long 0xbf5e,0xbf5e3f5e,0x3f800000,0x3f7f069e,0x3f350000,0x3f35bf80,0x3f800000,0x3f7ec46d
.long 0xbf803f5e,0xbf003f5e,0x3f800000,0x3f7e7a7a,0x3f35bf5e,0x3e85bf00,0x3f800000,0x3f7e28c6
.long 0xbf5e,0x3f5e3f5e,0x3f800000,0x3f79ee89,0xbf350000,0xbf35bf80,0x3f800000,0x3f795000
.long 0x3f803f5e,0x3f003f5e,0x3f800000,0x3f78a9e0,0xbf35bf5e,0xbe85bf00,0x3f800000,0x3f77fc2c
.long 0x0,0x0,0x3f800000,0x3f7dcf55,0xbf353f5e,0xbe853f00,0x3f800000,0x3f7d6e28
.long 0x3f80bf5e,0x3f00bf5e,0x3f800000,0x3f7d0543,0xbf350000,0xbf353f80,0x3f800000,0x3f7c94a8
.long 0x0,0x0,0x3f800000,0x3f7746ea,0x3f353f5e,0x3e853f00,0x3f800000,0x3f768a20
.long 0xbf80bf5e,0xbf00bf5e,0x3f800000,0x3f75c5d4,0x3f350000,0x3f353f80,0x3f800000,0x3f74fa0b
.long 0x0,0x0,0x3f800000,0x3f800000,0xbf35bf5e,0xbe85bf00,0x3f7dcf55,0x3f7d6e28
.long 0xbf80bf5e,0xbf00bf5e,0x3f7746ea,0x3f75c5d4,0xbf350000,0xbf35bf80,0x3f6c835e,0x3f692e5f
.long 0x0,0x0,0x0,0xbe05a8a8,0x3f35bf5e,0x3e85bf00,0xbe05a8a8,0xbe89e6f1
.long 0x3f80bf5e,0x3f00bf5e,0xbe8483ee,0xbece34d0,0x3f350000,0x3f35bf80,0xbec3ef15,0xbf072f74
.long 0x3f5e,0xbf5ebf5e,0x3f5db3d7,0x3f57e880,0x3f353f5e,0xbf77bf00,0x3f4b1934,0x3f424cfe
.long 0x3f800000,0xbf800000,0x3f3504f3,0x3f28cae3,0x3f35bf5e,0xbf773f00,0x3f1bd7ca,0x3f0be54a
.long 0x3f5e,0x3f5ebf5e,0xbf000000,0xbf248dbb,0xbf353f5e,0x3f77bf00,0xbf1bd7ca,0xbf3e9e4b
.long 0xbf800000,0x3f800000,0xbf3504f3,0xbf54db31,0xbf35bf5e,0x3f773f00,0xbf4b1934,0xbf66d223
.long 0xbf5e,0xbf5e3f5e,0x3f000000,0x3ed8616c,0xbf350000,0xbf353f80,0x3ec3ef15,0x3e94a031
.long 0xbf803f5e,0xbf003f5e,0x3e8483ee,0x3e1bc63c,0xbf353f5e,0xbe853f00,0x3e05a8a8,0x3c32b7da
.long 0xbf5e,0x3f5e3f5e,0xbf5db3d7,0xbf7426cb,0x3f350000,0x3f353f80,0xbf6c835e,0xbf7c94a8
.long 0x3f803f5e,0x3f003f5e,0xbf7746ea,0xbf7ff067,0x3f353f5e,0x3e853f00,0xbf7dcf55,0xbf7e28c6
.long 0x0,0x0,0x0,0xbe05a8a8,0x3f35bf5e,0x3e85bf00,0xbe05a8a8,0xbe89e6f1
.long 0x3f80bf5e,0x3f00bf5e,0xbe8483ee,0xbece34d0,0x3f350000,0x3f35bf80,0xbec3ef15,0xbf072f74
.long 0x0,0x0,0xbf800000,0xbf7746ea,0xbf35bf5e,0xbe85bf00,0xbf7dcf55,0xbf6b6e32
.long 0xbf80bf5e,0xbf00bf5e,0xbf7746ea,0xbf5adb81,0xbf350000,0xbf35bf80,0xbf6c835e,0xbf45e403
.long 0x3f800000,0x3f800000,0x3f800000,0x3f800000,0x3f7ff067,0x3f7fdce9,0x3f7fc1a0,0x3f7f9e8c
.long 0x3f7fc1a0,0x3f7f73af,0x3f7f069e,0x3f7e7a7a,0x3f7f73af,0x3f7ec46d,0x3f7dcf55,0x3f7c94a8
.long 0x3f7746ea,0x3f6c835e,0x3f5db3d7,0x3f4b1934,0x3f75c5d4,0x3f692e5f,0x3f57e880,0x3f424cfe
.long 0x3f7426cb,0x3f659974,0x3f51b3f3,0x3f38ecd8,0x3f726a03,0x3f61c598,0x3f4b1934,0x3f2effe8
.long 0x3f7f069e,0x3f7dcf55,0x3f7c1c5c,0x3f79ee89,0x3f7e7a7a,0x3f7c94a8,0x3f79ee89,0x3f768a20
.long 0x3f7dcf55,0x3f7b14be,0x3f7746ea,0x3f726a03,0x3f7d0543,0x3f795000,0x3f7426cb,0x3f6d9156
.long 0x3f708fb2,0x3f5db3d7,0x3f441b7d,0x3f248dbb,0x3f6e9811,0x3f596550,0x3f3cbe35,0x3f199e45
.long 0x3f6c835e,0x3f54db31,0x3f3504f3,0x3f0e39da,0x3f6a51da,0x3f5016b8,0x3f2cf37b,0x3f026926
.long 0x3f7c1c5c,0x3f7746ea,0x3f708fb2,0x3f6803ca,0x3f7b14be,0x3f74fa0b,0x3f6c835e,0x3f61c598
.long 0x3f79ee89,0x3f726a03,0x3f6803ca,0x3f5adb81,0x3f78a9e0,0x3f6f9788,0x3f631324,0x3f534aca
.long 0x3f6803ca,0x3f4b1934,0x3f248dbb,0x3eec6a50,0x3f659974,0x3f45e403,0x3f1bd7ca,0x3ed34e56
.long 0x3f631324,0x3f407893,0x3f12d5e8,0x3eb9917b,0x3f60712a,0x3f3ad85f,0x3f098c78,0x3e9f4757
.long 0x3f7746ea,0x3f6c835e,0x3f5db3d7,0x3f4b1934,0x3f75c5d4,0x3f692e5f,0x3f57e880,0x3f424cfe
.long 0x3f7426cb,0x3f659974,0x3f51b3f3,0x3f38ecd8,0x3f726a03,0x3f61c598,0x3f4b1934,0x3f2effe8
.long 0x3f5db3d7,0x3f3504f3,0x3f000000,0x3e8483ee,0x3f5adb81,0x3f2effe8,0x3eec6a50,0x3e52b743
.long 0x3f57e880,0x3f28cae3,0x3ed8616c,0x3e1bc63c,0x3f54db31,0x3f226799,0x3ec3ef15,0x3dc8bd36
.long 0x3f800000,0x3f800000,0x3f800000,0x3f800000,0x3f7d0543,0x3f7c94a8,0x3f7c1c5c,0x3f7b9c62
.long 0x3f7426cb,0x3f726a03,0x3f708fb2,0x3f6e9811,0x3f659974,0x3f61c598,0x3f5db3d7,0x3f596550
.long 0xbe8483ee,0xbec3ef15,0xbf000000,0xbf1bd7ca,0xbece34d0,0xbf072f74,0xbf248dbb,0xbf3e9e4b
.long 0xbf098c78,0xbf28cae3,0xbf441b7d,0xbf5adb81,0xbf28cae3,0xbf45e403,0xbf5db3d7,0xbf6f9788
.long 0x3f51b3f3,0x3f4b1934,0x3f441b7d,0x3f3cbe35,0x3f38ecd8,0x3f2effe8,0x3f248dbb,0x3f199e45
.long 0x3f1bd7ca,0x3f0e39da,0x3f000000,0x3ee273aa,0x3ef64429,0x3ed34e56,0x3eaf1d44,0x3e89e6f1
.long 0xbf441b7d,0xbf5db3d7,0xbf708fb2,0xbf7c1c5c,0xbf5adb81,0xbf6f9788,0xbf7c1c5c,0xbf7ffc1a
.long 0xbf6c835e,0xbf7b14be,0xbf800000,0xbf7b14be,0xbf78a9e0,0xbf7fdce9,0xbf7c1c5c,0xbf6d9156
.long 0x3eaf1d44,0x3e8483ee,0x3e31d0d4,0x3db27eb6,0x3e47c5c2,0x3dc8bd36,0x0,0xbdc8bd36
.long 0x3d32aa3e,0xbd85f213,0xbe31d0d4,0xbe8f45c0,0xbddef599,0xbe6886ae,0xbeaf1d44,0xbee77284
.long 0xbf7f069e,0xbf7dcf55,0xbf708fb2,0xbf57e880,0xbf7f73af,0xbf74fa0b,0xbf5db3d7,0xbf3ad85f
.long 0xbf79ee89,0xbf659974,0xbf441b7d,0xbf176012,0xbf6e9811,0xbf5016b8,0xbf248dbb,0xbedd6dea
.long 0xbe8483ee,0xbec3ef15,0xbf000000,0xbf1bd7ca,0xbece34d0,0xbf072f74,0xbf248dbb,0xbf3e9e4b
.long 0xbf098c78,0xbf28cae3,0xbf441b7d,0xbf5adb81,0xbf28cae3,0xbf45e403,0xbf5db3d7,0xbf6f9788
.long 0xbf5db3d7,0xbf3504f3,0xbf000000,0xbe8483ee,0xbf47a682,0xbf151d42,0xbeaf1d44,0xbd9c3ac6
.long 0xbf2cf37b,0xbee273aa,0xbe31d0d4,0x3ddef599,0xbf0e39da,0xbe94a031,0x0,0x3e94a031
.long 0x3f800000,0x3f800000,0x3f800000,0x3f800000,0x3f7f73af,0x3f7f4109,0x3f7f069e,0x3f7ec46d
.long 0x3f7dcf55,0x3f7d0543,0x3f7c1c5c,0x3f7b14be,0x3f7b14be,0x3f795000,0x3f7746ea,0x3f74fa0b
.long 0x3f3504f3,0x3f1bd7ca,0x3f000000,0x3ec3ef15,0x3f28cae3,0x3f0be54a,0x3ed8616c,0x3e94a031
.long 0x3f1bd7ca,0x3ef64429,0x3eaf1d44,0x3e47c5c2,0x3f0e39da,0x3ed34e56,0x3e8483ee,0x3dc8bd36
.long 0x3f7746ea,0x3f7426cb,0x3f708fb2,0x3f6c835e,0x3f726a03,0x3f6d9156,0x3f6803ca,0x3f61c598
.long 0x3f6c835e,0x3f659974,0x3f5db3d7,0x3f54db31,0x3f659974,0x3f5c4b07,0x3f51b3f3,0x3f45e403
.long 0x3f000000,0x3eaf1d44,0x3e31d0d4,0x0,0x3ee273aa,0x3e89e6f1,0x3db27eb6,0xbdc8bd36
.long 0x3ec3ef15,0x3e47c5c2,0x0,0xbe47c5c2,0x3ea493b7,0x3df52731,0xbdb27eb6,0xbe94a031
.long 0x3f5db3d7,0x3f51b3f3,0x3f441b7d,0x3f3504f3,0x3f54db31,0x3f45e403,0x3f3504f3,0x3f226799
.long 0x3f4b1934,0x3f38ecd8,0x3f248dbb,0x3f0e39da,0x3f407893,0x3f2ae1c9,0x3f12d5e8,0x3ef15aea
.long 0x3e8483ee,0x3d32aa3e,0xbe31d0d4,0xbec3ef15,0x3e47c5c2,0xbd060472,0xbe8483ee,0xbef15aea
.long 0x3e05a8a8,0xbddef599,0xbeaf1d44,0xbf0e39da,0x3d85f213,0xbe3cce2b,0xbed8616c,0xbf226799
.long 0x3f3504f3,0x3f1bd7ca,0x3f000000,0x3ec3ef15,0x3f28cae3,0x3f0be54a,0x3ed8616c,0x3e94a031
.long 0x3f1bd7ca,0x3ef64429,0x3eaf1d44,0x3e47c5c2,0x3f0e39da,0x3ed34e56,0x3e8483ee,0x3dc8bd36
.long 0x0,0xbe8483ee,0xbf000000,0xbf3504f3,0xbd85f213,0xbea9db13,0xbf12d5e8,0xbf45e403
.long 0xbe05a8a8,0xbece34d0,0xbf248dbb,0xbf54db31,0xbe47c5c2,0xbef15aea,0xbf3504f3,0xbf61c598
.long 0x3f800000,0x3f800000,0x3f800000,0x3f800000,0x3f7b14be,0x3f7a8575,0x3f79ee89,0x3f795000
.long 0x3f6c835e,0x3f6a51da,0x3f6803ca,0x3f659974,0x3f54db31,0x3f5016b8,0x3f4b1934,0x3f45e403
.long 0xbf3504f3,0xbf4b1934,0xbf5db3d7,0xbf6c835e,0xbf54db31,0xbf66d223,0xbf7426cb,0xbf7c94a8
.long 0xbf6c835e,0xbf78a9e0,0xbf7f069e,0xbf7f73af,0xbf7b14be,0xbf7fdce9,0xbf7dcf55,0xbf74fa0b
.long 0x3f3504f3,0x3f2cf37b,0x3f248dbb,0x3f1bd7ca,0x3f0e39da,0x3f026926,0x3eec6a50,0x3ed34e56
.long 0x3ec3ef15,0x3ea493b7,0x3e8483ee,0x3e47c5c2,0x3e47c5c2,0x3df52731,0x3d32aa3e,0xbd060472
.long 0xbf800000,0xbf7c1c5c,0xbf708fb2,0xbf5db3d7,0xbf7b14be,0xbf6d9156,0xbf57e880,0xbf3ad85f
.long 0xbf6c835e,0xbf54db31,0xbf3504f3,0xbf0e39da,0xbf54db31,0xbf3308b4,0xbf098c78,0xbeb45a1e
.long 0x0,0xbdb27eb6,0xbe31d0d4,0xbe8483ee,0xbe47c5c2,0xbe94a031,0xbec3ef15,0xbef15aea
.long 0xbec3ef15,0xbef64429,0xbf12d5e8,0xbf28cae3,0xbf0e39da,0xbf26aed9,0xbf3cbe35,0xbf5016b8
.long 0xbf3504f3,0xbf098c78,0xbeaf1d44,0xbe05a8a8,0xbf0e39da,0xbeb45a1e,0xbe05a8a8,0x3dc8bd36
.long 0xbec3ef15,0xbe1bc63c,0x3db27eb6,0x3ea493b7,0xbe47c5c2,0x3d5f4a99,0x3e99f61c,0x3f072f74
.long 0xbf3504f3,0xbf4b1934,0xbf5db3d7,0xbf6c835e,0xbf54db31,0xbf66d223,0xbf7426cb,0xbf7c94a8
.long 0xbf6c835e,0xbf78a9e0,0xbf7f069e,0xbf7f73af,0xbf7b14be,0xbf7fdce9,0xbf7dcf55,0xbf74fa0b
.long 0x0,0x3e8483ee,0x3f000000,0x3f3504f3,0x3e47c5c2,0x3ee77284,0x3f2cf37b,0x3f596550
.long 0x3ec3ef15,0x3f203c85,0x3f51b3f3,0x3f726a03,0x3f0e39da,0x3f45e403,0x3f6c835e,0x3f7ec46d
.long 0x3f800000,0x3f800000,0x0,0x0,0x3f7e7a7a,0x3f7e28c6,0x0,0xbc32b7da
.long 0x3f79ee89,0x3f78a9e0,0x0,0xbcb2b521,0x3f726a03,0x3f6f9788,0x0,0xbd060472
.long 0x3e8483ee,0x3e05a8a8,0x0,0xbe05a8a8,0x3e1bc63c,0x3c32b7da,0x0,0xbe10b9a6
.long 0x3d32aa3e,0xbddef599,0x0,0xbe1bc63c,0xbd85f213,0xbe6886ae,0x0,0xbe26ce12
.long 0x3f6803ca,0x3f631324,0x0,0xbd32aa3e,0x3f5adb81,0x3f534aca,0x0,0xbd5f4a99
.long 0x3f4b1934,0x3f407893,0x0,0xbd85f213,0x3f38ecd8,0x3f2ae1c9,0x0,0xbd9c3ac6
.long 0xbe31d0d4,0xbeaf1d44,0x0,0xbe31d0d4,0xbe8f45c0,0xbee77284,0x0,0xbe3cce2b
.long 0xbec3ef15,0xbf0e39da,0x0,0xbe47c5c2,0xbef64429,0xbf26aed9,0x0,0xbe52b743
.long 0x3f248dbb,0x3f12d5e8,0x0,0xbdb27eb6,0x3f0e39da,0x3ef15aea,0x0,0xbdc8bd36
.long 0x3eec6a50,0x3eb9917b,0x0,0xbddef599,0x3eb9917b,0x3e7e39c4,0x0,0xbdf52731
.long 0xbf12d5e8,0xbf3cbe35,0x0,0xbe5da259,0xbf28cae3,0xbf5016b8,0x0,0xbe6886ae
.long 0xbf3cbe35,0xbf60712a,0x0,0xbe7363ee,0xbf4e7327,0xbf6d9156,0x0,0xbe7e39c4
.long 0x3e8483ee,0x3e05a8a8,0x0,0xbe05a8a8,0x3e1bc63c,0x3c32b7da,0x0,0xbe10b9a6
.long 0x3d32aa3e,0xbddef599,0x0,0xbe1bc63c,0xbd85f213,0xbe6886ae,0x0,0xbe26ce12
.long 0xbf5db3d7,0xbf7746ea,0x0,0xbe8483ee,0xbf6a51da,0xbf7d6e28,0x0,0xbe89e6f1
.long 0xbf7426cb,0xbf7ff067,0x0,0xbe8f45c0,0xbf7b14be,0xbf7ec46d,0x0,0xbe94a031
.long 0x3f800000,0x3f800000,0x0,0x0,0x3f78a9e0,0x3f77fc2c,0xbe05a8a8,0xbe10b9a6
.long 0x3f631324,0x3f60712a,0xbe8483ee,0xbe8f45c0,0x3f407893,0x3f3ad85f,0xbec3ef15,0xbed34e56
.long 0xbf7746ea,0xbf7dcf55,0xbf800000,0xbf7dcf55,0xbf7ff067,0xbf7e28c6,0xbf7dcf55,0xbf768a20
.long 0xbf79ee89,0xbf6e9811,0xbf7746ea,0xbf6a51da,0xbf659974,0xbf5016b8,0xbf6c835e,0xbf596550
.long 0x3f12d5e8,0x3f098c78,0xbf000000,0xbf098c78,0x3eb9917b,0x3e9f4757,0xbf1bd7ca,0xbf26aed9
.long 0x3e05a8a8,0x3d85f213,0xbf3504f3,0xbf407893,0xbddef599,0xbe3cce2b,0xbf4b1934,0xbf56651d
.long 0xbf441b7d,0xbf248dbb,0xbf5db3d7,0xbf441b7d,0xbf176012,0xbedd6dea,0xbf4b1934,0xbf2ae1c9
.long 0xbec3ef15,0xbe47c5c2,0xbf3504f3,0xbf0e39da,0xbe1bc63c,0x3d5f4a99,0xbf1bd7ca,0xbedd6dea
.long 0xbeaf1d44,0xbed8616c,0xbf5db3d7,0xbf6803ca,0xbf0e39da,0xbf226799,0xbf6c835e,0xbf74fa0b
.long 0xbf3cbe35,0xbf4e7327,0xbf7746ea,0xbf7d0543,0xbf60712a,0xbf6d9156,0xbf7dcf55,0xbf7ffc1a
.long 0x3db27eb6,0x3e99f61c,0xbf000000,0xbe99f61c,0x3ea493b7,0x3f072f74,0xbec3ef15,0xbe26ce12
.long 0x3f098c78,0x3f38ecd8,0xbe8483ee,0xbcb2b521,0x3f38ecd8,0x3f5f15e7,0xbe05a8a8,0x3df52731
.long 0xbf7746ea,0xbf7dcf55,0xbf800000,0xbf7dcf55,0xbf7ff067,0xbf7e28c6,0xbf7dcf55,0xbf768a20
.long 0xbf79ee89,0xbf6e9811,0xbf7746ea,0xbf6a51da,0xbf659974,0xbf5016b8,0xbf6c835e,0xbf596550
.long 0x3f5db3d7,0x3f7746ea,0x0,0x3e8483ee,0x3f75c5d4,0x3f7ffc1a,0x3e05a8a8,0x3ec91503
.long 0x3f7fc1a0,0x3f78a9e0,0x3e8483ee,0x3f04ce53,0x3f7b14be,0x3f61c598,0x3ec3ef15,0x3f226799
.long 0x0,0x0,0x0,0x0,0xbcb2b521,0xbd060472,0xbd32aa3e,0xbd5f4a99
.long 0xbd32aa3e,0xbd85f213,0xbdb27eb6,0xbddef599,0xbd85f213,0xbdc8bd36,0xbe05a8a8,0xbe26ce12
.long 0xbe8483ee,0xbec3ef15,0xbf000000,0xbf1bd7ca,0xbe8f45c0,0xbed34e56,0xbf098c78,0xbf26aed9
.long 0xbe99f61c,0xbee273aa,0xbf12d5e8,0xbf310700,0xbea493b7,0xbef15aea,0xbf1bd7ca,0xbf3ad85f
.long 0xbdb27eb6,0xbe05a8a8,0xbe31d0d4,0xbe5da259,0xbddef599,0xbe26ce12,0xbe5da259,0xbe89e6f1
.long 0xbe05a8a8,0xbe47c5c2,0xbe8483ee,0xbea493b7,0xbe1bc63c,0xbe6886ae,0xbe99f61c,0xbebec330
.long 0xbeaf1d44,0xbf000000,0xbf248dbb,0xbf441b7d,0xbeb9917b,0xbf072f74,0xbf2cf37b,0xbf4cc94c
.long 0xbec3ef15,0xbf0e39da,0xbf3504f3,0xbf54db31,0xbece34d0,0xbf151d42,0xbf3cbe35,0xbf5c4b07
.long 0xbe31d0d4,0xbe8483ee,0xbeaf1d44,0xbed8616c,0xbe47c5c2,0xbe94a031,0xbec3ef15,0xbef15aea
.long 0xbe5da259,0xbea493b7,0xbed8616c,0xbf04ce53,0xbe7363ee,0xbeb45a1e,0xbeec6a50,0xbf108a14
.long 0xbed8616c,0xbf1bd7ca,0xbf441b7d,0xbf631324,0xbee273aa,0xbf226799,0xbf4b1934,0xbf692e5f
.long 0xbeec6a50,0xbf28cae3,0xbf51b3f3,0xbf6e9811,0xbef64429,0xbf2effe8,0xbf57e880,0xbf734c1c
.long 0xbe8483ee,0xbec3ef15,0xbf000000,0xbf1bd7ca,0xbe8f45c0,0xbed34e56,0xbf098c78,0xbf26aed9
.long 0xbe99f61c,0xbee273aa,0xbf12d5e8,0xbf310700,0xbea493b7,0xbef15aea,0xbf1bd7ca,0xbf3ad85f
.long 0xbf000000,0xbf3504f3,0xbf5db3d7,0xbf7746ea,0xbf04ce53,0xbf3ad85f,0xbf631324,0xbf7a8575
.long 0xbf098c78,0xbf407893,0xbf6803ca,0xbf7d0543,0xbf0e39da,0xbf45e403,0xbf6c835e,0xbf7ec46d
.long 0x0,0x0,0x0,0x0,0xbe1bc63c,0xbe26ce12,0xbe31d0d4,0xbe3cce2b
.long 0xbe99f61c,0xbea493b7,0xbeaf1d44,0xbeb9917b,0xbee273aa,0xbef15aea,0xbf000000,0xbf072f74
.long 0xbf7746ea,0xbf6c835e,0xbf5db3d7,0xbf4b1934,0xbf6a51da,0xbf596550,0xbf441b7d,0xbf2ae1c9
.long 0xbf57e880,0xbf407893,0xbf248dbb,0xbf04ce53,0xbf407893,0xbf226799,0xbf000000,0xbeb45a1e
.long 0xbf12d5e8,0xbf1bd7ca,0xbf248dbb,0xbf2cf37b,0xbf310700,0xbf3ad85f,0xbf441b7d,0xbf4cc94c
.long 0xbf4b1934,0xbf54db31,0xbf5db3d7,0xbf659974,0xbf60712a,0xbf692e5f,0xbf708fb2,0xbf768a20
.long 0xbf248dbb,0xbf000000,0xbeaf1d44,0xbe31d0d4,0xbf04ce53,0xbeb45a1e,0xbe31d0d4,0x3c32b7da
.long 0xbec3ef15,0xbe47c5c2,0x0,0x3e47c5c2,0xbe7363ee,0xbd060472,0x3e31d0d4,0x3ebec330
.long 0xbf708fb2,0xbf7746ea,0xbf7c1c5c,0xbf7f069e,0xbf7b14be,0xbf7ec46d,0xbf800000,0xbf7ec46d
.long 0xbf7fc1a0,0xbf7f73af,0xbf7c1c5c,0xbf75c5d4,0xbf7e7a7a,0xbf795000,0xbf708fb2,0xbf6459c6
.long 0xbdb27eb6,0x3e05a8a8,0x3eaf1d44,0x3f098c78,0x3d85f213,0x3e94a031,0x3f000000,0x3f2effe8
.long 0x3e5da259,0x3ee273aa,0x3f248dbb,0x3f4e7327,0x3eb9917b,0x3f151d42,0x3f441b7d,0x3f66d223
.long 0xbf7746ea,0xbf6c835e,0xbf5db3d7,0xbf4b1934,0xbf6a51da,0xbf596550,0xbf441b7d,0xbf2ae1c9
.long 0xbf57e880,0xbf407893,0xbf248dbb,0xbf04ce53,0xbf407893,0xbf226799,0xbf000000,0xbeb45a1e
.long 0x3f000000,0x3f3504f3,0x3f5db3d7,0x3f7746ea,0x3f203c85,0x3f5016b8,0x3f708fb2,0x3f7f4109
.long 0x3f3cbe35,0x3f659974,0x3f7c1c5c,0x3f7e7a7a,0x3f54db31,0x3f74fa0b,0x3f800000,0x3f74fa0b
.long 0x0,0x0,0x0,0x0,0xbd85f213,0xbd9c3ac6,0xbdb27eb6,0xbdc8bd36
.long 0xbe05a8a8,0xbe1bc63c,0xbe31d0d4,0xbe47c5c2,0xbe47c5c2,0xbe6886ae,0xbe8483ee,0xbe94a031
.long 0xbf3504f3,0xbf4b1934,0xbf5db3d7,0xbf6c835e,0xbf407893,0xbf56651d,0xbf6803ca,0xbf74fa0b
.long 0xbf4b1934,0xbf60712a,0xbf708fb2,0xbf7b14be,0xbf54db31,0xbf692e5f,0xbf7746ea,0xbf7ec46d
.long 0xbe8483ee,0xbe99f61c,0xbeaf1d44,0xbec3ef15,0xbea493b7,0xbebec330,0xbed8616c,0xbef15aea
.long 0xbec3ef15,0xbee273aa,0xbf000000,0xbf0e39da,0xbee273aa,0xbf026926,0xbf12d5e8,0xbf226799
.long 0xbf5db3d7,0xbf708fb2,0xbf7c1c5c,0xbf800000,0xbf659974,0xbf768a20,0xbf7f069e,0xbf7ec46d
.long 0xbf6c835e,0xbf7b14be,0xbf800000,0xbf7b14be,0xbf726a03,0xbf7e28c6,0xbf7f069e,0xbf74fa0b
.long 0xbf000000,0xbf12d5e8,0xbf248dbb,0xbf3504f3,0xbf0e39da,0xbf226799,0xbf3504f3,0xbf45e403
.long 0xbf1bd7ca,0xbf310700,0xbf441b7d,0xbf54db31,0xbf28cae3,0xbf3e9e4b,0xbf51b3f3,0xbf61c598
.long 0xbf7746ea,0xbf7fc1a0,0xbf7c1c5c,0xbf6c835e,0xbf7b14be,0xbf7fdce9,0xbf7746ea,0xbf61c598
.long 0xbf7dcf55,0xbf7e7a7a,0xbf708fb2,0xbf54db31,0xbf7f73af,0xbf7b9c62,0xbf6803ca,0xbf45e403
.long 0xbf3504f3,0xbf4b1934,0xbf5db3d7,0xbf6c835e,0xbf407893,0xbf56651d,0xbf6803ca,0xbf74fa0b
.long 0xbf4b1934,0xbf60712a,0xbf708fb2,0xbf7b14be,0xbf54db31,0xbf692e5f,0xbf7746ea,0xbf7ec46d
.long 0xbf800000,0xbf7746ea,0xbf5db3d7,0xbf3504f3,0xbf7f73af,0xbf718088,0xbf51b3f3,0xbf226799
.long 0xbf7dcf55,0xbf6a51da,0xbf441b7d,0xbf0e39da,0xbf7b14be,0xbf61c598,0xbf3504f3,0xbef15aea
.long 0x0,0x0,0x0,0x0,0xbe47c5c2,0xbe52b743,0xbe5da259,0xbe6886ae
.long 0xbec3ef15,0xbece34d0,0xbed8616c,0xbee273aa,0xbf0e39da,0xbf151d42,0xbf1bd7ca,0xbf226799
.long 0xbf3504f3,0xbf1bd7ca,0xbf000000,0xbec3ef15,0xbf0e39da,0xbedd6dea,0xbe99f61c,0xbe26ce12
.long 0xbec3ef15,0xbe7363ee,0xbdb27eb6,0x3d85f213,0xbe47c5c2,0xbd060472,0x3e05a8a8,0x3e94a031
.long 0xbf3504f3,0xbf3cbe35,0xbf441b7d,0xbf4b1934,0xbf54db31,0xbf5c4b07,0xbf631324,0xbf692e5f
.long 0xbf6c835e,0xbf726a03,0xbf7746ea,0xbf7b14be,0xbf7b14be,0xbf7e28c6,0xbf7fc1a0,0xbf7fdce9
.long 0x0,0x3e31d0d4,0x3eaf1d44,0x3f000000,0x3e47c5c2,0x3ebec330,0x3f098c78,0x3f2effe8
.long 0x3ec3ef15,0x3f0e39da,0x3f3504f3,0x3f54db31,0x3f0e39da,0x3f36fbaf,0x3f57e880,0x3f6f9788
.long 0xbf800000,0xbf7f069e,0xbf7c1c5c,0xbf7746ea,0xbf7b14be,0xbf74fa0b,0xbf6c835e,0xbf61c598
.long 0xbf6c835e,0xbf60712a,0xbf51b3f3,0xbf407893,0xbf54db31,0xbf424cfe,0xbf2cf37b,0xbf151d42
.long 0x3f3504f3,0x3f57e880,0x3f708fb2,0x3f7dcf55,0x3f54db31,0x3f6f9788,0x3f7dcf55,0x3f7ec46d
.long 0x3f6c835e,0x3f7d0543,0x3f7f069e,0x3f726a03,0x3f7b14be,0x3f7f9e8c,0x3f7426cb,0x3f596550
.long 0xbf3504f3,0xbf1bd7ca,0xbf000000,0xbec3ef15,0xbf0e39da,0xbedd6dea,0xbe99f61c,0xbe26ce12
.long 0xbec3ef15,0xbe7363ee,0xbdb27eb6,0x3d85f213,0xbe47c5c2,0xbd060472,0x3e05a8a8,0x3e94a031
.long 0x3f800000,0x3f7746ea,0x3f5db3d7,0x3f3504f3,0x3f7b14be,0x3f6459c6,0x3f3cbe35,0x3f072f74
.long 0x3f6c835e,0x3f47a682,0x3f12d5e8,0x3ea493b7,0x3f54db31,0x3f226799,0x3ec3ef15,0x3dc8bd36
.long 0x0,0x0,0x0,0x0,0xbddef599,0xbdf52731,0x1,0x0
.long 0xbe5da259,0xbe7363ee,0x2,0x0,0xbea493b7,0xbeb45a1e,0x3,0x0
.long 0xbf7746ea,0xbf7dcf55,0xc,0x0,0xbf7d0543,0xbf7ffc1a,0xd,0x0
.long 0xbf7fc1a0,0xbf7e7a7a,0xe,0x0,0xbf7f73af,0xbf795000,0xf,0x0
.long 0xbed8616c,0xbeec6a50,0x4,0x0,0xbf04ce53,0xbf108a14,0x5,0x0
.long 0xbf1bd7ca,0xbf28cae3,0x6,0x0,0xbf310700,0xbf3e9e4b,0x7,0x0
.long 0xbf7c1c5c,0xbf708fb2,0x10,0x0,0xbf75c5d4,0xbf6459c6,0x11,0x0
.long 0xbf6c835e,0xbf54db31,0x12,0x0,0xbf60712a,0xbf424cfe,0x13,0x0
.long 0xbf441b7d,0xbf51b3f3,0x8,0x0,0xbf54db31,0xbf61c598,0x9,0x0
.long 0xbf631324,0xbf6e9811,0xa,0x0,0xbf6e9811,0xbf77fc2c,0xb,0x0
.long 0xbf51b3f3,0xbf2cf37b,0x14,0x0,0xbf407893,0xbf151d42,0x15,0x0
.long 0xbf2cf37b,0xbef64429,0x16,0x0,0xbf176012,0xbebec330,0x17,0x0
.long 0xbf7746ea,0xbf7dcf55,0xc,0x0,0xbf7d0543,0xbf7ffc1a,0xd,0x0
.long 0xbf7fc1a0,0xbf7e7a7a,0xe,0x0,0xbf7f73af,0xbf795000,0xf,0x0
.long 0xbf000000,0xbe8483ee,0x18,0x0,0xbece34d0,0xbe10b9a6,0x19,0x0
.long 0xbe99f61c,0xbcb2b521,0x1a,0x0,0xbe47c5c2,0x3dc8bd36,0x1b,0x0
.long 0x0,0x0,0x0,0x0,0xbe7363ee,0xbe7e39c4,0x1,0x0
.long 0xbeec6a50,0xbef64429,0x2,0x0,0xbf28cae3,0xbf2effe8,0x3,0x0
.long 0xbe8483ee,0xbe05a8a8,0xc,0x0,0xbcb2b521,0x3df52731,0xd,0x0
.long 0x3e5da259,0x3eb9917b,0xe,0x0,0x3ee273aa,0x3f151d42,0xf,0x0
.long 0xbf51b3f3,0xbf57e880,0x4,0x0,0xbf6e9811,0xbf734c1c,0x5,0x0
.long 0xbf7dcf55,0xbf7f73af,0x6,0x0,0xbf7e7a7a,0xbf7b9c62,0x7,0x0
.long 0x3f248dbb,0x3f441b7d,0x10,0x0,0x3f4e7327,0x3f66d223,0x11,0x0
.long 0x3f6c835e,0x3f7b14be,0x12,0x0,0x3f7d0543,0x3f7f9e8c,0x13,0x0
.long 0xbf708fb2,0xbf6803ca,0x8,0x0,0xbf54db31,0xbf45e403,0x9,0x0
.long 0xbf2cf37b,0xbf176012,0xa,0x0,0xbef64429,0xbebec330,0xb,0x0
.long 0x3f7f069e,0x3f7426cb,0x14,0x0,0x3f726a03,0x3f596550,0x15,0x0
.long 0x3f57e880,0x3f310700,0x16,0x0,0x3f310700,0x3efb25e8,0x17,0x0
.long 0xbe8483ee,0xbe05a8a8,0xc,0x0,0xbcb2b521,0x3df52731,0xd,0x0
.long 0x3e5da259,0x3eb9917b,0xe,0x0,0x3ee273aa,0x3f151d42,0xf,0x0
.long 0x3f000000,0x3e8483ee,0x18,0x0,0x3e8f45c0,0x3c32b7da,0x19,0x0
.long 0x3d32aa3e,0xbe7363ee,0x1a,0x0,0xbe47c5c2,0xbef15aea,0x1b,0x0
.long 0x0,0x0,0x0,0x3f803f80,0x0,0x0,0x0,0x3f800000
.long 0x0,0x0,0x0,0x0,0x0,0x0,0x0,0x0
.long 0x0,0x0,0x0,0x0,0x0,0x0,0x0,0x0
.long 0x0,0x0,0x0,0x0,0x0,0x0,0x0,0x0
.long 0x0,0x0,0x0,0x0,0x0,0x0,0x0,0x0
.long 0x0,0x0,0x0,0x0,0x0,0x0,0x0,0x0
.long 0x0,0x0,0x0,0x0,0x0,0x0,0x0,0x0
.long 0x0,0x0,0x0,0x0,0x0,0x0,0x0,0x0
.long 0x3f803f80,0x3f80,0x0,0x0,0x3f803f80,0x3f803f80,0x0,0x0
.long 0x3f803f80,0x3f803f80,0x3f80,0x0,0x3f800000,0x3f803f80,0x3f803f80,0x0
.long 0x0,0x3f803f80,0x3f803f80,0x3f80,0x0,0x3f800000,0x3f803f80,0x3f803f80
.long 0x0,0x0,0x3f803f80,0x3f803f80,0x0,0x0,0x3f800000,0x3f803f80
.long 0x0,0x0,0x0,0x3f803f80,0x0,0x0,0x0,0x3f800000
.long 0x0,0x0,0x0,0x0,0x0,0x0,0x0,0x0
.long 0x0,0x0,0x0,0x0,0x0,0x0,0x0,0x0
.long 0x0,0x0,0x0,0x0,0x0,0x0,0x0,0x0
.long 0x0,0x0,0x0,0x0,0x0,0x0,0x0,0x0
.long 0x0,0x0,0x0,0x0,0x0,0x0,0x0,0x0
.long 0x0,0x0,0x0,0x0,0x0,0x0,0x0,0x0
.long 0x3f80,0x0,0x0,0x0,0x3f803f80,0x0,0x0,0x0
.long 0x3f803f80,0x3f80,0x0,0x0,0x3f803f80,0x3f803f80,0x0,0x0
.long 0x3f803f80,0x3f803f80,0x3f80,0x0,0x3f800000,0x3f803f80,0x3f803f80,0x0
.long 0x0,0x3f803f80,0x3f803f80,0x3f80,0x0,0x3f800000,0x3f803f80,0x3f803f80
.long 0x0,0x0,0x3f803f80,0x3f803f80,0x0,0x0,0x3f800000,0x3f803f80
.long 0x0,0x0,0x0,0x0,0x0,0x0,0x0,0x0
.long 0x0,0x0,0x0,0x0,0x0,0x0,0x0,0x0
.long 0x0,0x0,0x0,0x0,0x0,0x0,0x0,0x0
.long 0x0,0x0,0x0,0x0,0x0,0x0,0x0,0x0
.long 0x0,0x0,0x0,0x0,0x0,0x0,0x0,0x0
.long 0x0,0x0,0x0,0x0,0x0,0x0,0x0,0x0
.long 0x0,0x0,0x0,0x0,0x0,0x0,0x0,0x0
.long 0x3f80,0x0,0x0,0x0,0x3f803f80,0x0,0x0,0x0
.long 0x0,0x0,0x0,0x0,0x0,0x0,0x0,0x0
.long 0x0,0x0,0x0,0x0,0x0,0x0,0x0,0x0
.long 0x0,0x0,0x0,0x0,0x0,0x0,0x0,0x0
.long 0x0,0x0,0x0,0x0,0x0,0x0,0x0,0x0
.long 0x0,0x0,0x0,0x0,0x0,0x0,0x0,0x0
.long 0x0,0x0,0x0,0x0,0x0,0x0,0x0,0x0
.long 0x0,0x0,0x0,0x0,0x0,0x0,0x0,0x0
.long 0x0,0x0,0x0,0x0,0x0,0x0,0x0,0x0
.long 0x0,0x3f800000,0x3f803f80,0x0,0x0,0x0,0x3f803f80,0x3f80
.long 0x0,0x0,0x3f800000,0x3f803f80,0x0,0x0,0x0,0x3f803f80
.long 0x0,0x0,0x0,0x3f800000,0x0,0x0,0x0,0x0
.long 0x0,0x0,0x0,0x0,0x0,0x0,0x0,0x0
.long 0x0,0x0,0x0,0x0,0x0,0x0,0x0,0x0
.long 0x0,0x0,0x0,0x0,0x0,0x0,0x0,0x0
.long 0x0,0x0,0x0,0x0,0x0,0x0,0x0,0x0
.long 0x0,0x0,0x0,0x0,0x0,0x0,0x0,0x0
.long 0x0,0x0,0x0,0x0,0x0,0x0,0x0,0x0
.long 0x0,0x0,0x0,0x0,0x3f80,0x0,0x0,0x0
.long 0x3f803f80,0x0,0x0,0x0,0x3f803f80,0x3f80,0x0,0x0
.long 0x3f800000,0x3f803f80,0x0,0x0,0x0,0x3f803f80,0x3f80,0x0
.long 0x0,0x3f800000,0x3f803f80,0x0,0x0,0x0,0x3f803f80,0x3f80
.long 0x0,0x0,0x3f800000,0x3f803f80,0x0,0x0,0x0,0x3f803f80
.long 0x0,0x0,0x0,0x3f800000,0x0,0x0,0x0,0x0
.long 0x0,0x0,0x0,0x0,0x0,0x0,0x0,0x0
.long 0x0,0x0,0x0,0x0,0x0,0x0,0x0,0x0
.long 0x0,0x0,0x0,0x0,0x0,0x0,0x0,0x0
.long 0x0,0x0,0x0,0x0,0x0,0x0,0x0,0x0
.long 0x0,0x0,0x0,0x0,0x0,0x0,0x0,0x0
.long 0x0,0x0,0x0,0x0,0x0,0x0,0x0,0x0
.long 0x0,0x0,0x0,0x0,0x3f80,0x0,0x0,0x0
.long 0x3f803f80,0x0,0x0,0x0,0x3f803f80,0x3f80,0x0,0x0
.long 0x3f800000,0x3f803f80,0x0,0x0,0x0,0x3f803f80,0x3f80,0x0
.long 0x3f803f80,0x3f803f80,0x3f803f80,0x3f803f80,0x3f800000,0x3f803f80,0x3f803f80,0x3f803f80
.long 0x0,0x3f803f80,0x3f803f80,0x3f803f80,0x0,0x3f800000,0x3f803f80,0x3f803f80
.long 0x0,0x0,0x3f803f80,0x3f803f80,0x0,0x0,0x3f800000,0x3f803f80
.long 0x0,0x0,0x0,0x3f803f80,0x0,0x0,0x0,0x3f800000
.long 0x0,0x0,0x0,0x0,0x0,0x0,0x0,0x0
.long 0x0,0x0,0x0,0x0,0x0,0x0,0x0,0x0
.long 0x0,0x0,0x0,0x0,0x0,0x0,0x0,0x0
.long 0x0,0x0,0x0,0x0,0x0,0x0,0x0,0x0
.long 0x3f80,0x0,0x0,0x0,0x3f803f80,0x0,0x0,0x0
.long 0x3f803f80,0x3f80,0x0,0x0,0x3f803f80,0x3f803f80,0x0,0x0
.long 0x3f803f80,0x3f803f80,0x3f80,0x0,0x3f803f80,0x3f803f80,0x3f803f80,0x0
.long 0x3f803f80,0x3f803f80,0x3f803f80,0x3f80,0x3f803f80,0x3f803f80,0x3f803f80,0x3f803f80
.long 0x3f803f80,0x3f803f80,0x3f803f80,0x3f803f80,0x3f800000,0x3f803f80,0x3f803f80,0x3f803f80
.long 0x0,0x3f803f80,0x3f803f80,0x3f803f80,0x0,0x3f800000,0x3f803f80,0x3f803f80
.long 0x0,0x0,0x3f803f80,0x3f803f80,0x0,0x0,0x3f800000,0x3f803f80
.long 0x0,0x0,0x0,0x3f803f80,0x0,0x0,0x0,0x3f800000
.long 0x0,0x0,0x0,0x0,0x0,0x0,0x0,0x0
.long 0x0,0x0,0x0,0x0,0x0,0x0,0x0,0x0
.long 0x0,0x0,0x0,0x0,0x0,0x0,0x0,0x0
.long 0x0,0x0,0x0,0x0,0x0,0x0,0x0,0x0
.long 0x3f80,0x0,0x0,0x0,0x3f803f80,0x0,0x0,0x0
.long 0x3f803f80,0x3f80,0x0,0x0,0x3f803f80,0x3f803f80,0x0,0x0
.long 0x3f803f80,0x3f803f80,0x3f80,0x0,0x3f803f80,0x3f803f80,0x3f803f80,0x0
.long 0x3f803f80,0x3f803f80,0x3f803f80,0x3f80,0x3f803f80,0x3f803f80,0x3f803f80,0x3f803f80
.long 0x0,0x0,0x0,0x0,0x0,0x0,0x0,0x0
.long 0x0,0x0,0x0,0x0,0x0,0x0,0x0,0x0
.long 0x0,0x0,0x0,0x0,0x0,0x0,0x0,0x0
.long 0x0,0x0,0x0,0x0,0x0,0x0,0x0,0x0
.long 0x0,0x0,0x0,0x0,0x0,0x0,0x0,0x0
.long 0x0,0x0,0x0,0x0,0x0,0x0,0x0,0x0
.long 0x0,0x0,0x0,0x0,0x0,0x0,0x0,0x0
.long 0x0,0x0,0x0,0x0,0x0,0x0,0x0,0x0
.long 0x0,0x0,0x0,0x0,0x0,0x0,0x0,0x0
.long 0x0,0x0,0x0,0x0,0x0,0x0,0x0,0x0
.long 0x0,0x0,0x0,0x0,0x0,0x0,0x0,0x0
.long 0x0,0x0,0x0,0x0,0x0,0x0,0x0,0x0
.long 0x0,0x0,0x0,0x0,0x0,0x0,0x0,0x0
.long 0x0,0x0,0x0,0x0,0x0,0x0,0x0,0x0
.long 0x0,0x0,0x0,0x0,0x0,0x0,0x0,0x0
.long 0x0,0x0,0x0,0x0,0x0,0x0,0x0,0x0
.long 0x3f800000,0x3f803f80,0x3f803f80,0x3f803f80,0x0,0x3f803f80,0x3f803f80,0x3f803f80
.long 0x0,0x3f800000,0x3f803f80,0x3f803f80,0x0,0x0,0x3f803f80,0x3f803f80
.long 0x0,0x0,0x3f800000,0x3f803f80,0x0,0x0,0x0,0x3f803f80
.long 0x0,0x0,0x0,0x3f800000,0x0,0x0,0x0,0x0
.long 0x0,0x0,0x0,0x0,0x0,0x0,0x0,0x0
.long 0x0,0x0,0x0,0x0,0x0,0x0,0x0,0x0
.long 0x0,0x0,0x0,0x0,0x0,0x0,0x0,0x0
.long 0x0,0x0,0x0,0x0,0x0,0x0,0x0,0x0
.long 0x0,0x0,0x0,0x0,0x3f80,0x0,0x0,0x0
.long 0x3f803f80,0x0,0x0,0x0,0x3f803f80,0x3f80,0x0,0x0
.long 0x3f803f80,0x3f803f80,0x0,0x0,0x3f803f80,0x3f803f80,0x3f80,0x0
.long 0x3f803f80,0x3f803f80,0x3f803f80,0x0,0x3f803f80,0x3f803f80,0x3f803f80,0x3f80
.long 0x3f800000,0x3f803f80,0x3f803f80,0x3f803f80,0x0,0x3f803f80,0x3f803f80,0x3f803f80
.long 0x0,0x3f800000,0x3f803f80,0x3f803f80,0x0,0x0,0x3f803f80,0x3f803f80
.long 0x0,0x0,0x3f800000,0x3f803f80,0x0,0x0,0x0,0x3f803f80
.long 0x0,0x0,0x0,0x3f800000,0x0,0x0,0x0,0x0
.long 0x0,0x0,0x0,0x0,0x0,0x0,0x0,0x0
.long 0x0,0x0,0x0,0x0,0x0,0x0,0x0,0x0
.long 0x0,0x0,0x0,0x0,0x0,0x0,0x0,0x0
.long 0x0,0x0,0x0,0x0,0x0,0x0,0x0,0x0
.long 0x0,0x0,0x0,0x0,0x3f80,0x0,0x0,0x0
.long 0x3f803f80,0x0,0x0,0x0,0x3f803f80,0x3f80,0x0,0x0
.long 0x3f803f80,0x3f803f80,0x0,0x0,0x3f803f80,0x3f803f80,0x3f80,0x0
.long 0x3f803f80,0x3f803f80,0x3f803f80,0x0,0x3f803f80,0x3f803f80,0x3f803f80,0x3f80
.long 0x0,0x0,0x0,0x0,0x0,0x0,0x0,0x0
.long 0x0,0x0,0x0,0x0,0x0,0x0,0x0,0x0
.long 0x0,0x0,0x0,0x0,0x0,0x0,0x0,0x0
.long 0x0,0x0,0x0,0x0,0x0,0x0,0x0,0x0
.long 0x0,0x0,0x0,0x0,0x0,0x0,0x0,0x0
.long 0x0,0x0,0x0,0x0,0xffff,0x0,0x0,0x0
.long 0xffffffff,0x0,0x0,0x0,0xffff0000,0xffff,0x0,0x0
.long 0x0,0xffffffff,0x0,0x0,0x0,0xffff0000,0xffff,0x0
.long 0x0,0x0,0x0,0x0,0x0,0x0,0x0,0x0
.long 0x0,0x0,0x0,0x0,0xffff,0x0,0x0,0x0
.long 0xffffffff,0x0,0x0,0x0,0xffff0000,0xffff,0x0,0x0
.long 0x0,0xffffffff,0x0,0x0,0x0,0xffff0000,0xffff,0x0
.long 0x0,0x0,0xffffffff,0x0,0x0,0x0,0xffff0000,0xffff
.long 0x0,0x0,0x0,0xffffffff,0x0,0x0,0x0,0xffff0000
.long 0x0,0x0,0x0,0x0,0x0,0x0,0x0,0x0
.long 0x0,0x0,0x0,0x0,0x0,0x0,0x0,0x0
.long 0x0,0x0,0xffffffff,0x0,0x0,0x0,0xffff0000,0xffff
.long 0x0,0x0,0x0,0xffffffff,0x0,0x0,0x0,0xffff0000
.long 0x0,0x0,0x0,0x0,0x0,0x0,0x0,0x0
.long 0x0,0x0,0x0,0x0,0x0,0x0,0x0,0x0
.long 0x0,0x0,0x0,0x0,0x0,0x0,0x0,0x0
.long 0x0,0x0,0x0,0x0,0x0,0x0,0x0,0x0
.long 0x0,0x0,0x0,0x0,0x0,0x0,0x0,0x0
.long 0x0,0x0,0x0,0x0,0x0,0x0,0x0,0x0
.long 0x0,0x0,0x0,0x0,0x0,0x0,0x0,0x0
.long 0x0,0x0,0x0,0x0,0x0,0x0,0x0,0x0
.long 0x0,0x0,0x0,0x0,0x0,0x0,0x0,0x0
.long 0x0,0x0,0x0,0x0,0x0,0x0,0x0,0x0
.long 0x0,0x0,0x0,0x0,0x0,0x0,0x0,0x0
.long 0x0,0x0,0x0,0x0,0x0,0x0,0x0,0x0
.long 0x0,0x0,0x0,0x0,0x0,0x0,0x0,0x0
.long 0x0,0x0,0x0,0x0,0x0,0x0,0x0,0x0
.long 0x0,0x0,0x0,0x0,0x120,0x0,0x40,0x10
.long 0x240,0x120,0x90,0x20,0x360,0x240,0xd0,0x30
.long 0x480,0x240,0x120,0x40,0x5a0,0x240,0x160,0x50
.long 0x6c0,0x360,0x1b0,0x60,0x7e0,0x480,0x1f0,0x70
.long 0x900,0x480,0x200,0x90,0xa20,0x480,0x240,0x80
.long 0xb40,0x5a0,0x290,0xb0,0xc60,0x6c0,0x2d0,0xa0
.long 0xd80,0x6c0,0x320,0xd0,0xea0,0x6c0,0x360,0xc0
.long 0xfc0,0x7e0,0x3b0,0xf0,0x10e0,0x900,0x3f0,0xe0
.long 0x10,0x10,0x10,0x120,0x130,0x10,0x50,0x130
.long 0x250,0x130,0x80,0x100,0x370,0x250,0xc0,0x110
.long 0x490,0x250,0x130,0x160,0x5b0,0x250,0x170,0x170
.long 0x6d0,0x370,0x1a0,0x140,0x7f0,0x490,0x1e0,0x150
.long 0x910,0x490,0x210,0x1b0,0xa30,0x490,0x250,0x1a0
.long 0xb50,0x5b0,0x280,0x190,0xc70,0x6d0,0x2c0,0x180
.long 0xd90,0x6d0,0x330,0x1f0,0xeb0,0x6d0,0x370,0x1e0
.long 0xfd0,0x7f0,0x3a0,0x1d0,0x10f0,0x910,0x3e0,0x1c0
.long 0x20,0x20,0x20,0x200,0x140,0x20,0x60,0x210
.long 0x260,0x140,0xb0,0x220,0x380,0x260,0xf0,0x230
.long 0x4a0,0x260,0x100,0x240,0x5c0,0x260,0x140,0x250
.long 0x6e0,0x380,0x190,0x260,0x800,0x4a0,0x1d0,0x270
.long 0x920,0x4a0,0x220,0x290,0xa40,0x4a0,0x260,0x280
.long 0xb60,0x5c0,0x2b0,0x2b0,0xc80,0x6e0,0x2f0,0x2a0
.long 0xda0,0x6e0,0x300,0x2d0,0xec0,0x6e0,0x340,0x2c0
.long 0xfe0,0x800,0x390,0x2f0,0x1100,0x920,0x3d0,0x2e0
.long 0x30,0x30,0x30,0x320,0x150,0x30,0x70,0x330
.long 0x270,0x150,0xa0,0x300,0x390,0x270,0xe0,0x310
.long 0x4b0,0x270,0x110,0x360,0x5d0,0x270,0x150,0x370
.long 0x6f0,0x390,0x180,0x340,0x810,0x4b0,0x1c0,0x350
.long 0x930,0x4b0,0x230,0x3b0,0xa50,0x4b0,0x270,0x3a0
.long 0xb70,0x5d0,0x2a0,0x390,0xc90,0x6f0,0x2e0,0x380
.long 0xdb0,0x6f0,0x310,0x3f0,0xed0,0x6f0,0x350,0x3e0
.long 0xff0,0x810,0x380,0x3d0,0x1110,0x930,0x3c0,0x3c0
.long 0xffffffc0,0xe88,0x1530,0x0,0x0,0x9c8,0x1670,0x1200
.long 0x10,0x508,0x1538,0x9000,0x20,0x48,0x1678,0xa200
.long 0x30,0xe80,0x1540,0x12000,0x40,0x9c0,0x1680,0x13200
.long 0x50,0x500,0x1548,0x1b000,0x60,0x40,0x1688,0x1c200
.long 0x70,0xe78,0x1550,0x24000,0x90,0x9b8,0x1690,0x25200
.long 0x80,0x4f8,0x1558,0x2d000,0xb0,0x38,0x1698,0x2e200
.long 0xa0,0xe70,0x1560,0x36000,0xd0,0x9b0,0x16a0,0x37200
.long 0xc0,0x4f0,0x1568,0x3f000,0xf0,0x30,0x16a8,0x40200
.long 0xe0,0xe78,0x1520,0x48000,0x120,0x9b8,0x1660,0x49200
.long 0x130,0x4f8,0x1528,0x51000,0x100,0x38,0x1668,0x52200
.long 0x110,0xe70,0x1530,0x5a000,0x160,0x9b0,0x1670,0x5b200
.long 0x170,0x4f0,0x1538,0x63000,0x140,0x30,0x1678,0x64200
.long 0x150,0xe68,0x1540,0x6c000,0x1b0,0x9a8,0x1680,0x6d200
.long 0x1a0,0x4e8,0x1548,0x75000,0x190,0x28,0x1688,0x76200
.long 0x180,0xe60,0x1550,0x7e000,0x1f0,0x9a0,0x1690,0x7f200
.long 0x1e0,0x4e0,0x1558,0x87000,0x1d0,0x20,0x1698,0x88200
.long 0x1c0,0xe68,0x1510,0x2400,0x200,0x9a8,0x1650,0x3600
.long 0x210,0x4e8,0x1518,0xb400,0x220,0x28,0x1658,0xc600
.long 0x230,0xe60,0x1520,0x14400,0x240,0x9a0,0x1660,0x15600
.long 0x250,0x4e0,0x1528,0x1d400,0x260,0x20,0x1668,0x1e600
.long 0x270,0xe58,0x1530,0x26400,0x290,0x998,0x1670,0x27600
.long 0x280,0x4d8,0x1538,0x2f400,0x2b0,0x18,0x1678,0x30600
.long 0x2a0,0xe50,0x1540,0x38400,0x2d0,0x990,0x1680,0x39600
.long 0x2c0,0x4d0,0x1548,0x41400,0x2f0,0x10,0x1688,0x42600
.long 0x2e0,0xe58,0x1500,0x4a400,0x320,0x998,0x1640,0x4b600
.long 0x330,0x4d8,0x1508,0x53400,0x300,0x18,0x1648,0x54600
.long 0x310,0xe50,0x1510,0x5c400,0x360,0x990,0x1650,0x5d600
.long 0x370,0x4d0,0x1518,0x65400,0x340,0x10,0x1658,0x66600
.long 0x350,0xe48,0x1520,0x6e400,0x3b0,0x988,0x1660,0x6f600
.long 0x3a0,0x4c8,0x1528,0x77400,0x390,0x8,0x1668,0x78600
.long 0x380,0xe40,0x1530,0x80400,0x3f0,0x980,0x1670,0x81600
.long 0x3e0,0x4c0,0x1538,0x89400,0x3d0,0x0,0x1678,0x8a600
.long 0x400000,0x0,0x0,0x0,0x0,0x1,0x0,0x90
.long 0xd,0x0,0x0,0xd0,0x0,0x0,0x0,0x0
.long 0x400100,0x0,0x0,0x0,0x0,0x1,0x8,0x90
.long 0xd,0x1210,0x0,0xd0,0x1210,0x0,0x0,0x0
.long 0x400200,0x4ad0,0x0,0x1,0x4800,0x1,0x0,0xffffff70
.long 0xd,0x1c0,0x2d08,0xd0,0x24200,0x0,0x0,0x0
.long 0x400300,0x4ad0,0x0,0x1,0x0,0x1,0x8,0xffffff70
.long 0xd,0x13d0,0x2c78,0xd0,0x25410,0x0,0x0,0x0
.long 0x400400,0x0,0x0,0x0,0x0,0x1,0x0,0x90
.long 0xd,0x90,0x0,0xd0,0x48400,0x0,0x0,0x0
.long 0x400500,0x0,0x0,0x0,0x0,0x1,0x8,0x90
.long 0xd,0x12a0,0x0,0xd0,0x49610,0x0,0x0,0x0
.long 0x400600,0x4ad0,0x0,0x1,0x4800,0x1,0x0,0xffffff70
.long 0xd,0x130,0x2d08,0xd0,0x6c600,0x0,0x0,0x0
.long 0x400700,0x4ad0,0x0,0x1,0x0,0x1,0x8,0xffffff70
.long 0xd,0x1340,0x2c78,0xd0,0x6d810,0x0,0x0,0x0
.long 0x400800,0x0,0x0,0x0,0x0,0x1,0x0,0x90
.long 0xd,0x120,0x0,0xd0,0x90800,0x0,0x0,0x0
.long 0x400900,0x0,0x0,0x0,0x0,0x1,0x8,0x90
.long 0xd,0x1330,0x0,0xd0,0x91a10,0x0,0x0,0x0
.long 0x400a00,0x4ad0,0x0,0x1,0x4800,0x1,0x0,0xffffff70
.long 0xd,0xa0,0x2d08,0xd0,0xb4a00,0x0,0x0,0x0
.long 0x400b00,0x4ad0,0x0,0x1,0x0,0x1,0x8,0xffffff70
.long 0xd,0x12b0,0x2c78,0xd0,0xb5c10,0x0,0x0,0x0
.long 0x400c00,0x0,0x0,0x0,0x0,0x1,0x0,0x90
.long 0xd,0x1b0,0x0,0xd0,0xd8c00,0x0,0x0,0x0
.long 0x400d00,0x0,0x0,0x0,0x0,0x1,0x8,0x90
.long 0xd,0x13c0,0x0,0xd0,0xd9e10,0x0,0x0,0x0
.long 0x400e00,0x4ad0,0x0,0x1,0x4800,0x1,0x0,0xffffff70
.long 0xd,0x10,0x2d08,0xd0,0xfce00,0x0,0x0,0x0
.long 0x400f00,0x4ad0,0x0,0x1,0x0,0x1,0x8,0xffffff70
.long 0xd,0x1220,0x2c78,0xd0,0xfe010,0x0,0x0,0x0
.long 0x401000,0x0,0x1,0x0,0x0,0x0,0x1,0x90
.long 0xc,0x240,0x2,0xc0,0x242,0x0,0x0,0x0
.long 0x4010c0,0x4ad0,0x0,0x0,0x0,0x0,0x1,0x90
.long 0xc,0x250,0xa,0xc0,0x24442,0x0,0x0,0x0
.long 0x401180,0x0,0x1,0x1,0x0,0x0,0x1,0xffffff70
.long 0xc,0x23a0,0x2c78,0xc0,0x21de,0x0,0x0,0x0
.long 0x401240,0x4ad0,0x0,0x1,0x0,0x0,0x1,0xffffff70
.long 0xc,0x2390,0x2c70,0xc0,0x263de,0x0,0x0,0x0
.long 0x401300,0x0,0x0,0x0,0x0,0x0,0x1,0x90
.long 0xc,0x2d0,0x2,0xc0,0x48642,0x0,0x0,0x0
.long 0x4013c0,0x4ad0,0x0,0x0,0x0,0x0,0x1,0x90
.long 0xc,0x2e0,0xa,0xc0,0x6c842,0x0,0x0,0x0
.long 0x401480,0x0,0x0,0x1,0x0,0x0,0x1,0xffffff70
.long 0xc,0x2310,0x2c78,0xc0,0x4a5de,0x0,0x0,0x0
.long 0x401540,0x4ad0,0x0,0x1,0x0,0x0,0x1,0xffffff70
.long 0xc,0x2300,0x2c70,0xc0,0x6e7de,0x0,0x0,0x0
.long 0x401600,0x0,0x0,0x0,0x0,0x0,0x1,0x90
.long 0xc,0x360,0x2,0xc0,0x90a42,0x0,0x0,0x0
.long 0x4016c0,0x4ad0,0x0,0x0,0x0,0x0,0x1,0x90
.long 0xc,0x370,0xa,0xc0,0xb4c42,0x0,0x0,0x0
.long 0x401780,0x0,0x0,0x1,0x0,0x0,0x1,0xffffff70
.long 0xc,0x2280,0x2c78,0xc0,0x929de,0x0,0x0,0x0
.long 0x401840,0x4ad0,0x0,0x1,0x0,0x0,0x1,0xffffff70
.long 0xc,0x2270,0x2c70,0xc0,0xb6bde,0x0,0x0,0x0
.long 0x401900,0x0,0x0,0x0,0x0,0x0,0x1,0x90
.long 0xc,0x3f0,0x2,0xc0,0xd8e42,0x0,0x0,0x0
.long 0x4019c0,0x4ad0,0x0,0x0,0x0,0x0,0x1,0x90
.long 0xc,0x400,0xa,0xc0,0xfd042,0x0,0x0,0x0
.long 0x401a80,0x0,0x0,0x1,0x0,0x0,0x1,0xffffff70
.long 0xc,0x21f0,0x2c78,0xc0,0xdadde,0x0,0x0,0x0
.long 0x401b40,0x4ad0,0x0,0x1,0x0,0x0,0x1,0xffffff70
.long 0xc,0x21e0,0x2c70,0xc0,0xfefde,0x0,0x0,0x0
.long 0x401c00,0x0,0x1,0x0,0x0,0x0,0x2,0x90
.long 0xc,0x480,0x4,0xc0,0x484,0x0,0x0,0x0
.long 0x401cc0,0x4ad0,0x0,0x0,0x0,0x0,0x2,0x90
.long 0xc,0x490,0xc,0xc0,0x24684,0x0,0x0,0x0
.long 0x401d80,0x0,0x1,0x1,0x0,0x0,0x2,0xffffff70
.long 0xc,0x2160,0x2c76,0xc0,0x1f9c,0x0,0x0,0x0
.long 0x401e40,0x4ad0,0x0,0x1,0x0,0x0,0x2,0xffffff70
.long 0xc,0x2140,0x2c7e,0xc0,0x2619c,0x0,0x0,0x0
.long 0x401f00,0x0,0x0,0x0,0x0,0x0,0x2,0x90
.long 0xc,0x510,0x4,0xc0,0x48884,0x0,0x0,0x0
.long 0x401fc0,0x4ad0,0x0,0x0,0x0,0x0,0x2,0x90
.long 0xc,0x520,0xc,0xc0,0x6ca84,0x0,0x0,0x0
.long 0x402080,0x0,0x0,0x1,0x0,0x0,0x2,0xffffff70
.long 0xc,0x20d0,0x2c76,0xc0,0x4a39c,0x0,0x0,0x0
.long 0x402140,0x4ad0,0x0,0x1,0x0,0x0,0x2,0xffffff70
.long 0xc,0x20b0,0x2c7e,0xc0,0x6e59c,0x0,0x0,0x0
.long 0x402200,0x0,0x0,0x0,0x0,0x0,0x2,0x90
.long 0xc,0x5a0,0x4,0xc0,0x90c84,0x0,0x0,0x0
.long 0x4022c0,0x4ad0,0x0,0x0,0x0,0x0,0x2,0x90
.long 0xc,0x5b0,0xc,0xc0,0xb4e84,0x0,0x0,0x0
.long 0x402380,0x0,0x0,0x1,0x0,0x0,0x2,0xffffff70
.long 0xc,0x2040,0x2c76,0xc0,0x9279c,0x0,0x0,0x0
.long 0x402440,0x4ad0,0x0,0x1,0x0,0x0,0x2,0xffffff70
.long 0xc,0x2020,0x2c7e,0xc0,0xb699c,0x0,0x0,0x0
.long 0x402500,0x0,0x0,0x0,0x0,0x0,0x2,0x90
.long 0xc,0x630,0x4,0xc0,0xd9084,0x0,0x0,0x0
.long 0x4025c0,0x4ad0,0x0,0x0,0x0,0x0,0x2,0x90
.long 0xc,0x640,0xc,0xc0,0xfd284,0x0,0x0,0x0
.long 0x402680,0x0,0x0,0x1,0x0,0x0,0x2,0xffffff70
.long 0xc,0x1fb0,0x2c76,0xc0,0xdab9c,0x0,0x0,0x0
.long 0x402740,0x4ad0,0x0,0x1,0x0,0x0,0x2,0xffffff70
.long 0xc,0x1f90,0x2c7e,0xc0,0xfed9c,0x0,0x0,0x0
.long 0x402800,0x0,0x1,0x0,0x0,0x0,0x3,0x90
.long 0xc,0x6c0,0x6,0xc0,0x6c6,0x0,0x0,0x0
.long 0x4028c0,0x4ad0,0x0,0x0,0x0,0x0,0x3,0x90
.long 0xc,0x6d0,0xe,0xc0,0x248c6,0x0,0x0,0x0
.long 0x402980,0x0,0x1,0x1,0x0,0x0,0x3,0xffffff70
.long 0xc,0x1f20,0x2c74,0xc0,0x1d5a,0x0,0x0,0x0
.long 0x402a40,0x4ad0,0x0,0x1,0x0,0x0,0x3,0xffffff70
.long 0xc,0x1f00,0x2c7c,0xc0,0x25f5a,0x0,0x0,0x0
.long 0x402b00,0x0,0x0,0x0,0x0,0x0,0x3,0x90
.long 0xc,0x750,0x6,0xc0,0x48ac6,0x0,0x0,0x0
.long 0x402bc0,0x4ad0,0x0,0x0,0x0,0x0,0x3,0x90
.long 0xc,0x760,0xe,0xc0,0x6ccc6,0x0,0x0,0x0
.long 0x402c80,0x0,0x0,0x1,0x0,0x0,0x3,0xffffff70
.long 0xc,0x1e90,0x2c74,0xc0,0x4a15a,0x0,0x0,0x0
.long 0x402d40,0x4ad0,0x0,0x1,0x0,0x0,0x3,0xffffff70
.long 0xc,0x1e70,0x2c7c,0xc0,0x6e35a,0x0,0x0,0x0
.long 0x402e00,0x0,0x0,0x0,0x0,0x0,0x3,0x90
.long 0xc,0x7e0,0x6,0xc0,0x90ec6,0x0,0x0,0x0
.long 0x402ec0,0x4ad0,0x0,0x0,0x0,0x0,0x3,0x90
.long 0xc,0x7f0,0xe,0xc0,0xb50c6,0x0,0x0,0x0
.long 0x402f80,0x0,0x0,0x1,0x0,0x0,0x3,0xffffff70
.long 0xc,0x1e00,0x2c74,0xc0,0x9255a,0x0,0x0,0x0
.long 0x403040,0x4ad0,0x0,0x1,0x0,0x0,0x3,0xffffff70
.long 0xc,0x1de0,0x2c7c,0xc0,0xb675a,0x0,0x0,0x0
.long 0x403100,0x0,0x0,0x0,0x0,0x0,0x3,0x90
.long 0xc,0x870,0x6,0xc0,0xd92c6,0x0,0x0,0x0
.long 0x4031c0,0x4ad0,0x0,0x0,0x0,0x0,0x3,0x90
.long 0xc,0x880,0xe,0xc0,0xfd4c6,0x0,0x0,0x0
.long 0x403280,0x0,0x0,0x1,0x0,0x0,0x3,0xffffff70
.long 0xc,0x1d70,0x2c74,0xc0,0xda95a,0x0,0x0,0x0
.long 0x403340,0x4ad0,0x0,0x1,0x0,0x0,0x3,0xffffff70
.long 0xc,0x1d50,0x2c7c,0xc0,0xfeb5a,0x0,0x0,0x0
.long 0x403400,0x0,0x1,0x0,0x0,0x0,0x4,0x90
.long 0xc,0x900,0x8,0xc0,0x908,0x0,0x0,0x0
.long 0x4034c0,0x4ad0,0x0,0x0,0x0,0x0,0x4,0x90
.long 0xc,0x920,0x0,0xc0,0x24b08,0x0,0x0,0x0
.long 0x403580,0x0,0x1,0x1,0x0,0x0,0x4,0xffffff70
.long 0xc,0x1ce0,0x2c72,0xc0,0x1b18,0x0,0x0,0x0
.long 0x403640,0x4ad0,0x0,0x1,0x0,0x0,0x4,0xffffff70
.long 0xc,0x1cc0,0x2c7a,0xc0,0x25d18,0x0,0x0,0x0
.long 0x403700,0x0,0x0,0x0,0x0,0x0,0x4,0x90
.long 0xc,0x990,0x8,0xc0,0x48d08,0x0,0x0,0x0
.long 0x4037c0,0x4ad0,0x0,0x0,0x0,0x0,0x4,0x90
.long 0xc,0x9b0,0x0,0xc0,0x6cf08,0x0,0x0,0x0
.long 0x403880,0x0,0x0,0x1,0x0,0x0,0x4,0xffffff70
.long 0xc,0x1c50,0x2c72,0xc0,0x49f18,0x0,0x0,0x0
.long 0x403940,0x4ad0,0x0,0x1,0x0,0x0,0x4,0xffffff70
.long 0xc,0x1c30,0x2c7a,0xc0,0x6e118,0x0,0x0,0x0
.long 0x403a00,0x0,0x0,0x0,0x0,0x0,0x4,0x90
.long 0xc,0xa20,0x8,0xc0,0x91108,0x0,0x0,0x0
.long 0x403ac0,0x4ad0,0x0,0x0,0x0,0x0,0x4,0x90
.long 0xc,0xa40,0x0,0xc0,0xb5308,0x0,0x0,0x0
.long 0x403b80,0x0,0x0,0x1,0x0,0x0,0x4,0xffffff70
.long 0xc,0x1bc0,0x2c72,0xc0,0x92318,0x0,0x0,0x0
.long 0x403c40,0x4ad0,0x0,0x1,0x0,0x0,0x4,0xffffff70
.long 0xc,0x1ba0,0x2c7a,0xc0,0xb6518,0x0,0x0,0x0
.long 0x403d00,0x0,0x0,0x0,0x0,0x0,0x4,0x90
.long 0xc,0xab0,0x8,0xc0,0xd9508,0x0,0x0,0x0
.long 0x403dc0,0x4ad0,0x0,0x0,0x0,0x0,0x4,0x90
.long 0xc,0xad0,0x0,0xc0,0xfd708,0x0,0x0,0x0
.long 0x403e80,0x0,0x0,0x1,0x0,0x0,0x4,0xffffff70
.long 0xc,0x1b30,0x2c72,0xc0,0xda718,0x0,0x0,0x0
.long 0x403f40,0x4ad0,0x0,0x1,0x0,0x0,0x4,0xffffff70
.long 0xc,0x1b10,0x2c7a,0xc0,0xfe918,0x0,0x0,0x0
.long 0x404000,0x0,0x1,0x0,0x0,0x0,0x5,0x90
.long 0xc,0xb40,0xa,0xc0,0xb4a,0x0,0x0,0x0
.long 0x4040c0,0x4ad0,0x0,0x0,0x0,0x0,0x5,0x90
.long 0xc,0xb60,0x2,0xc0,0x24d4a,0x0,0x0,0x0
.long 0x404180,0x0,0x1,0x1,0x0,0x0,0x5,0xffffff70
.long 0xc,0x1aa0,0x2c70,0xc0,0x18d6,0x0,0x0,0x0
.long 0x404240,0x4ad0,0x0,0x1,0x0,0x0,0x5,0xffffff70
.long 0xc,0x1a80,0x2c78,0xc0,0x25ad6,0x0,0x0,0x0
.long 0x404300,0x0,0x0,0x0,0x0,0x0,0x5,0x90
.long 0xc,0xbd0,0xa,0xc0,0x48f4a,0x0,0x0,0x0
.long 0x4043c0,0x4ad0,0x0,0x0,0x0,0x0,0x5,0x90
.long 0xc,0xbf0,0x2,0xc0,0x6d14a,0x0,0x0,0x0
.long 0x404480,0x0,0x0,0x1,0x0,0x0,0x5,0xffffff70
.long 0xc,0x1a10,0x2c70,0xc0,0x49cd6,0x0,0x0,0x0
.long 0x404540,0x4ad0,0x0,0x1,0x0,0x0,0x5,0xffffff70
.long 0xc,0x19f0,0x2c78,0xc0,0x6ded6,0x0,0x0,0x0
.long 0x404600,0x0,0x0,0x0,0x0,0x0,0x5,0x90
.long 0xc,0xc60,0xa,0xc0,0x9134a,0x0,0x0,0x0
.long 0x4046c0,0x4ad0,0x0,0x0,0x0,0x0,0x5,0x90
.long 0xc,0xc80,0x2,0xc0,0xb554a,0x0,0x0,0x0
.long 0x404780,0x0,0x0,0x1,0x0,0x0,0x5,0xffffff70
.long 0xc,0x1980,0x2c70,0xc0,0x920d6,0x0,0x0,0x0
.long 0x404840,0x4ad0,0x0,0x1,0x0,0x0,0x5,0xffffff70
.long 0xc,0x1960,0x2c78,0xc0,0xb62d6,0x0,0x0,0x0
.long 0x404900,0x0,0x0,0x0,0x0,0x0,0x5,0x90
.long 0xc,0xcf0,0xa,0xc0,0xd974a,0x0,0x0,0x0
.long 0x4049c0,0x4ad0,0x0,0x0,0x0,0x0,0x5,0x90
.long 0xc,0xd10,0x2,0xc0,0xfd94a,0x0,0x0,0x0
.long 0x404a80,0x0,0x0,0x1,0x0,0x0,0x5,0xffffff70
.long 0xc,0x18f0,0x2c70,0xc0,0xda4d6,0x0,0x0,0x0
.long 0x404b40,0x4ad0,0x0,0x1,0x0,0x0,0x5,0xffffff70
.long 0xc,0x18d0,0x2c78,0xc0,0xfe6d6,0x0,0x0,0x0
.long 0x404c00,0x0,0x1,0x0,0x0,0x0,0x6,0x90
.long 0xc,0xd80,0xc,0xc0,0xd8c,0x0,0x0,0x0
.long 0x404cc0,0x4ad0,0x0,0x0,0x0,0x0,0x6,0x90
.long 0xc,0xda0,0x4,0xc0,0x24f8c,0x0,0x0,0x0
.long 0x404d80,0x0,0x1,0x1,0x0,0x0,0x6,0xffffff70
.long 0xc,0x1850,0x2c7e,0xc0,0x1694,0x0,0x0,0x0
.long 0x404e40,0x4ad0,0x0,0x1,0x0,0x0,0x6,0xffffff70
.long 0xc,0x1840,0x2c76,0xc0,0x25894,0x0,0x0,0x0
.long 0x404f00,0x0,0x0,0x0,0x0,0x0,0x6,0x90
.long 0xc,0xe10,0xc,0xc0,0x4918c,0x0,0x0,0x0
.long 0x404fc0,0x4ad0,0x0,0x0,0x0,0x0,0x6,0x90
.long 0xc,0xe30,0x4,0xc0,0x6d38c,0x0,0x0,0x0
.long 0x405080,0x0,0x0,0x1,0x0,0x0,0x6,0xffffff70
.long 0xc,0x17c0,0x2c7e,0xc0,0x49a94,0x0,0x0,0x0
.long 0x405140,0x4ad0,0x0,0x1,0x0,0x0,0x6,0xffffff70
.long 0xc,0x17b0,0x2c76,0xc0,0x6dc94,0x0,0x0,0x0
.long 0x405200,0x0,0x0,0x0,0x0,0x0,0x6,0x90
.long 0xc,0xea0,0xc,0xc0,0x9158c,0x0,0x0,0x0
.long 0x4052c0,0x4ad0,0x0,0x0,0x0,0x0,0x6,0x90
.long 0xc,0xec0,0x4,0xc0,0xb578c,0x0,0x0,0x0
.long 0x405380,0x0,0x0,0x1,0x0,0x0,0x6,0xffffff70
.long 0xc,0x1730,0x2c7e,0xc0,0x91e94,0x0,0x0,0x0
.long 0x405440,0x4ad0,0x0,0x1,0x0,0x0,0x6,0xffffff70
.long 0xc,0x1720,0x2c76,0xc0,0xb6094,0x0,0x0,0x0
.long 0x405500,0x0,0x0,0x0,0x0,0x0,0x6,0x90
.long 0xc,0xf30,0xc,0xc0,0xd998c,0x0,0x0,0x0
.long 0x4055c0,0x4ad0,0x0,0x0,0x0,0x0,0x6,0x90
.long 0xc,0xf50,0x4,0xc0,0xfdb8c,0x0,0x0,0x0
.long 0x405680,0x0,0x0,0x1,0x0,0x0,0x6,0xffffff70
.long 0xc,0x16a0,0x2c7e,0xc0,0xda294,0x0,0x0,0x0
.long 0x405740,0x4ad0,0x0,0x1,0x0,0x0,0x6,0xffffff70
.long 0xc,0x1690,0x2c76,0xc0,0xfe494,0x0,0x0,0x0
.long 0x405800,0x0,0x1,0x0,0x0,0x0,0x7,0x90
.long 0xc,0xfc0,0xe,0xc0,0xfce,0x0,0x0,0x0
.long 0x4058c0,0x4ad0,0x0,0x0,0x0,0x0,0x7,0x90
.long 0xc,0xfe0,0x6,0xc0,0x251ce,0x0,0x0,0x0
.long 0x405980,0x0,0x1,0x1,0x0,0x0,0x7,0xffffff70
.long 0xc,0x1610,0x2c7c,0xc0,0x1452,0x0,0x0,0x0
.long 0x405a40,0x4ad0,0x0,0x1,0x0,0x0,0x7,0xffffff70
.long 0xc,0x1600,0x2c74,0xc0,0x25652,0x0,0x0,0x0
.long 0x405b00,0x0,0x0,0x0,0x0,0x0,0x7,0x90
.long 0xc,0x1050,0xe,0xc0,0x493ce,0x0,0x0,0x0
.long 0x405bc0,0x4ad0,0x0,0x0,0x0,0x0,0x7,0x90
.long 0xc,0x1070,0x6,0xc0,0x6d5ce,0x0,0x0,0x0
.long 0x405c80,0x0,0x0,0x1,0x0,0x0,0x7,0xffffff70
.long 0xc,0x1580,0x2c7c,0xc0,0x49852,0x0,0x0,0x0
.long 0x405d40,0x4ad0,0x0,0x1,0x0,0x0,0x7,0xffffff70
.long 0xc,0x1570,0x2c74,0xc0,0x6da52,0x0,0x0,0x0
.long 0x405e00,0x0,0x0,0x0,0x0,0x0,0x7,0x90
.long 0xc,0x10e0,0xe,0xc0,0x917ce,0x0,0x0,0x0
.long 0x405ec0,0x4ad0,0x0,0x0,0x0,0x0,0x7,0x90
.long 0xc,0x1100,0x6,0xc0,0xb59ce,0x0,0x0,0x0
.long 0x405f80,0x0,0x0,0x1,0x0,0x0,0x7,0xffffff70
.long 0xc,0x14f0,0x2c7c,0xc0,0x91c52,0x0,0x0,0x0
.long 0x406040,0x4ad0,0x0,0x1,0x0,0x0,0x7,0xffffff70
.long 0xc,0x14e0,0x2c74,0xc0,0xb5e52,0x0,0x0,0x0
.long 0x406100,0x0,0x0,0x0,0x0,0x0,0x7,0x90
.long 0xc,0x1170,0xe,0xc0,0xd9bce,0x0,0x0,0x0
.long 0x4061c0,0x4ad0,0x0,0x0,0x0,0x0,0x7,0x90
.long 0xc,0x1190,0x6,0xc0,0xfddce,0x0,0x0,0x0
.long 0x406280,0x0,0x0,0x1,0x0,0x0,0x7,0xffffff70
.long 0xc,0x1460,0x2c7c,0xc0,0xda052,0x0,0x0,0x0
.long 0x406340,0x4ad0,0x0,0x1,0x0,0x0,0x7,0xffffff70
.long 0xc,0x1450,0x2c74,0xc0,0xfe252,0x0,0x0,0x0
.long 0x8,0x28,0x60,0xffffffa6,0x10,0x24,0x2,0x34
.long 0x14,0x24,0x32,0x34,0x18,0x28,0x62,0xffffffa6
.long 0x28,0x1c,0x64,0xffffffd4,0x48,0x18,0x68,0xffffffa4
.long 0x50,0x24,0xa,0x34,0x54,0x1c,0x3a,0xffffffd4
.long 0x58,0x28,0x6a,0xffffffa6,0x64,0x24,0x3c,0x34
.long 0x68,0x38,0x6c,0xffffffa8,0x78,0x2c,0x6e,0xffffffd6
.long 0x84,0x24,0x40,0x34,0x90,0x24,0x12,0x34
.long 0x94,0x24,0x42,0x34,0x98,0x18,0x72,0xffffffa4
.long 0x98,0x18,0x72,0xffffffa4,0x98,0x18,0x72,0xffffffa4
.long 0x98,0x18,0x72,0xffffffa4,0x98,0x18,0x72,0xffffffa4
.long 0x4,0x1c,0x30,0xffffffd4,0x4,0x1c,0x30,0xffffffd4
.long 0x0,0x24,0x0,0x34,0x0,0x24,0x0,0x34
.long 0x8,0x28,0x16,0x5a,0x10,0x24,0x74,0xffffffcc
.long 0x14,0x24,0x44,0xffffffcc,0x18,0x28,0x14,0x5a
.long 0x28,0x1c,0x12,0x2c,0x48,0x18,0xe,0x5c
.long 0x50,0x24,0x6c,0xffffffcc,0x54,0x1c,0x3c,0x2c
.long 0x58,0x28,0xc,0x5a,0x64,0x24,0x3a,0xffffffcc
.long 0x68,0x38,0xa,0x58,0x78,0x2c,0x8,0x2a
.long 0x84,0x24,0x36,0xffffffcc,0x90,0x24,0x64,0xffffffcc
.long 0x94,0x24,0x34,0xffffffcc,0x98,0x18,0x4,0x5c
.long 0x98,0x18,0x4,0x5c,0x98,0x18,0x4,0x5c
.long 0x98,0x18,0x4,0x5c,0x98,0x18,0x4,0x5c
.long 0x4,0x1c,0x46,0x2c,0x4,0x1c,0x46,0x2c
.long 0x0,0x24,0x76,0xffffffcc,0x0,0x24,0x76,0xffffffcc
.long 0x8,0x28,0x60,0xffffffa6,0x10,0x24,0x2,0x34
.long 0x14,0x24,0x32,0x34,0x18,0x28,0x62,0xffffffa6
.long 0x28,0x1c,0x64,0xffffffd4,0x48,0x18,0x68,0xffffffa4
.long 0x50,0x24,0xa,0x34,0x54,0x1c,0x3a,0xffffffd4
.long 0x58,0x28,0x6a,0xffffffa6,0x64,0x24,0x3c,0x34
.long 0x68,0x1c,0x6c,0xffffffd4,0x78,0x28,0x6e,0xffffffa6
.long 0x90,0x24,0x12,0x34,0x94,0x24,0x42,0x34
.long 0x98,0x18,0x72,0xffffffa4,0xa4,0x1c,0x44,0xffffffd4
.long 0xc8,0x0,0x78,0x0,0xc8,0x0,0x78,0x0
.long 0xa8,0x1c,0x74,0xffffffd4,0xa8,0x1c,0x74,0xffffffd4
.long 0x4,0x1c,0x30,0xffffffd4,0x4,0x1c,0x30,0xffffffd4
.long 0x0,0x24,0x0,0x34,0x0,0x24,0x0,0x34
.long 0x8,0x28,0x18,0x5a,0x10,0x24,0x76,0xffffffcc
.long 0x14,0x24,0x46,0xffffffcc,0x18,0x28,0x16,0x5a
.long 0x28,0x1c,0x14,0x2c,0x48,0x18,0x10,0x5c
.long 0x50,0x24,0x6e,0xffffffcc,0x54,0x1c,0x3e,0x2c
.long 0x58,0x28,0xe,0x5a,0x64,0x24,0x3c,0xffffffcc
.long 0x68,0x1c,0xc,0x2c,0x78,0x28,0xa,0x5a
.long 0x90,0x24,0x66,0xffffffcc,0x94,0x24,0x36,0xffffffcc
.long 0x98,0x18,0x6,0x5c,0xa4,0x1c,0x34,0x2c
.long 0xc8,0x0,0x0,0x0,0xc8,0x0,0x0,0x0
.long 0xa8,0x1c,0x4,0x2c,0xa8,0x1c,0x4,0x2c
.long 0x4,0x1c,0x48,0x2c,0x4,0x1c,0x48,0x2c
.long 0x0,0x24,0x78,0xffffffcc,0x0,0x24,0x78,0xffffffcc
.size L_tab, 48640
L_A2:
    s_mov_b32 s3, 0x3fb8aa3b
    s_mov_b32 s4, 0xffff0000
    v_lshlrev_b32 v164, 16, v164
    v_lshlrev_b32 v160, 16, v160
    v_lshlrev_b32 v162, 16, v162
    v_lshlrev_b32 v163, 16, v163
    v_lshlrev_b32 v161, 16, v161
    v_lshlrev_b32 v9, 16, v9
    v_mul_f32 v164, s3, v164
    v_mul_f32 v160, s3, v160
    v_max_f32_e64 v165, |v162|, |v163|
    v_exp_f32 v164, v164
    v_exp_f32 v160, v160
    v_max_f32_dpp v165, v165, v165 row_shr:1 row_mask:0xf bank_mask:0xf
    v_cvt_pk_bf16_f32 v164, v164, v164
    v_cvt_pk_bf16_f32 v160, v160, v160
    v_max_f32_dpp v165, v165, v165 row_shr:2 row_mask:0xf bank_mask:0xf
    v_and_b32 v164, s4, v164
    v_and_b32 v160, s4, v160
    v_max_f32_dpp v165, v165, v165 row_shr:4 row_mask:0xf bank_mask:0xf
    v_mul_f32 v160, v160, v164
    v_mul_f32 v161, v161, v164
    v_max_f32_dpp v165, v165, v165 row_shr:8 row_mask:0xf bank_mask:0xf
    v_mul_f32 v148, 0xbfb8aa3b, v160
    v_mul_f32 v150, 0.15915494, v161
    v_max_f32_dpp v165, v165, v165 row_bcast:15 row_mask:0xa bank_mask:0xf
    v_mul_f32 v149, 0x41800000, v148
    v_mul_f32 v151, 0x41800000, v150
    v_max_f32_dpp v165, v165, v165 row_bcast:31 row_mask:0xc bank_mask:0xf
    v_fract_f32 v150, v150
    v_fract_f32 v151, v151
    v_readlane_b32 s3, v165, 63
    v_exp_f32 v148, v148
    v_exp_f32 v149, v149
    v_cos_f32 v152, v150
    v_cos_f32 v153, v151
    s_and_b32 s3, s3, 0x7f800000
    s_max_u32 s3, s3, 0x01000000
    s_min_u32 s3, s3, 0x7e000000
    s_sub_u32 s4, 0x7f000000, s3
    v_sin_f32 v154, v150
    v_sin_f32 v155, v151
    v_add_f32 v164, v164, v164
    v_mul_f32 v162, s4, v162
    v_mul_f32 v163, s4, v163
    v_mul_f32 v166, s3, v164
    v_mul_f32 v167, s3, v164
    .p2align 3
    v_pk_mul_f32 v[112:113], v[148:149], v[152:153]
    v_pk_mul_f32 v[114:115], v[148:149], v[154:155]
    v_cvt_pk_f16_f32 v92, v162, -v163
    v_pk_mul_f32 v[116:117], v[112:113], v[112:113]
    v_pk_mul_f32 v[118:119], v[112:113], v[114:115]
    v_pk_fma_f32 v[116:117], v[114:115], v[114:115], v[116:117] neg_lo:[1,0,0] neg_hi:[1,0,0]
    v_pk_fma_f32 v[118:119], v[114:115], v[112:113], v[118:119]
    v_cvt_pk_f16_f32 v64, v112, v114
    v_cvt_pk_f16_f32 v79, v113, v115
    v_pk_mul_f32 v[124:125], v[116:117], v[116:117]
    v_pk_mul_f32 v[126:127], v[116:117], v[118:119]
    v_pk_mul_f32 v[120:121], v[116:117], v[112:113]
    v_pk_mul_f32 v[122:123], v[116:117], v[114:115]
    v_pk_fma_f32 v[124:125], v[118:119], v[118:119], v[124:125] neg_lo:[1,0,0] neg_hi:[1,0,0]
    v_pk_fma_f32 v[126:127], v[118:119], v[116:117], v[126:127]
    v_pk_fma_f32 v[120:121], v[118:119], v[114:115], v[120:121] neg_lo:[1,0,0] neg_hi:[1,0,0]
    v_pk_fma_f32 v[122:123], v[118:119], v[112:113], v[122:123]
    v_cvt_pk_f16_f32 v65, v116, v118
    v_cvt_pk_f16_f32 v80, v117, v119
    v_pk_mul_f32 v[128:129], v[124:125], v[124:125]
    v_pk_mul_f32 v[130:131], v[124:125], v[126:127]
    v_pk_fma_f32 v[128:129], v[126:127], v[126:127], v[128:129] neg_lo:[1,0,0] neg_hi:[1,0,0]
    v_pk_fma_f32 v[130:131], v[126:127], v[124:125], v[130:131]
    v_cvt_pk_f16_f32 v81, v121, v123
    v_cvt_pk_f16_f32 v82, v125, v127
    v_cvt_pk_f16_f32 v66, v120, v122
    v_cvt_pk_f16_f32 v67, v124, v126
    v_pk_mul_f16 v148, v92, v79 op_sel:[0,0] op_sel_hi:[1,0]
    v_pk_mul_f16 v149, v92, v80 op_sel:[0,0] op_sel_hi:[1,0]
    v_pk_mul_f16 v150, v92, v81 op_sel:[0,0] op_sel_hi:[1,0]
    v_pk_mul_f16 v93, v92, v82 op_sel:[0,0] op_sel_hi:[1,0]
    v_pk_fma_f16 v148, v92, v79, v148 op_sel:[1,1,0] op_sel_hi:[0,1,1] neg_hi:[1,0,0]
    v_pk_fma_f16 v149, v92, v80, v149 op_sel:[1,1,0] op_sel_hi:[0,1,1] neg_hi:[1,0,0]
    v_pk_fma_f16 v150, v92, v81, v150 op_sel:[1,1,0] op_sel_hi:[0,1,1] neg_hi:[1,0,0]
    v_pk_fma_f16 v93, v92, v82, v93 op_sel:[1,1,0] op_sel_hi:[0,1,1] neg_hi:[1,0,0]
    v_pk_mul_f32 v[132:133], v[128:129], v[124:125]
    v_pk_mul_f32 v[134:135], v[128:129], v[126:127]
    v_pk_mul_f32 v[136:137], v[128:129], v[128:129]
    v_pk_mul_f32 v[138:139], v[128:129], v[130:131]
    v_pk_fma_f32 v[132:133], v[130:131], v[126:127], v[132:133] neg_lo:[1,0,0] neg_hi:[1,0,0]
    v_pk_fma_f32 v[134:135], v[130:131], v[124:125], v[134:135]
    v_pk_fma_f32 v[136:137], v[130:131], v[130:131], v[136:137] neg_lo:[1,0,0] neg_hi:[1,0,0]
    v_pk_fma_f32 v[138:139], v[130:131], v[128:129], v[138:139]
    v_cvt_pk_f16_f32 v83, v129, v131
    v_cvt_pk_f16_f32 v71, v128, v130
    ds_write_addtid_b32 v92 offset:0
    ds_write_addtid_b32 v148 offset:288
    ds_write_addtid_b32 v149 offset:576
    ds_write_addtid_b32 v150 offset:864
    v_pk_mul_f16 v151, v93, v79 op_sel:[0,0] op_sel_hi:[1,0]
    v_pk_mul_f16 v152, v93, v80 op_sel:[0,0] op_sel_hi:[1,0]
    v_pk_mul_f16 v153, v93, v81 op_sel:[0,0] op_sel_hi:[1,0]
    v_pk_mul_f16 v94, v92, v83 op_sel:[0,0] op_sel_hi:[1,0]
    v_pk_fma_f16 v151, v93, v79, v151 op_sel:[1,1,0] op_sel_hi:[0,1,1] neg_hi:[1,0,0]
    v_pk_fma_f16 v152, v93, v80, v152 op_sel:[1,1,0] op_sel_hi:[0,1,1] neg_hi:[1,0,0]
    v_pk_fma_f16 v153, v93, v81, v153 op_sel:[1,1,0] op_sel_hi:[0,1,1] neg_hi:[1,0,0]
    v_pk_fma_f16 v94, v92, v83, v94 op_sel:[1,1,0] op_sel_hi:[0,1,1] neg_hi:[1,0,0]
    v_cvt_pk_f16_f32 v84, v133, v135
    v_cvt_pk_f16_f32 v75, v132, v134
    v_cvt_pk_f16_f32 v85, v137, v139
    ds_write_addtid_b32 v93 offset:1152
    ds_write_addtid_b32 v151 offset:1440
    ds_write_addtid_b32 v152 offset:1728
    ds_write_addtid_b32 v153 offset:2016
    v_pk_mul_f16 v154, v94, v79 op_sel:[0,0] op_sel_hi:[1,0]
    v_pk_mul_f16 v155, v94, v80 op_sel:[0,0] op_sel_hi:[1,0]
    v_pk_mul_f16 v156, v94, v81 op_sel:[0,0] op_sel_hi:[1,0]
    v_pk_mul_f16 v95, v92, v84 op_sel:[0,0] op_sel_hi:[1,0]
    v_pk_fma_f16 v154, v94, v79, v154 op_sel:[1,1,0] op_sel_hi:[0,1,1] neg_hi:[1,0,0]
    v_pk_fma_f16 v155, v94, v80, v155 op_sel:[1,1,0] op_sel_hi:[0,1,1] neg_hi:[1,0,0]
    v_pk_fma_f16 v156, v94, v81, v156 op_sel:[1,1,0] op_sel_hi:[0,1,1] neg_hi:[1,0,0]
    v_pk_fma_f16 v95, v92, v84, v95 op_sel:[1,1,0] op_sel_hi:[0,1,1] neg_hi:[1,0,0]
    v_pk_mul_f32 v[140:141], v[136:137], v[136:137]
    v_pk_mul_f32 v[142:143], v[136:137], v[138:139]
    v_pk_fma_f32 v[140:141], v[138:139], v[138:139], v[140:141] neg_lo:[1,0,0] neg_hi:[1,0,0]
    v_pk_fma_f32 v[142:143], v[138:139], v[136:137], v[142:143]
    ds_write_addtid_b32 v94 offset:2304
    ds_write_addtid_b32 v154 offset:2592
    ds_write_addtid_b32 v155 offset:2880
    ds_write_addtid_b32 v156 offset:3168
    v_pk_mul_f16 v157, v95, v79 op_sel:[0,0] op_sel_hi:[1,0]
    v_pk_mul_f16 v158, v95, v80 op_sel:[0,0] op_sel_hi:[1,0]
    v_pk_mul_f16 v159, v95, v81 op_sel:[0,0] op_sel_hi:[1,0]
    v_pk_fma_f16 v157, v95, v79, v157 op_sel:[1,1,0] op_sel_hi:[0,1,1] neg_hi:[1,0,0]
    v_pk_fma_f16 v158, v95, v80, v158 op_sel:[1,1,0] op_sel_hi:[0,1,1] neg_hi:[1,0,0]
    v_pk_fma_f16 v159, v95, v81, v159 op_sel:[1,1,0] op_sel_hi:[0,1,1] neg_hi:[1,0,0]
    v_pk_mul_f32 v[144:145], v[140:141], v[140:141]
    v_pk_mul_f32 v[146:147], v[140:141], v[142:143]
    v_pk_fma_f32 v[144:145], v[142:143], v[142:143], v[144:145] neg_lo:[1,0,0] neg_hi:[1,0,0]
    v_pk_fma_f32 v[146:147], v[142:143], v[140:141], v[146:147]
    ds_write_addtid_b32 v95 offset:3456
    ds_write_addtid_b32 v157 offset:3744
    ds_write_addtid_b32 v158 offset:4032
    ds_write_addtid_b32 v159 offset:4320
    ds_read_b128 v[96:99], v10 offset:0
    ds_read_b128 v[100:103], v10 offset:64
    ds_read_b128 v[104:107], v10 offset:128
    ds_read_b128 v[108:111], v10 offset:192
    s_cmp_eq_u32 s34, 1
    s_cbranch_scc0 L_A_g1
    global_load_dwordx3 v[44:46], v39, s[8:9] offset:3456
L_A_g1:
    v_mov_b32 v160, 0x3c00
    v_pk_mul_f16 v68, v67, v64 op_sel:[0,0] op_sel_hi:[1,0]
    v_pk_mul_f16 v69, v67, v65 op_sel:[0,0] op_sel_hi:[1,0]
    v_pk_mul_f16 v70, v67, v66 op_sel:[0,0] op_sel_hi:[1,0]
    v_pk_fma_f16 v68, v67, v64, v68 op_sel:[1,1,0] op_sel_hi:[0,1,1] neg_lo:[1,0,0]
    v_pk_fma_f16 v69, v67, v65, v69 op_sel:[1,1,0] op_sel_hi:[0,1,1] neg_lo:[1,0,0]
    v_pk_fma_f16 v70, v67, v66, v70 op_sel:[1,1,0] op_sel_hi:[0,1,1] neg_lo:[1,0,0]
    v_cvt_pk_f16_f32 v86, v141, v143
    v_cvt_pk_f16_f32 v87, v145, v147
    ds_write_addtid_b32 v160 offset:0
    ds_write_addtid_b32 v64 offset:288
    ds_write_addtid_b32 v65 offset:576
    ds_write_addtid_b32 v66 offset:864
    v_pk_mul_f16 v72, v71, v64 op_sel:[0,0] op_sel_hi:[1,0]
    v_pk_mul_f16 v73, v71, v65 op_sel:[0,0] op_sel_hi:[1,0]
    v_pk_mul_f16 v74, v71, v66 op_sel:[0,0] op_sel_hi:[1,0]
    v_pk_mul_f16 v88, v86, v85 op_sel:[0,0] op_sel_hi:[1,0]
    v_pk_fma_f16 v72, v71, v64, v72 op_sel:[1,1,0] op_sel_hi:[0,1,1] neg_lo:[1,0,0]
    v_pk_fma_f16 v73, v71, v65, v73 op_sel:[1,1,0] op_sel_hi:[0,1,1] neg_lo:[1,0,0]
    v_pk_fma_f16 v74, v71, v66, v74 op_sel:[1,1,0] op_sel_hi:[0,1,1] neg_lo:[1,0,0]
    v_pk_fma_f16 v88, v86, v85, v88 op_sel:[1,1,0] op_sel_hi:[0,1,1] neg_lo:[1,0,0]
    ds_write_addtid_b32 v67 offset:1152
    ds_write_addtid_b32 v68 offset:1440
    ds_write_addtid_b32 v69 offset:1728
    ds_write_addtid_b32 v70 offset:2016
    v_pk_mul_f16 v76, v75, v64 op_sel:[0,0] op_sel_hi:[1,0]
    v_pk_mul_f16 v77, v75, v65 op_sel:[0,0] op_sel_hi:[1,0]
    v_pk_mul_f16 v78, v75, v66 op_sel:[0,0] op_sel_hi:[1,0]
    v_pk_mul_f16 v89, v87, v85 op_sel:[0,0] op_sel_hi:[1,0]
    v_pk_fma_f16 v76, v75, v64, v76 op_sel:[1,1,0] op_sel_hi:[0,1,1] neg_lo:[1,0,0]
    v_pk_fma_f16 v77, v75, v65, v77 op_sel:[1,1,0] op_sel_hi:[0,1,1] neg_lo:[1,0,0]
    v_pk_fma_f16 v78, v75, v66, v78 op_sel:[1,1,0] op_sel_hi:[0,1,1] neg_lo:[1,0,0]
    v_pk_fma_f16 v89, v87, v85, v89 op_sel:[1,1,0] op_sel_hi:[0,1,1] neg_lo:[1,0,0]
    ds_write_addtid_b32 v71 offset:2304
    ds_write_addtid_b32 v72 offset:2592
    ds_write_addtid_b32 v73 offset:2880
    ds_write_addtid_b32 v74 offset:3168
    v_pk_mul_f16 v148, v85, v65 op_sel:[0,0] op_sel_hi:[1,0]
    v_pk_mul_f16 v149, v85, v67 op_sel:[0,0] op_sel_hi:[1,0]
    v_pk_mul_f16 v150, v85, v69 op_sel:[0,0] op_sel_hi:[1,0]
    v_pk_mul_f16 v151, v85, v71 op_sel:[0,0] op_sel_hi:[1,0]
    v_pk_fma_f16 v148, v85, v65, v148 op_sel:[1,1,0] op_sel_hi:[0,1,1] neg_lo:[1,0,0]
    v_pk_fma_f16 v149, v85, v67, v149 op_sel:[1,1,0] op_sel_hi:[0,1,1] neg_lo:[1,0,0]
    v_pk_fma_f16 v150, v85, v69, v150 op_sel:[1,1,0] op_sel_hi:[0,1,1] neg_lo:[1,0,0]
    v_pk_fma_f16 v151, v85, v71, v151 op_sel:[1,1,0] op_sel_hi:[0,1,1] neg_lo:[1,0,0]
    ds_write_addtid_b32 v75 offset:3456
    ds_write_addtid_b32 v76 offset:3744
    ds_write_addtid_b32 v77 offset:4032
    ds_write_addtid_b32 v78 offset:4320
    ds_read_b128 v[112:115], v10 offset:0
    ds_read_b128 v[116:119], v10 offset:64
    ds_read_b128 v[120:123], v10 offset:128
    ds_read_b128 v[124:127], v10 offset:192
    v_pk_mul_f16 v152, v85, v73 op_sel:[0,0] op_sel_hi:[1,0]
    v_pk_mul_f16 v153, v85, v75 op_sel:[0,0] op_sel_hi:[1,0]
    v_pk_mul_f16 v154, v85, v77 op_sel:[0,0] op_sel_hi:[1,0]
    v_pk_mul_f16 v155, v85, v79 op_sel:[0,0] op_sel_hi:[1,0]
    v_pk_fma_f16 v152, v85, v73, v152 op_sel:[1,1,0] op_sel_hi:[0,1,1] neg_lo:[1,0,0]
    v_pk_fma_f16 v153, v85, v75, v153 op_sel:[1,1,0] op_sel_hi:[0,1,1] neg_lo:[1,0,0]
    v_pk_fma_f16 v154, v85, v77, v154 op_sel:[1,1,0] op_sel_hi:[0,1,1] neg_lo:[1,0,0]
    v_pk_fma_f16 v155, v85, v79, v155 op_sel:[1,1,0] op_sel_hi:[0,1,1] neg_lo:[1,0,0]
    ds_write_addtid_b32 v85 offset:0
    ds_write_addtid_b32 v148 offset:288
    ds_write_addtid_b32 v149 offset:576
    ds_write_addtid_b32 v150 offset:864
    ds_write_addtid_b32 v151 offset:1152
    v_pk_mul_f16 v156, v86, v67 op_sel:[0,0] op_sel_hi:[1,0]
    v_pk_mul_f16 v157, v86, v71 op_sel:[0,0] op_sel_hi:[1,0]
    v_pk_mul_f16 v158, v86, v75 op_sel:[0,0] op_sel_hi:[1,0]
    v_pk_mul_f16 v159, v86, v79 op_sel:[0,0] op_sel_hi:[1,0]
    v_pk_fma_f16 v156, v86, v67, v156 op_sel:[1,1,0] op_sel_hi:[0,1,1] neg_lo:[1,0,0]
    v_pk_fma_f16 v157, v86, v71, v157 op_sel:[1,1,0] op_sel_hi:[0,1,1] neg_lo:[1,0,0]
    v_pk_fma_f16 v158, v86, v75, v158 op_sel:[1,1,0] op_sel_hi:[0,1,1] neg_lo:[1,0,0]
    v_pk_fma_f16 v159, v86, v79, v159 op_sel:[1,1,0] op_sel_hi:[0,1,1] neg_lo:[1,0,0]
    ds_write_addtid_b32 v152 offset:1440
    ds_write_addtid_b32 v153 offset:1728
    ds_write_addtid_b32 v154 offset:2016
    ds_write_addtid_b32 v155 offset:2304
    s_waitcnt lgkmcnt(9)
    .p2align 3
    v_mfma_f32_16x16x32_f16 v[128:131], v[112:115], v[96:99], 0
    v_mfma_f32_16x16x32_f16 v[128:131], v[116:119], v[100:103], v[128:131]
    v_mfma_f32_16x16x32_f16 v[128:131], v[120:123], v[104:107], v[128:131]
    v_mfma_f32_16x16x32_f16 v[128:131], v[124:127], v[108:111], v[128:131]
    ds_read_b128 v[112:115], v11 offset:0
    ds_read_b128 v[116:119], v11 offset:64
    ds_read_b128 v[120:123], v11 offset:128
    ds_read_b128 v[124:127], v11 offset:192
    v_pk_mul_f16 v148, v88, v67 op_sel:[0,0] op_sel_hi:[1,0]
    v_pk_mul_f16 v149, v88, v71 op_sel:[0,0] op_sel_hi:[1,0]
    v_pk_mul_f16 v150, v88, v75 op_sel:[0,0] op_sel_hi:[1,0]
    v_pk_mul_f16 v151, v88, v79 op_sel:[0,0] op_sel_hi:[1,0]
    v_pk_mul_f16 v90, v87, v86 op_sel:[0,0] op_sel_hi:[1,0]
    v_pk_mul_f16 v91, v87, v88 op_sel:[0,0] op_sel_hi:[1,0]
    v_pk_fma_f16 v148, v88, v67, v148 op_sel:[1,1,0] op_sel_hi:[0,1,1] neg_lo:[1,0,0]
    v_pk_fma_f16 v149, v88, v71, v149 op_sel:[1,1,0] op_sel_hi:[0,1,1] neg_lo:[1,0,0]
    v_pk_fma_f16 v150, v88, v75, v150 op_sel:[1,1,0] op_sel_hi:[0,1,1] neg_lo:[1,0,0]
    v_pk_fma_f16 v151, v88, v79, v151 op_sel:[1,1,0] op_sel_hi:[0,1,1] neg_lo:[1,0,0]
    v_pk_fma_f16 v90, v87, v86, v90 op_sel:[1,1,0] op_sel_hi:[0,1,1] neg_lo:[1,0,0]
    v_pk_fma_f16 v91, v87, v88, v91 op_sel:[1,1,0] op_sel_hi:[0,1,1] neg_lo:[1,0,0]
    ds_write_addtid_b32 v156 offset:0
    ds_write_addtid_b32 v157 offset:288
    ds_write_addtid_b32 v158 offset:576
    ds_write_addtid_b32 v159 offset:864
    v_pk_mul_f32 v[128:129], v[128:129], v[166:167]
    v_pk_mul_f32 v[130:131], v[130:131], v[166:167]
    s_waitcnt lgkmcnt(4)
    .p2align 3
    v_mfma_f32_16x16x32_f16 v[132:135], v[112:115], v[96:99], 0
    v_mfma_f32_16x16x32_f16 v[132:135], v[116:119], v[100:103], v[132:135]
    v_mfma_f32_16x16x32_f16 v[132:135], v[120:123], v[104:107], v[132:135]
    v_mfma_f32_16x16x32_f16 v[132:135], v[124:127], v[108:111], v[132:135]
    ds_write_b128 v12, v[128:131] offset:10608
    v_pk_mul_f16 v152, v87, v71 op_sel:[0,0] op_sel_hi:[1,0]
    v_pk_mul_f16 v153, v87, v79 op_sel:[0,0] op_sel_hi:[1,0]
    v_pk_mul_f16 v154, v89, v71 op_sel:[0,0] op_sel_hi:[1,0]
    v_pk_mul_f16 v155, v89, v79 op_sel:[0,0] op_sel_hi:[1,0]
    v_pk_fma_f16 v152, v87, v71, v152 op_sel:[1,1,0] op_sel_hi:[0,1,1] neg_lo:[1,0,0]
    v_pk_fma_f16 v153, v87, v79, v153 op_sel:[1,1,0] op_sel_hi:[0,1,1] neg_lo:[1,0,0]
    v_pk_fma_f16 v154, v89, v71, v154 op_sel:[1,1,0] op_sel_hi:[0,1,1] neg_lo:[1,0,0]
    v_pk_fma_f16 v155, v89, v79, v155 op_sel:[1,1,0] op_sel_hi:[0,1,1] neg_lo:[1,0,0]
    ds_write_addtid_b32 v148 offset:1152
    ds_write_addtid_b32 v149 offset:1440
    ds_write_addtid_b32 v150 offset:1728
    ds_write_addtid_b32 v151 offset:2016
    v_pk_mul_f32 v[132:133], v[132:133], v[166:167]
    v_pk_mul_f32 v[134:135], v[134:135], v[166:167]
    v_mov_b32_e64 v4, s57
    v_mov_b32_e64 v5, 1
    ds_write_b128 v12, v[132:135] offset:11632
    s_mov_b64 exec, 1
    ds_write_b32 v4, v5 offset:10592
    s_mov_b64 exec, -1
    v_pk_mul_f16 v156, v90, v71 op_sel:[0,0] op_sel_hi:[1,0]
    v_pk_mul_f16 v157, v90, v79 op_sel:[0,0] op_sel_hi:[1,0]
    v_pk_mul_f16 v158, v91, v71 op_sel:[0,0] op_sel_hi:[1,0]
    v_pk_mul_f16 v159, v91, v79 op_sel:[0,0] op_sel_hi:[1,0]
    v_pk_fma_f16 v156, v90, v71, v156 op_sel:[1,1,0] op_sel_hi:[0,1,1] neg_lo:[1,0,0]
    v_pk_fma_f16 v157, v90, v79, v157 op_sel:[1,1,0] op_sel_hi:[0,1,1] neg_lo:[1,0,0]
    v_pk_fma_f16 v158, v91, v71, v158 op_sel:[1,1,0] op_sel_hi:[0,1,1] neg_lo:[1,0,0]
    v_pk_fma_f16 v159, v91, v79, v159 op_sel:[1,1,0] op_sel_hi:[0,1,1] neg_lo:[1,0,0]
    ds_write_addtid_b32 v152 offset:2304
    ds_write_addtid_b32 v153 offset:2592
    ds_write_addtid_b32 v154 offset:2880
    ds_write_addtid_b32 v155 offset:3168
    ds_write_addtid_b32 v156 offset:3456
    ds_write_addtid_b32 v157 offset:3744
    ds_write_addtid_b32 v158 offset:4032
    ds_write_addtid_b32 v159 offset:4320
    ds_read_b128 v[112:115], v10 offset:0
    ds_read_b128 v[116:119], v10 offset:64
    ds_read_b128 v[120:123], v10 offset:128
    ds_read_b128 v[124:127], v10 offset:192
    v_cmp_eq_u32 vcc, 0, v1
    s_cmp_eq_u32 s49, 0
    s_cselect_b64 vcc, vcc, 0
    s_mov_b32 s3, 0x100000
    v_cndmask_b32 v9, 0, v9, vcc
L_A_fl:
    ds_read_b32 v4, v55 offset:10592
    ds_read_b32 v5, v55 offset:13680
    ds_read_b128 v[64:67], v13 offset:10608
    ds_read_b128 v[68:71], v13 offset:13696
    ds_read_b128 v[72:75], v14 offset:10608
    ds_read_b128 v[76:79], v14 offset:13696
    s_sub_u32 s3, s3, 1
    s_cbranch_scc1 L_A_fl2
    s_waitcnt lgkmcnt(4)
    v_min_u32 v4, v4, v5
    v_cmp_lt_u32 vcc, 0, v4
    s_nop 4
    s_cbranch_vccnz L_A_fl2
    s_sleep 2
    s_branch L_A_fl
L_A_fl2:
    s_waitcnt lgkmcnt(4)
    v_mfma_f32_16x16x32_f16 v[136:139], v[112:115], v[96:99], 0
    v_mfma_f32_16x16x32_f16 v[136:139], v[116:119], v[100:103], v[136:139]
    v_mfma_f32_16x16x32_f16 v[136:139], v[120:123], v[104:107], v[136:139]
    v_mfma_f32_16x16x32_f16 v[136:139], v[124:127], v[108:111], v[136:139]
    s_waitcnt lgkmcnt(0)
    v_add_f32 v64, v64, v9
    v_pk_add_f32 v[64:65], v[64:65], v[68:69]
    v_pk_add_f32 v[66:67], v[66:67], v[70:71]
    v_pk_add_f32 v[72:73], v[72:73], v[76:77]
    v_pk_add_f32 v[74:75], v[74:75], v[78:79]
    v_cvt_pk_bf16_f32 v80, v67, v66
    v_cvt_pk_bf16_f32 v81, v65, v64
    ds_write_b64 v15, v[80:81] offset:12
    v_cvt_pk_bf16_f32 v82, v66, v65
    v_cvt_pk_bf16_f32 v83, v64, v75
    ds_write_b64 v15, v[82:83] offset:1228
    v_cvt_pk_bf16_f32 v84, v65, v64
    v_cvt_pk_bf16_f32 v85, v75, v74
    ds_write_b64 v15, v[84:85] offset:2444
    v_cvt_pk_bf16_f32 v86, v64, v75
    v_cvt_pk_bf16_f32 v87, v74, v73
    ds_write_b64 v15, v[86:87] offset:3660
    v_pk_mul_f32 v[136:137], v[136:137], v[166:167]
    v_pk_mul_f32 v[138:139], v[138:139], v[166:167]
    ds_write_b128 v12, v[136:139] offset:12656
    s_cmp_eq_u32 s49, 0
    s_cbranch_scc1 L_A_nox
    s_mov_b32 exec_lo, 0
    s_mov_b32 exec_hi, 0x80000000
    v_mov_b32 v96, 0
    v_mov_b32 v97, 0
    v_cvt_pk_bf16_f32 v98, 0, v67
    v_cvt_pk_bf16_f32 v99, v67, v67
    v_mov_b32 v100, 0
    v_mov_b32 v104, 0
    v_mov_b32 v103, v80
    v_mov_b32 v107, v82
    ds_write_b128 v55, v[96:99] offset:48
    v_mov_b32 v101, v98
    v_mov_b32 v102, v99
    v_mov_b32 v105, v99
    v_mov_b32 v106, v99
    v_mov_b32 v98, v99
    ds_write_b128 v55, v[100:103] offset:2480
    ds_write_b128 v55, v[104:107] offset:3696
    ds_write_b128 v55, v[96:99] offset:1264
L_A_nox:
    s_mov_b64 exec, 1
    v_mov_b32 v4, s57
    v_mov_b32 v5, 2
    ds_write_b32 v4, v5 offset:10592
    s_mov_b64 exec, -1
    s_mul_i32 s3, s48, 9216
    v_lshl_add_u32 v0, v1, 4, s3
    v_mov_b32 v15, 163072
    v_mov_b32 v14, 1
    s_cmp_eq_u32 s49, 0
    s_cbranch_scc0 L_A_Y
    s_cmp_ge_u32 s31, 8
    s_cbranch_scc1 L_A_tX
    global_load_dwordx3 v[32:34], v39, s[8:9] offset:0
    global_load_dwordx3 v[36:38], v39, s[8:9] offset:1152
    global_load_dwordx3 v[40:42], v39, s[8:9] offset:2304
    global_load_dwordx3 v[44:46], v39, s[8:9] offset:3456
    s_setprio 0
    s_mov_b32 s3, 0x100000
L_A_fwx:
    ds_read_b32 v4, v55 offset:13680
    s_sub_u32 s3, s3, 1
    s_cbranch_scc1 L_A_fxx
    s_waitcnt lgkmcnt(0)
    v_cmp_le_u32 vcc, 2, v4
    s_nop 4
    s_cbranch_vccnz L_A_fxx
    s_sleep 2
    s_branch L_A_fwx
L_A_fxx:
    ds_read_b128 v[124:127], v13 offset:12656
    ds_read_b128 v[128:131], v13 offset:15744
    v_lshrrev_b32 v4, 2, v1
    v_and_b32 v5, 1, v1
    v_lshl_add_u32 v5, v5, 7, s55
    v_lshl_add_u32 v10, v4, 3, v5
    v_lshl_add_u32 v11, v4, 2, v5
    v_add_u32 v11, 5376, v11
    s_waitcnt lgkmcnt(0)
    v_pk_add_f32 v[124:125], v[124:125], v[128:129]
    v_pk_add_f32 v[126:127], v[126:127], v[130:131]
    v_cvt_pk_bf16_f32 v132, v124, v125
    v_cvt_pk_bf16_f32 v133, v126, v127
    s_mov_b32 exec_lo, 0x33333333
    s_mov_b32 exec_hi, 0x33333333
    ds_write_b64 v10, v[132:133] offset:4984
    s_mov_b32 exec_lo, 0xcccccccc
    s_mov_b32 exec_hi, 0xcccccccc
    ds_write2_b32 v11, v132, v133 offset0:15 offset1:31
    ds_write2_b32 v11, v132, v133 offset0:94 offset1:110
    s_mov_b64 exec, -1
    ds_read_b64 v[84:85], v49 offset:576
    ds_read_b64 v[86:87], v49 offset:584
    ds_read_b64 v[116:117], v49 offset:64
    ds_read_b64 v[118:119], v49 offset:72
    ds_read_b64 v[80:81], v49 offset:640
    ds_read_b64 v[82:83], v49 offset:648
    ds_read_b64 v[112:113], v49 offset:128
    ds_read_b64 v[114:115], v49 offset:136
    ds_read_b64 v[76:77], v49 offset:704
    ds_read_b64 v[78:79], v49 offset:712
    ds_read_b64 v[108:109], v49 offset:192
    ds_read_b64 v[110:111], v49 offset:200
    ds_read_b64 v[72:73], v49 offset:768
    ds_read_b64 v[74:75], v49 offset:776
    ds_read_b64 v[104:105], v49 offset:256
    ds_read_b64 v[106:107], v49 offset:264
    ds_read_b64 v[68:69], v49 offset:832
    ds_read_b64 v[70:71], v49 offset:840
    ds_read_b64 v[100:101], v49 offset:320
    ds_read_b64 v[102:103], v49 offset:328
    ds_read_b64 v[64:65], v49 offset:896
    ds_read_b64 v[66:67], v49 offset:904
    ds_read_b64 v[96:97], v49 offset:384
    ds_read_b64 v[98:99], v49 offset:392
    ds_read_b64 v[60:61], v49 offset:960
    ds_read_b64 v[62:63], v49 offset:968
    ds_read_b64 v[92:93], v49 offset:448
    ds_read_b64 v[94:95], v49 offset:456
    ds_read_b64 v[56:57], v49 offset:1024
    ds_read_b64 v[58:59], v49 offset:1032
    ds_read_b64 v[88:89], v49 offset:512
    ds_read_b64 v[90:91], v49 offset:520
    ds_read_b64 v[120:121], v49 offset:0
    ds_read_b64 v[122:123], v49 offset:8
    s_waitcnt lgkmcnt(0)
    s_barrier
    s_setprio 3
    s_branch L_A_krX
L_A_tX:
    s_waitcnt vmcnt(0) lgkmcnt(0)
    s_barrier
    s_setprio 3
    ds_read_b128 v[124:127], v13 offset:12656
    ds_read_b128 v[128:131], v13 offset:15744
    v_lshrrev_b32 v4, 2, v1
    v_and_b32 v5, 1, v1
    v_lshl_add_u32 v5, v5, 7, s55
    v_lshl_add_u32 v10, v4, 3, v5
    v_lshl_add_u32 v11, v4, 2, v5
    v_add_u32 v11, 5376, v11
    s_waitcnt lgkmcnt(0)
    v_pk_add_f32 v[124:125], v[124:125], v[128:129]
    v_pk_add_f32 v[126:127], v[126:127], v[130:131]
    v_cvt_pk_bf16_f32 v132, v124, v125
    v_cvt_pk_bf16_f32 v133, v126, v127
    s_mov_b32 exec_lo, 0x33333333
    s_mov_b32 exec_hi, 0x33333333
    ds_write_b64 v10, v[132:133] offset:4984
    s_mov_b32 exec_lo, 0xcccccccc
    s_mov_b32 exec_hi, 0xcccccccc
    ds_write2_b32 v11, v132, v133 offset0:15 offset1:31
    ds_write2_b32 v11, v132, v133 offset0:94 offset1:110
    s_mov_b64 exec, -1
    s_mov_b64 exec, 1
    v_mov_b32 v4, 3
    ds_write_b32 v55, v4 offset:13680
    s_mov_b64 exec, -1
    ds_read_b64 v[84:85], v49 offset:576
    ds_read_b64 v[86:87], v49 offset:584
    ds_read_b64 v[116:117], v49 offset:64
    ds_read_b64 v[118:119], v49 offset:72
    ds_read_b64 v[80:81], v49 offset:640
    ds_read_b64 v[82:83], v49 offset:648
    ds_read_b64 v[112:113], v49 offset:128
    ds_read_b64 v[114:115], v49 offset:136
    ds_read_b64 v[76:77], v49 offset:704
    ds_read_b64 v[78:79], v49 offset:712
    ds_read_b64 v[108:109], v49 offset:192
    ds_read_b64 v[110:111], v49 offset:200
    ds_read_b64 v[72:73], v49 offset:768
    ds_read_b64 v[74:75], v49 offset:776
    ds_read_b64 v[104:105], v49 offset:256
    ds_read_b64 v[106:107], v49 offset:264
    ds_read_b64 v[68:69], v49 offset:832
    ds_read_b64 v[70:71], v49 offset:840
    ds_read_b64 v[100:101], v49 offset:320
    ds_read_b64 v[102:103], v49 offset:328
    ds_read_b64 v[64:65], v49 offset:896
    ds_read_b64 v[66:67], v49 offset:904
    ds_read_b64 v[96:97], v49 offset:384
    ds_read_b64 v[98:99], v49 offset:392
    ds_read_b64 v[60:61], v49 offset:960
    ds_read_b64 v[62:63], v49 offset:968
    ds_read_b64 v[92:93], v49 offset:448
    ds_read_b64 v[94:95], v49 offset:456
    ds_read_b64 v[56:57], v49 offset:1024
    ds_read_b64 v[58:59], v49 offset:1032
    ds_read_b64 v[88:89], v49 offset:512
    ds_read_b64 v[90:91], v49 offset:520
    ds_read_b64 v[120:121], v49 offset:0
    ds_read_b64 v[122:123], v49 offset:8
L_A_krX:
    ds_read_b128 v[124:127], v48 offset:6064
    ds_read_b128 v[128:131], v48 offset:6128
    ds_read_b128 v[132:135], v48 offset:6192
    s_waitcnt lgkmcnt(2)
    v_mfma_f32_16x16x32_bf16 v[148:151], v[84:87], v[124:127], 0
    v_mfma_f32_16x16x32_bf16 v[152:155], v[116:119], v[124:127], 0
    ds_read_b128 v[136:139], v48 offset:6256
    s_waitcnt lgkmcnt(2)
    v_mfma_f32_16x16x32_bf16 v[148:151], v[80:83], v[128:131], v[148:151]
    v_mfma_f32_16x16x32_bf16 v[152:155], v[112:115], v[128:131], v[152:155]
    ds_read_b128 v[140:143], v48 offset:6320
    s_waitcnt lgkmcnt(2)
    v_mfma_f32_16x16x32_bf16 v[148:151], v[76:79], v[132:135], v[148:151]
    v_mfma_f32_16x16x32_bf16 v[152:155], v[108:111], v[132:135], v[152:155]
    ds_read_b128 v[144:147], v48 offset:6384
    ds_read_u16 v9, v55 offset:5238
    ds_read_b128 v[4:7], v7 offset:4096
    s_waitcnt lgkmcnt(4)
    v_mfma_f32_16x16x32_bf16 v[148:151], v[72:75], v[136:139], v[148:151]
    v_mfma_f32_16x16x32_bf16 v[152:155], v[104:107], v[136:139], v[152:155]
    ds_read_b128 v[124:127], v48 offset:6448
    s_waitcnt lgkmcnt(4)
    v_mfma_f32_16x16x32_bf16 v[148:151], v[68:71], v[140:143], v[148:151]
    v_mfma_f32_16x16x32_bf16 v[152:155], v[100:103], v[140:143], v[152:155]
    s_waitcnt lgkmcnt(1)
    v_lshl_or_b32 v9, v9, 16, v9
    v_and_b32 v4, v9, v4
    ds_read_b128 v[128:131], v48 offset:6512
    v_mfma_f32_16x16x32_bf16 v[148:151], v[64:67], v[144:147], v[148:151]
    v_and_b32 v5, v9, v5
    v_and_b32 v6, v9, v6
    v_mfma_f32_16x16x32_bf16 v[152:155], v[96:99], v[144:147], v[152:155]
    v_and_b32 v7, v9, v7
    s_waitcnt lgkmcnt(1)
    v_mfma_f32_16x16x32_bf16 v[148:151], v[60:63], v[124:127], v[148:151]
    ds_read_b128 v[132:135], v48 offset:6576
    v_mfma_f32_16x16x32_bf16 v[152:155], v[92:95], v[124:127], v[152:155]
    s_waitcnt lgkmcnt(1)
    v_mfma_f32_16x16x32_bf16 v[148:151], v[56:59], v[128:131], v[148:151]
    ds_read_b128 v[136:139], v48 offset:6640
    v_mfma_f32_16x16x32_bf16 v[152:155], v[88:91], v[128:131], v[152:155]
    v_mfma_f32_16x16x32_bf16 v[156:159], v[120:123], v[128:131], 0
    s_waitcnt lgkmcnt(1)
    v_mfma_f32_16x16x32_bf16 v[152:155], v[84:87], v[132:135], v[152:155]
    ds_read_b128 v[140:143], v48 offset:6704
    v_mfma_f32_16x16x32_bf16 v[156:159], v[116:119], v[132:135], v[156:159]
    s_waitcnt lgkmcnt(1)
    v_mfma_f32_16x16x32_bf16 v[152:155], v[80:83], v[136:139], v[152:155]
    ds_read_b128 v[144:147], v48 offset:6768
    v_mfma_f32_16x16x32_bf16 v[156:159], v[112:115], v[136:139], v[156:159]
    v_cvt_pk_bf16_f32 v148, v148, v149
    v_cvt_pk_bf16_f32 v149, v150, v151
    ds_write_b64 v54, v[148:149] offset:10592
    ds_read_b128 v[124:127], v48 offset:6832
    s_waitcnt lgkmcnt(3)
    v_mfma_f32_16x16x32_bf16 v[152:155], v[76:79], v[140:143], v[152:155]
    v_mfma_f32_16x16x32_bf16 v[156:159], v[108:111], v[140:143], v[156:159]
    ds_read_b128 v[132:135], v48 offset:6896
    s_waitcnt lgkmcnt(3)
    v_mfma_f32_16x16x32_bf16 v[152:155], v[72:75], v[144:147], v[152:155]
    v_mfma_f32_16x16x32_bf16 v[156:159], v[104:107], v[144:147], v[156:159]
    ds_read_b128 v[136:139], v48 offset:6960
    s_waitcnt lgkmcnt(2)
    v_mfma_f32_16x16x32_bf16 v[152:155], v[68:71], v[124:127], v[152:155]
    v_mfma_f32_16x16x32_bf16 v[156:159], v[100:103], v[124:127], v[156:159]
    ds_read_b128 v[140:143], v48 offset:7024
    s_waitcnt lgkmcnt(2)
    v_mfma_f32_16x16x32_bf16 v[152:155], v[64:67], v[132:135], v[152:155]
    v_mfma_f32_16x16x32_bf16 v[156:159], v[96:99], v[132:135], v[156:159]
    s_waitcnt lgkmcnt(1)
    v_mfma_f32_16x16x32_bf16 v[152:155], v[60:63], v[136:139], v[152:155]
    v_mfma_f32_16x16x32_bf16 v[156:159], v[92:95], v[136:139], v[156:159]
    s_waitcnt lgkmcnt(0)
    v_mfma_f32_16x16x32_bf16 v[152:155], v[56:59], v[140:143], v[152:155]
    v_mfma_f32_16x16x32_bf16 v[156:159], v[88:91], v[140:143], v[156:159]
    ds_read_b128 v[144:147], v52 offset:6448
    v_mfma_f32_16x16x32_bf16 v[160:163], v[120:123], v[140:143], 0
    ds_read_b128 v[124:127], v48 offset:7088
    s_nop 3
    v_cvt_pk_bf16_f32 v152, v152, v153
    v_cvt_pk_bf16_f32 v153, v154, v155
    ds_write_b64 v54, v[152:153] offset:11104
    s_cmp_ge_u32 s31, 8
    s_cbranch_scc1 L_A_uw
    v_lshlrev_b32 v12, 3, v35
    v_add_u32 v12, 61792, v12
    v_add_u32 v13, 50304, v12
    s_waitcnt vmcnt(0)
    v_perm_b32 v148, v36, v32, s52
    v_perm_b32 v149, v44, v40, s52
    ds_write_b64 v12, v[148:149] offset:0
    v_perm_b32 v150, v36, v32, s53
    v_perm_b32 v151, v44, v40, s53
    ds_write_b64 v12, v[150:151] offset:16768
    v_perm_b32 v152, v37, v33, s52
    v_perm_b32 v153, v45, v41, s52
    ds_write_b64 v12, v[152:153] offset:33536
    v_perm_b32 v154, v37, v33, s53
    v_perm_b32 v155, v45, v41, s53
    ds_write_b64 v13, v[154:155] offset:0
    v_perm_b32 v148, v38, v34, s52
    v_perm_b32 v149, v46, v42, s52
    ds_write_b64 v13, v[148:149] offset:16768
    v_perm_b32 v150, v38, v34, s53
    v_perm_b32 v151, v46, v42, s53
    ds_write_b64 v13, v[150:151] offset:33536
    s_mov_b64 exec, 1
    ds_add_u32 v15, v14 offset:16
    s_mov_b64 exec, -1
L_A_uw:
    ds_read_b128 v[132:135], v48 offset:7152
    s_mov_b64 exec, 1
    ds_add_u32 v15, v14 offset:0
    s_mov_b64 exec, -1
    s_setprio 2
    s_waitcnt lgkmcnt(4)
    v_mfma_f32_16x16x32_bf16 v[32:35], v[144:147], v[16:19], 0
    v_mfma_f32_16x16x32_bf16 v[36:39], v[144:147], v[20:23], 0
    s_waitcnt lgkmcnt(3)
    v_mfma_f32_16x16x32_bf16 v[156:159], v[84:87], v[124:127], v[156:159]
    ds_read_b128 v[136:139], v48 offset:7216
    v_mfma_f32_16x16x32_bf16 v[160:163], v[116:119], v[124:127], v[160:163]
    ds_read_b128 v[140:143], v52 offset:6704
    s_waitcnt lgkmcnt(3)
    v_mfma_f32_16x16x32_bf16 v[156:159], v[80:83], v[132:135], v[156:159]
    s_nop 0
    v_cvt_pk_bf16_f32 v147, v36, v32
    v_cvt_pk_bf16_f32 v146, v37, v33
    v_cvt_pk_bf16_f32 v145, v38, v34
    v_cvt_pk_bf16_f32 v144, v39, v35
    ds_read_b128 v[124:127], v48 offset:7280
    v_mfma_f32_16x16x32_bf16 v[160:163], v[112:115], v[132:135], v[160:163]
    s_waitcnt lgkmcnt(2)
    v_mfma_f32_16x16x32_bf16 v[156:159], v[76:79], v[136:139], v[156:159]
    s_waitcnt lgkmcnt(1)
    v_mfma_f32_16x16x32_bf16 v[40:43], v[140:143], v[16:19], 0
    v_mfma_f32_16x16x32_bf16 v[44:47], v[140:143], v[20:23], 0
    ds_read_b64 v[132:133], v50 offset:4976
    ds_read_b64 v[134:135], v50 offset:4984
    v_mfma_f32_16x16x32_bf16 v[160:163], v[108:111], v[136:139], v[160:163]
    ds_read_b64 v[140:141], v50 offset:5104
    ds_read_b64 v[142:143], v50 offset:5112
    s_waitcnt lgkmcnt(4)
    v_mfma_f32_16x16x32_bf16 v[156:159], v[72:75], v[124:127], v[156:159]
    ds_read_b64 v[136:137], v50 offset:5232
    ds_read_b64 v[138:139], v50 offset:5240
    v_mfma_f32_16x16x32_bf16 v[160:163], v[104:107], v[124:127], v[160:163]
    ds_read_b128 v[124:127], v48 offset:7344
    v_cvt_pk_bf16_f32 v131, v44, v40
    v_cvt_pk_bf16_f32 v130, v45, v41
    v_cvt_pk_bf16_f32 v129, v46, v42
    v_cvt_pk_bf16_f32 v128, v47, v43
    s_waitcnt lgkmcnt(5)
    v_mfma_f32_16x16x32_bf16 v[156:159], v[144:147], v[132:135], v[156:159]
    s_waitcnt lgkmcnt(3)
    v_mfma_f32_16x16x32_bf16 v[160:163], v[144:147], v[140:143], v[160:163]
    ds_read_b128 v[104:107], v48 offset:7408
    s_waitcnt lgkmcnt(2)
    v_mfma_f32_16x16x32_bf16 v[164:167], v[144:147], v[136:139], 0
    s_waitcnt lgkmcnt(1)
    v_mfma_f32_16x16x32_bf16 v[156:159], v[68:71], v[124:127], v[156:159]
    ds_read_b128 v[144:147], v48 offset:7472
    s_cmp_ge_u32 s31, 4
    s_cbranch_scc1 L_A_oX0
    s_mov_b32 s3, 0x100000
L_A_wX0:
    ds_read_b32 v13, v15 offset:0
    s_sub_u32 s3, s3, 1
    s_cbranch_scc1 L_A_xX0
    s_waitcnt lgkmcnt(0)
    v_cmp_eq_u32 vcc, 6, v13
    s_nop 4
    s_cbranch_vccnz L_A_xX0
    s_sleep 1
    s_branch L_A_wX0
L_A_xX0:
    s_and_b32 s3, s31, 3
    s_cmp_lt_u32 s3, 2
    s_cselect_b32 s4, 0, 1
    s_and_b32 s3, s3, 1
    s_lshl_b32 s5, s4, 9
    s_lshl_b32 s6, s3, 8
    s_add_u32 s5, s5, s6
    s_add_u32 s5, s5, 65888
    v_lshl_add_u32 v12, v1, 2, s5
    v_add_u32 v13, 50304, v12
    ds_read_b32 v148, v12 offset:0
    ds_read_b32 v149, v12 offset:16768
    ds_read_b32 v150, v12 offset:33536
    ds_read_b32 v151, v13 offset:0
    ds_read_b32 v152, v13 offset:16768
    ds_read_b32 v153, v13 offset:33536
    s_lshl_b32 s4, s4, 8
    s_lshl_b32 s3, s3, 3
    s_add_u32 s4, s4, s3
    s_mul_i32 s4, s4, 2304
    s_add_u32 s4, s4, s54
    v_add_u32 v13, s4, v8
    s_waitcnt lgkmcnt(0)
    v_perm_b32 v10, v149, v148, s52
    v_perm_b32 v11, v151, v150, s52
    v_perm_b32 v12, v153, v152, s52
    global_store_dwordx3 v13, v[10:12], s[60:61] offset:0
    v_perm_b32 v148, v149, v148, s53
    v_perm_b32 v149, v151, v150, s53
    v_perm_b32 v150, v153, v152, s53
    global_store_dwordx3 v13, v[148:150], s[60:61] offset:2304
L_A_oX0:
    ds_read_b64 v[136:137], v50 offset:4912
    ds_read_b64 v[138:139], v50 offset:4920
    v_mfma_f32_16x16x32_bf16 v[160:163], v[100:103], v[124:127], v[160:163]
    ds_read_b64 v[124:125], v50 offset:5040
    ds_read_b64 v[126:127], v50 offset:5048
    s_waitcnt lgkmcnt(5)
    v_mfma_f32_16x16x32_bf16 v[156:159], v[64:67], v[104:107], v[156:159]
    ds_read_b64 v[64:65], v50 offset:5168
    ds_read_b64 v[66:67], v50 offset:5176
    v_mfma_f32_16x16x32_bf16 v[160:163], v[96:99], v[104:107], v[160:163]
    s_waitcnt lgkmcnt(6)
    v_mfma_f32_16x16x32_bf16 v[156:159], v[60:63], v[144:147], v[156:159]
    ds_read_b128 v[104:107], v48 offset:7536
    s_waitcnt lgkmcnt(5)
    v_mfma_f32_16x16x32_bf16 v[156:159], v[128:131], v[136:139], v[156:159]
    s_waitcnt lgkmcnt(3)
    v_mfma_f32_16x16x32_bf16 v[160:163], v[128:131], v[124:127], v[160:163]
    s_waitcnt lgkmcnt(1)
    v_mfma_f32_16x16x32_bf16 v[164:167], v[128:131], v[64:67], v[164:167]
    v_mfma_f32_16x16x32_bf16 v[160:163], v[92:95], v[144:147], v[160:163]
    s_waitcnt lgkmcnt(0)
    v_mfma_f32_16x16x32_bf16 v[156:159], v[56:59], v[104:107], v[156:159]
    ds_read_b128 v[128:131], v52 offset:6960
    v_mfma_f32_16x16x32_bf16 v[160:163], v[88:91], v[104:107], v[160:163]
    ds_read_b128 v[144:147], v48 offset:7600
    v_mfma_f32_16x16x32_bf16 v[164:167], v[120:123], v[104:107], v[164:167]
    s_nop 3
    v_cvt_pk_bf16_f32 v156, v156, v157
    v_cvt_pk_bf16_f32 v157, v158, v159
    ds_write_b64 v54, v[156:157] offset:11616
    s_mov_b64 exec, 1
    ds_add_u32 v15, v14 offset:4
    s_mov_b64 exec, -1
    s_setprio 1
    ds_read_b128 v[64:67], v48 offset:7664
    s_waitcnt lgkmcnt(4)
    v_mfma_f32_16x16x32_bf16 v[32:35], v[128:131], v[16:19], 0
    v_mfma_f32_16x16x32_bf16 v[36:39], v[128:131], v[20:23], 0
    ds_read_b128 v[120:123], v52 offset:7216
    s_waitcnt lgkmcnt(4)
    v_mfma_f32_16x16x32_bf16 v[160:163], v[84:87], v[144:147], v[160:163]
    v_mfma_f32_16x16x32_bf16 v[164:167], v[116:119], v[144:147], v[164:167]
    ds_read_b128 v[104:107], v48 offset:7728
    s_nop 2
    v_cvt_pk_bf16_f32 v131, v36, v32
    v_cvt_pk_bf16_f32 v130, v37, v33
    v_cvt_pk_bf16_f32 v129, v38, v34
    v_cvt_pk_bf16_f32 v128, v39, v35
    s_waitcnt lgkmcnt(2)
    v_mfma_f32_16x16x32_bf16 v[160:163], v[80:83], v[64:67], v[160:163]
    s_waitcnt lgkmcnt(1)
    v_mfma_f32_16x16x32_bf16 v[40:43], v[120:123], v[16:19], 0
    v_mfma_f32_16x16x32_bf16 v[44:47], v[120:123], v[20:23], 0
    v_mfma_f32_16x16x32_bf16 v[164:167], v[112:115], v[64:67], v[164:167]
    s_waitcnt lgkmcnt(0)
    v_mfma_f32_16x16x32_bf16 v[160:163], v[76:79], v[104:107], v[160:163]
    ds_read_b128 v[116:119], v48 offset:7792
    s_nop 3
    v_cvt_pk_bf16_f32 v147, v44, v40
    v_cvt_pk_bf16_f32 v146, v45, v41
    v_cvt_pk_bf16_f32 v145, v46, v42
    v_cvt_pk_bf16_f32 v144, v47, v43
    ds_read_b64 v[112:113], v49 offset:256
    ds_read_b64 v[114:115], v49 offset:264
    v_mfma_f32_16x16x32_bf16 v[160:163], v[128:131], v[132:135], v[160:163]
    v_mfma_f32_16x16x32_bf16 v[164:167], v[128:131], v[140:143], v[164:167]
    v_mfma_f32_16x16x32_bf16 v[164:167], v[108:111], v[104:107], v[164:167]
    s_waitcnt lgkmcnt(2)
    v_mfma_f32_16x16x32_bf16 v[160:163], v[72:75], v[116:119], v[160:163]
    ds_read_b128 v[64:67], v48 offset:7856
    s_waitcnt lgkmcnt(1)
    v_mfma_f32_16x16x32_bf16 v[164:167], v[112:115], v[116:119], v[164:167]
    v_mfma_f32_16x16x32_bf16 v[160:163], v[144:147], v[136:139], v[160:163]
    s_cmp_ge_u32 s31, 4
    s_cbranch_scc1 L_A_oX1
    s_mov_b32 s3, 0x100000
L_A_wX1:
    ds_read_b32 v13, v15 offset:4
    s_sub_u32 s3, s3, 1
    s_cbranch_scc1 L_A_xX1
    s_waitcnt lgkmcnt(0)
    v_cmp_eq_u32 vcc, 12, v13
    s_nop 4
    s_cbranch_vccnz L_A_xX1
    s_sleep 1
    s_branch L_A_wX1
L_A_xX1:
    s_and_b32 s3, s31, 3
    s_cmp_lt_u32 s3, 2
    s_cselect_b32 s4, 2, 5
    s_and_b32 s3, s3, 1
    s_lshl_b32 s5, s4, 9
    s_lshl_b32 s6, s3, 8
    s_add_u32 s5, s5, s6
    s_add_u32 s5, s5, 65888
    v_lshl_add_u32 v12, v1, 2, s5
    v_add_u32 v13, 50304, v12
    ds_read_b32 v148, v12 offset:0
    ds_read_b32 v149, v12 offset:16768
    ds_read_b32 v150, v12 offset:33536
    ds_read_b32 v151, v13 offset:0
    ds_read_b32 v152, v13 offset:16768
    ds_read_b32 v153, v13 offset:33536
    s_lshl_b32 s4, s4, 8
    s_lshl_b32 s3, s3, 3
    s_add_u32 s4, s4, s3
    s_mul_i32 s4, s4, 2304
    s_add_u32 s4, s4, s54
    v_add_u32 v13, s4, v8
    s_waitcnt lgkmcnt(0)
    v_perm_b32 v10, v149, v148, s52
    v_perm_b32 v11, v151, v150, s52
    v_perm_b32 v12, v153, v152, s52
    global_store_dwordx3 v13, v[10:12], s[60:61] offset:0
    v_perm_b32 v148, v149, v148, s53
    v_perm_b32 v149, v151, v150, s53
    v_perm_b32 v150, v153, v152, s53
    global_store_dwordx3 v13, v[148:150], s[60:61] offset:2304
L_A_oX1:
    ds_read_b64 v[120:121], v49 offset:896
    ds_read_b64 v[122:123], v49 offset:904
    ds_read_b128 v[108:111], v48 offset:7920
    v_mfma_f32_16x16x32_bf16 v[164:167], v[144:147], v[124:127], v[164:167]
    s_waitcnt lgkmcnt(3)
    v_mfma_f32_16x16x32_bf16 v[160:163], v[68:71], v[64:67], v[160:163]
    ds_read_b128 v[140:143], v48 offset:7984
    v_mfma_f32_16x16x32_bf16 v[164:167], v[100:103], v[64:67], v[164:167]
    s_mov_b32 s3, 0x100000
L_A_wXu2:
    ds_read_b32 v13, v15 offset:16
    s_sub_u32 s3, s3, 1
    s_cbranch_scc1 L_A_xXu2
    s_waitcnt lgkmcnt(0)
    v_cmp_eq_u32 vcc, 4, v13
    s_nop 4
    s_cbranch_vccnz L_A_xXu2
    s_sleep 1
    s_branch L_A_wXu2
L_A_xXu2:
    ds_read_b128 v[104:107], v48 offset:8048
    v_mfma_f32_16x16x32_bf16 v[160:163], v[120:123], v[108:111], v[160:163]
    v_mfma_f32_16x16x32_bf16 v[164:167], v[96:99], v[108:111], v[164:167]
    v_mfma_f32_16x16x32_bf16 v[160:163], v[60:63], v[140:143], v[160:163]
    v_mfma_f32_16x16x32_bf16 v[164:167], v[92:95], v[140:143], v[164:167]
    ds_read_b128 v[128:131], v48 offset:6512
    s_waitcnt lgkmcnt(1)
    v_mfma_f32_16x16x32_bf16 v[160:163], v[56:59], v[104:107], v[160:163]
    ds_read_b128 v[116:119], v52 offset:7472
    v_mfma_f32_16x16x32_bf16 v[164:167], v[88:91], v[104:107], v[164:167]
    ds_read_b128 v[112:115], v48 offset:8112
    s_nop 4
    v_cvt_pk_bf16_f32 v160, v160, v161
    v_cvt_pk_bf16_f32 v161, v162, v163
    ds_write_b64 v54, v[160:161] offset:12128
    ds_read_b128 v[124:127], v48 offset:8176
    s_mov_b64 exec, 1
    ds_add_u32 v15, v14 offset:8
    s_mov_b64 exec, -1
    s_setprio 0
    s_waitcnt lgkmcnt(5)
    v_mfma_f32_16x16x32_bf16 v[164:167], v[4:7], v[128:131], v[164:167]
    ds_read_b128 v[144:147], v52 offset:7728
    s_waitcnt lgkmcnt(5)
    v_mfma_f32_16x16x32_bf16 v[32:35], v[116:119], v[16:19], 0
    v_mfma_f32_16x16x32_bf16 v[36:39], v[116:119], v[20:23], 0
    ds_read_b128 v[100:103], v48 offset:8240
    s_waitcnt lgkmcnt(5)
    v_mfma_f32_16x16x32_bf16 v[164:167], v[84:87], v[112:115], v[164:167]
    ds_read_b128 v[64:67], v48 offset:8304
    s_waitcnt lgkmcnt(4)
    v_mfma_f32_16x16x32_bf16 v[164:167], v[80:83], v[124:127], v[164:167]
    s_nop 1
    v_cvt_pk_bf16_f32 v95, v36, v32
    v_cvt_pk_bf16_f32 v94, v37, v33
    v_cvt_pk_bf16_f32 v93, v38, v34
    v_cvt_pk_bf16_f32 v92, v39, v35
    s_waitcnt lgkmcnt(2)
    v_mfma_f32_16x16x32_bf16 v[40:43], v[144:147], v[16:19], 0
    v_mfma_f32_16x16x32_bf16 v[44:47], v[144:147], v[20:23], 0
    ds_read_b64 v[96:97], v53 offset:6456
    ds_read_b64 v[98:99], v53 offset:6464
    s_waitcnt lgkmcnt(3)
    v_mfma_f32_16x16x32_bf16 v[164:167], v[76:79], v[100:103], v[164:167]
    s_waitcnt lgkmcnt(2)
    v_mfma_f32_16x16x32_bf16 v[164:167], v[72:75], v[64:67], v[164:167]
    ds_read_b128 v[108:111], v48 offset:8368
    s_nop 0
    v_cvt_pk_bf16_f32 v143, v44, v40
    v_cvt_pk_bf16_f32 v142, v45, v41
    v_cvt_pk_bf16_f32 v141, v46, v42
    v_cvt_pk_bf16_f32 v140, v47, v43
    ds_read_b128 v[88:91], v48 offset:8432
    v_mfma_f32_16x16x32_bf16 v[164:167], v[92:95], v[132:135], v[164:167]
    s_waitcnt lgkmcnt(2)
    v_mfma_f32_16x16x32_bf16 v[32:35], v[96:99], v[24:27], 0
    v_mfma_f32_16x16x32_bf16 v[36:39], v[96:99], v[28:31], 0
    s_cmp_ge_u32 s31, 4
    s_cbranch_scc1 L_A_oX2
    s_mov_b32 s3, 0x100000
L_A_wX2:
    ds_read_b32 v13, v15 offset:8
    s_sub_u32 s3, s3, 1
    s_cbranch_scc1 L_A_xX2
    s_waitcnt lgkmcnt(0)
    v_cmp_eq_u32 vcc, 12, v13
    s_nop 4
    s_cbranch_vccnz L_A_xX2
    s_sleep 1
    s_branch L_A_wX2
L_A_xX2:
    s_and_b32 s3, s31, 3
    s_cmp_lt_u32 s3, 2
    s_cselect_b32 s4, 3, 6
    s_and_b32 s3, s3, 1
    s_lshl_b32 s5, s4, 9
    s_lshl_b32 s6, s3, 8
    s_add_u32 s5, s5, s6
    s_add_u32 s5, s5, 65888
    v_lshl_add_u32 v12, v1, 2, s5
    v_add_u32 v13, 50304, v12
    ds_read_b32 v148, v12 offset:0
    ds_read_b32 v149, v12 offset:16768
    ds_read_b32 v150, v12 offset:33536
    ds_read_b32 v151, v13 offset:0
    ds_read_b32 v152, v13 offset:16768
    ds_read_b32 v153, v13 offset:33536
    s_lshl_b32 s4, s4, 8
    s_lshl_b32 s3, s3, 3
    s_add_u32 s4, s4, s3
    s_mul_i32 s4, s4, 2304
    s_add_u32 s4, s4, s54
    v_add_u32 v13, s4, v8
    s_waitcnt lgkmcnt(0)
    v_perm_b32 v10, v149, v148, s52
    v_perm_b32 v11, v151, v150, s52
    v_perm_b32 v12, v153, v152, s52
    global_store_dwordx3 v13, v[10:12], s[60:61] offset:0
    v_perm_b32 v148, v149, v148, s53
    v_perm_b32 v149, v151, v150, s53
    v_perm_b32 v150, v153, v152, s53
    global_store_dwordx3 v13, v[148:150], s[60:61] offset:2304
L_A_oX2:
    ds_read_b128 v[104:107], v48 offset:8496
    s_waitcnt lgkmcnt(2)
    v_mfma_f32_16x16x32_bf16 v[164:167], v[68:71], v[108:111], v[164:167]
    ds_read_b128 v[128:131], v48 offset:8560
    s_waitcnt lgkmcnt(2)
    v_mfma_f32_16x16x32_bf16 v[164:167], v[120:123], v[88:91], v[164:167]
    ds_read_b64 v[116:117], v51 offset:0
    ds_read_b64 v[118:119], v51 offset:8
    v_cvt_pk_bf16_f32 v87, v36, v32
    v_cvt_pk_bf16_f32 v86, v37, v33
    v_cvt_pk_bf16_f32 v85, v38, v34
    v_cvt_pk_bf16_f32 v84, v39, v35
    v_mfma_f32_16x16x32_bf16 v[164:167], v[140:143], v[136:139], v[164:167]
    s_waitcnt lgkmcnt(3)
    v_mfma_f32_16x16x32_bf16 v[164:167], v[60:63], v[104:107], v[164:167]
    s_waitcnt lgkmcnt(2)
    v_mfma_f32_16x16x32_bf16 v[164:167], v[56:59], v[128:131], v[164:167]
    s_waitcnt lgkmcnt(0)
    v_mfma_f32_16x16x32_bf16 v[164:167], v[84:87], v[116:119], v[164:167]
    s_nop 7
    v_cvt_pk_bf16_f32 v164, v164, v165
    v_cvt_pk_bf16_f32 v165, v166, v167
    ds_write_b64 v54, v[164:165] offset:12640
    s_mov_b64 exec, 1
    ds_add_u32 v15, v14 offset:12
    s_mov_b64 exec, -1
    s_cmp_ge_u32 s31, 4
    s_cbranch_scc1 L_A_oX3
    s_mov_b32 s3, 0x100000
L_A_wX3:
    ds_read_b32 v13, v15 offset:12
    s_sub_u32 s3, s3, 1
    s_cbranch_scc1 L_A_xX3
    s_waitcnt lgkmcnt(0)
    v_cmp_eq_u32 vcc, 12, v13
    s_nop 4
    s_cbranch_vccnz L_A_xX3
    s_sleep 1
    s_branch L_A_wX3
L_A_xX3:
    s_and_b32 s3, s31, 3
    s_cmp_lt_u32 s3, 2
    s_cselect_b32 s4, 4, 7
    s_and_b32 s3, s3, 1
    s_lshl_b32 s5, s4, 9
    s_lshl_b32 s6, s3, 8
    s_add_u32 s5, s5, s6
    s_add_u32 s5, s5, 65888
    v_lshl_add_u32 v12, v1, 2, s5
    v_add_u32 v13, 50304, v12
    ds_read_b32 v148, v12 offset:0
    ds_read_b32 v149, v12 offset:16768
    ds_read_b32 v150, v12 offset:33536
    ds_read_b32 v151, v13 offset:0
    ds_read_b32 v152, v13 offset:16768
    ds_read_b32 v153, v13 offset:33536
    s_lshl_b32 s4, s4, 8
    s_lshl_b32 s3, s3, 3
    s_add_u32 s4, s4, s3
    s_mul_i32 s4, s4, 2304
    s_add_u32 s4, s4, s54
    v_add_u32 v13, s4, v8
    s_waitcnt lgkmcnt(0)
    v_perm_b32 v10, v149, v148, s52
    v_perm_b32 v11, v151, v150, s52
    v_perm_b32 v12, v153, v152, s52
    global_store_dwordx3 v13, v[10:12], s[60:61] offset:0
    v_perm_b32 v148, v149, v148, s53
    v_perm_b32 v149, v151, v150, s53
    v_perm_b32 v150, v153, v152, s53
    global_store_dwordx3 v13, v[148:150], s[60:61] offset:2304
L_A_oX3:
    s_branch L_A_out
L_A_Y:
    s_cmp_ge_u32 s31, 8
    s_cbranch_scc1 L_A_tY
    v_lshlrev_b32 v4, 3, v35
    v_add_u32 v4, 61792, v4
    v_add_u32 v5, 50304, v4
    s_waitcnt vmcnt(0)
    v_perm_b32 v124, v36, v32, s52
    v_perm_b32 v125, v44, v40, s52
    ds_write_b64 v4, v[124:125] offset:0
    v_perm_b32 v126, v36, v32, s53
    v_perm_b32 v127, v44, v40, s53
    ds_write_b64 v4, v[126:127] offset:16768
    v_perm_b32 v128, v37, v33, s52
    v_perm_b32 v129, v45, v41, s52
    ds_write_b64 v4, v[128:129] offset:33536
    v_perm_b32 v130, v37, v33, s53
    v_perm_b32 v131, v45, v41, s53
    ds_write_b64 v5, v[130:131] offset:0
    v_perm_b32 v132, v38, v34, s52
    v_perm_b32 v133, v46, v42, s52
    ds_write_b64 v5, v[132:133] offset:16768
    v_perm_b32 v134, v38, v34, s53
    v_perm_b32 v135, v46, v42, s53
    ds_write_b64 v5, v[134:135] offset:33536
    s_setprio 0
    s_mov_b32 s3, 0x100000
L_A_fwy:
    ds_read_b32 v4, v55 offset:13680
    ds_read_b32 v5, v55 offset:10592
    s_sub_u32 s3, s3, 1
    s_cbranch_scc1 L_A_fxy
    s_waitcnt lgkmcnt(0)
    v_min_u32 v4, v4, v5
    v_cmp_le_u32 vcc, 2, v4
    s_nop 4
    s_cbranch_vccnz L_A_fxy
    s_sleep 2
    s_branch L_A_fwy
L_A_fxy:
    ds_read_b64 v[120:121], v49 offset:0
    ds_read_b64 v[122:123], v49 offset:8
    ds_read_b64 v[116:117], v49 offset:64
    ds_read_b64 v[118:119], v49 offset:72
    ds_read_b64 v[112:113], v49 offset:128
    ds_read_b64 v[114:115], v49 offset:136
    ds_read_b64 v[108:109], v49 offset:192
    ds_read_b64 v[110:111], v49 offset:200
    ds_read_b64 v[104:105], v49 offset:256
    ds_read_b64 v[106:107], v49 offset:264
    ds_read_b64 v[100:101], v49 offset:320
    ds_read_b64 v[102:103], v49 offset:328
    ds_read_b64 v[96:97], v49 offset:384
    ds_read_b64 v[98:99], v49 offset:392
    ds_read_b64 v[92:93], v49 offset:448
    ds_read_b64 v[94:95], v49 offset:456
    ds_read_b64 v[88:89], v49 offset:512
    ds_read_b64 v[90:91], v49 offset:520
    s_waitcnt lgkmcnt(0)
    s_barrier
    s_setprio 3
    s_branch L_A_krY
L_A_tY:
    s_waitcnt vmcnt(0) lgkmcnt(0)
    s_barrier
    s_setprio 3
    ds_read_b64 v[120:121], v49 offset:0
    ds_read_b64 v[122:123], v49 offset:8
    ds_read_b64 v[116:117], v49 offset:64
    ds_read_b64 v[118:119], v49 offset:72
    ds_read_b64 v[112:113], v49 offset:128
    ds_read_b64 v[114:115], v49 offset:136
    ds_read_b64 v[108:109], v49 offset:192
    ds_read_b64 v[110:111], v49 offset:200
    ds_read_b64 v[104:105], v49 offset:256
    ds_read_b64 v[106:107], v49 offset:264
    ds_read_b64 v[100:101], v49 offset:320
    ds_read_b64 v[102:103], v49 offset:328
    ds_read_b64 v[96:97], v49 offset:384
    ds_read_b64 v[98:99], v49 offset:392
    ds_read_b64 v[92:93], v49 offset:448
    ds_read_b64 v[94:95], v49 offset:456
    ds_read_b64 v[88:89], v49 offset:512
    ds_read_b64 v[90:91], v49 offset:520
    s_mov_b32 s3, 0x100000
L_A_fwz:
    ds_read_b32 v4, v55 offset:13680
    s_sub_u32 s3, s3, 1
    s_cbranch_scc1 L_A_fxz
    s_waitcnt lgkmcnt(0)
    v_cmp_le_u32 vcc, 3, v4
    s_nop 4
    s_cbranch_vccnz L_A_fxz
    s_sleep 2
    s_branch L_A_fwz
L_A_fxz:
L_A_krY:
    ds_read_b128 v[56:59], v52 offset:6960
    ds_read_b128 v[60:63], v52 offset:7216
    ds_read_b64 v[64:65], v50 offset:5232
    ds_read_b64 v[66:67], v50 offset:5240
    s_waitcnt lgkmcnt(3)
    v_mfma_f32_16x16x32_bf16 v[32:35], v[56:59], v[16:19], 0
    v_mfma_f32_16x16x32_bf16 v[36:39], v[56:59], v[20:23], 0
    ds_read_b128 v[68:71], v52 offset:7472
    s_nop 6
    v_cvt_pk_bf16_f32 v75, v36, v32
    v_cvt_pk_bf16_f32 v74, v37, v33
    v_cvt_pk_bf16_f32 v73, v38, v34
    v_cvt_pk_bf16_f32 v72, v39, v35
    ds_read_b64 v[76:77], v50 offset:5168
    ds_read_b64 v[78:79], v50 offset:5176
    s_waitcnt lgkmcnt(5)
    v_mfma_f32_16x16x32_bf16 v[40:43], v[60:63], v[16:19], 0
    v_mfma_f32_16x16x32_bf16 v[44:47], v[60:63], v[20:23], 0
    s_waitcnt lgkmcnt(3)
    v_mfma_f32_16x16x32_bf16 v[148:151], v[72:75], v[64:67], 0
    ds_read_b128 v[80:83], v52 offset:7728
    s_nop 4
    v_cvt_pk_bf16_f32 v87, v44, v40
    v_cvt_pk_bf16_f32 v86, v45, v41
    v_cvt_pk_bf16_f32 v85, v46, v42
    v_cvt_pk_bf16_f32 v84, v47, v43
    ds_read_b64 v[124:125], v50 offset:5104
    ds_read_b64 v[126:127], v50 offset:5112
    s_waitcnt lgkmcnt(5)
    v_mfma_f32_16x16x32_bf16 v[32:35], v[68:71], v[16:19], 0
    v_mfma_f32_16x16x32_bf16 v[36:39], v[68:71], v[20:23], 0
    ds_read_u16 v9, v55 offset:5238
    ds_read_b128 v[4:7], v7 offset:4096
    s_waitcnt lgkmcnt(5)
    v_mfma_f32_16x16x32_bf16 v[148:151], v[84:87], v[76:79], v[148:151]
    s_nop 3
    v_cvt_pk_bf16_f32 v131, v36, v32
    v_cvt_pk_bf16_f32 v130, v37, v33
    v_cvt_pk_bf16_f32 v129, v38, v34
    v_cvt_pk_bf16_f32 v128, v39, v35
    ds_read_b128 v[132:135], v52 offset:7984
    s_waitcnt lgkmcnt(5)
    v_mfma_f32_16x16x32_bf16 v[40:43], v[80:83], v[16:19], 0
    v_mfma_f32_16x16x32_bf16 v[44:47], v[80:83], v[20:23], 0
    ds_read_b64 v[136:137], v50 offset:5040
    ds_read_b64 v[138:139], v50 offset:5048
    s_waitcnt lgkmcnt(5)
    v_mfma_f32_16x16x32_bf16 v[148:151], v[128:131], v[124:127], v[148:151]
    s_waitcnt lgkmcnt(3)
    v_lshl_or_b32 v9, v9, 16, v9
    v_and_b32 v4, v9, v4
    v_mfma_f32_16x16x32_bf16 v[152:155], v[128:131], v[64:67], 0
    v_and_b32 v5, v9, v5
    v_and_b32 v6, v9, v6
    v_cvt_pk_bf16_f32 v143, v44, v40
    v_cvt_pk_bf16_f32 v142, v45, v41
    v_cvt_pk_bf16_f32 v141, v46, v42
    v_cvt_pk_bf16_f32 v140, v47, v43
    ds_read_b128 v[144:147], v52 offset:8240
    s_waitcnt lgkmcnt(3)
    v_mfma_f32_16x16x32_bf16 v[32:35], v[132:135], v[16:19], 0
    v_mfma_f32_16x16x32_bf16 v[36:39], v[132:135], v[20:23], 0
    ds_read_b64 v[56:57], v50 offset:4976
    ds_read_b64 v[58:59], v50 offset:4984
    s_waitcnt lgkmcnt(3)
    v_mfma_f32_16x16x32_bf16 v[148:151], v[140:143], v[136:139], v[148:151]
    v_and_b32 v7, v9, v7
    v_mfma_f32_16x16x32_bf16 v[152:155], v[140:143], v[76:79], v[152:155]
    s_nop 1
    v_cvt_pk_bf16_f32 v63, v36, v32
    v_cvt_pk_bf16_f32 v62, v37, v33
    v_cvt_pk_bf16_f32 v61, v38, v34
    v_cvt_pk_bf16_f32 v60, v39, v35
    s_waitcnt lgkmcnt(2)
    v_mfma_f32_16x16x32_bf16 v[40:43], v[144:147], v[16:19], 0
    v_mfma_f32_16x16x32_bf16 v[44:47], v[144:147], v[20:23], 0
    ds_read_b64 v[72:73], v53 offset:6456
    ds_read_b64 v[74:75], v53 offset:6464
    s_waitcnt lgkmcnt(2)
    v_mfma_f32_16x16x32_bf16 v[148:151], v[60:63], v[56:59], v[148:151]
    ds_read_b64 v[68:69], v50 offset:4912
    ds_read_b64 v[70:71], v50 offset:4920
    v_mfma_f32_16x16x32_bf16 v[152:155], v[60:63], v[124:127], v[152:155]
    v_mfma_f32_16x16x32_bf16 v[156:159], v[60:63], v[64:67], 0
    v_cvt_pk_bf16_f32 v87, v44, v40
    v_cvt_pk_bf16_f32 v86, v45, v41
    v_cvt_pk_bf16_f32 v85, v46, v42
    v_cvt_pk_bf16_f32 v84, v47, v43
    s_waitcnt lgkmcnt(2)
    v_mfma_f32_16x16x32_bf16 v[32:35], v[72:75], v[24:27], 0
    v_mfma_f32_16x16x32_bf16 v[36:39], v[72:75], v[28:31], 0
    ds_read_b64 v[80:81], v53 offset:6968
    ds_read_b64 v[82:83], v53 offset:6976
    s_waitcnt lgkmcnt(2)
    v_mfma_f32_16x16x32_bf16 v[148:151], v[84:87], v[68:71], v[148:151]
    ds_read_b64 v[128:129], v51 offset:64
    ds_read_b64 v[130:131], v51 offset:72
    v_mfma_f32_16x16x32_bf16 v[152:155], v[84:87], v[136:139], v[152:155]
    ds_read_b64 v[132:133], v51 offset:128
    ds_read_b64 v[134:135], v51 offset:136
    v_mfma_f32_16x16x32_bf16 v[156:159], v[84:87], v[76:79], v[156:159]
    ds_read_b64 v[140:141], v51 offset:192
    ds_read_b64 v[142:143], v51 offset:200
    v_cvt_pk_bf16_f32 v147, v36, v32
    v_cvt_pk_bf16_f32 v146, v37, v33
    v_cvt_pk_bf16_f32 v145, v38, v34
    v_cvt_pk_bf16_f32 v144, v39, v35
    s_waitcnt lgkmcnt(6)
    v_mfma_f32_16x16x32_bf16 v[40:43], v[80:83], v[24:27], 0
    v_mfma_f32_16x16x32_bf16 v[44:47], v[80:83], v[28:31], 0
    ds_read_b64 v[64:65], v51 offset:0
    ds_read_b64 v[66:67], v51 offset:8
    s_waitcnt lgkmcnt(6)
    v_mfma_f32_16x16x32_bf16 v[148:151], v[144:147], v[128:131], v[148:151]
    s_waitcnt lgkmcnt(4)
    v_mfma_f32_16x16x32_bf16 v[152:155], v[144:147], v[132:135], v[152:155]
    s_waitcnt lgkmcnt(2)
    v_mfma_f32_16x16x32_bf16 v[156:159], v[144:147], v[140:143], v[156:159]
    v_cvt_pk_bf16_f32 v63, v44, v40
    v_cvt_pk_bf16_f32 v62, v45, v41
    v_cvt_pk_bf16_f32 v61, v46, v42
    v_cvt_pk_bf16_f32 v60, v47, v43
    ds_read_b128 v[72:75], v48 offset:7024
    s_waitcnt lgkmcnt(1)
    v_mfma_f32_16x16x32_bf16 v[148:151], v[60:63], v[64:67], v[148:151]
    v_mfma_f32_16x16x32_bf16 v[152:155], v[60:63], v[128:131], v[152:155]
    ds_read_b128 v[76:79], v48 offset:8048
    v_mfma_f32_16x16x32_bf16 v[156:159], v[60:63], v[132:135], v[156:159]
    s_setprio 2
    s_waitcnt lgkmcnt(1)
    v_mfma_f32_16x16x32_bf16 v[148:151], v[4:7], v[72:75], v[148:151]
    s_mov_b32 s3, 0x100000
L_A_wYu2:
    ds_read_b32 v13, v15 offset:16
    s_sub_u32 s3, s3, 1
    s_cbranch_scc1 L_A_xYu2
    s_waitcnt lgkmcnt(0)
    v_cmp_eq_u32 vcc, 4, v13
    s_nop 4
    s_cbranch_vccnz L_A_xYu2
    s_sleep 1
    s_branch L_A_wYu2
L_A_xYu2:
    ds_read_b128 v[84:87], v48 offset:8112
    ds_read_b128 v[80:83], v48 offset:8176
    ds_read_b128 v[140:143], v48 offset:8240
    ds_read_b128 v[144:147], v48 offset:8304
    v_mfma_f32_16x16x32_bf16 v[148:151], v[120:123], v[76:79], v[148:151]
    ds_read_b128 v[132:135], v48 offset:8368
    s_waitcnt lgkmcnt(4)
    v_mfma_f32_16x16x32_bf16 v[148:151], v[116:119], v[84:87], v[148:151]
    ds_read_b128 v[60:63], v48 offset:8432
    s_waitcnt lgkmcnt(4)
    v_mfma_f32_16x16x32_bf16 v[148:151], v[112:115], v[80:83], v[148:151]
    ds_read_b128 v[72:75], v48 offset:8496
    s_waitcnt lgkmcnt(4)
    v_mfma_f32_16x16x32_bf16 v[148:151], v[108:111], v[140:143], v[148:151]
    ds_read_b128 v[84:87], v48 offset:8560
    s_waitcnt lgkmcnt(4)
    v_mfma_f32_16x16x32_bf16 v[148:151], v[104:107], v[144:147], v[148:151]
    s_waitcnt lgkmcnt(3)
    v_mfma_f32_16x16x32_bf16 v[148:151], v[100:103], v[132:135], v[148:151]
    ds_read_b64 v[80:81], v49 offset:576
    ds_read_b64 v[82:83], v49 offset:584
    ds_read_b128 v[140:143], v48 offset:8624
    s_waitcnt lgkmcnt(5)
    v_mfma_f32_16x16x32_bf16 v[148:151], v[96:99], v[60:63], v[148:151]
    s_waitcnt lgkmcnt(4)
    v_mfma_f32_16x16x32_bf16 v[148:151], v[92:95], v[72:75], v[148:151]
    ds_read_b64 v[144:145], v49 offset:640
    ds_read_b64 v[146:147], v49 offset:648
    ds_read_b128 v[132:135], v48 offset:8688
    s_waitcnt lgkmcnt(6)
    v_mfma_f32_16x16x32_bf16 v[148:151], v[88:91], v[84:87], v[148:151]
    v_mfma_f32_16x16x32_bf16 v[152:155], v[120:123], v[84:87], v[152:155]
    ds_read_b64 v[60:61], v49 offset:704
    ds_read_b64 v[62:63], v49 offset:712
    ds_read_b128 v[72:75], v48 offset:8752
    s_waitcnt lgkmcnt(6)
    v_mfma_f32_16x16x32_bf16 v[148:151], v[80:83], v[140:143], v[148:151]
    v_mfma_f32_16x16x32_bf16 v[152:155], v[116:119], v[140:143], v[152:155]
    s_waitcnt lgkmcnt(3)
    v_mfma_f32_16x16x32_bf16 v[148:151], v[144:147], v[132:135], v[148:151]
    ds_read_b64 v[84:85], v49 offset:768
    ds_read_b64 v[86:87], v49 offset:776
    ds_read_b128 v[140:143], v48 offset:8816
    v_mfma_f32_16x16x32_bf16 v[152:155], v[112:115], v[132:135], v[152:155]
    s_waitcnt lgkmcnt(3)
    v_mfma_f32_16x16x32_bf16 v[148:151], v[60:63], v[72:75], v[148:151]
    ds_read_b64 v[132:133], v49 offset:832
    ds_read_b64 v[134:135], v49 offset:840
    ds_read_b128 v[76:79], v48 offset:8880
    v_mfma_f32_16x16x32_bf16 v[152:155], v[108:111], v[72:75], v[152:155]
    s_cmp_ge_u32 s31, 4
    s_cbranch_scc1 L_A_oY0
    s_mov_b32 s3, 0x100000
L_A_wY0:
    ds_read_b32 v13, v15 offset:0
    s_sub_u32 s3, s3, 1
    s_cbranch_scc1 L_A_xY0
    s_waitcnt lgkmcnt(0)
    v_cmp_eq_u32 vcc, 6, v13
    s_nop 4
    s_cbranch_vccnz L_A_xY0
    s_sleep 1
    s_branch L_A_wY0
L_A_xY0:
    s_and_b32 s3, s31, 3
    s_cmp_lt_u32 s3, 2
    s_cselect_b32 s4, 0, 1
    s_and_b32 s3, s3, 1
    s_lshl_b32 s5, s4, 9
    s_lshl_b32 s6, s3, 8
    s_add_u32 s5, s5, s6
    s_add_u32 s5, s5, 65888
    v_lshl_add_u32 v12, v1, 2, s5
    v_add_u32 v13, 50304, v12
    ds_read_b32 v160, v12 offset:0
    ds_read_b32 v161, v12 offset:16768
    ds_read_b32 v162, v12 offset:33536
    ds_read_b32 v163, v13 offset:0
    ds_read_b32 v164, v13 offset:16768
    ds_read_b32 v165, v13 offset:33536
    s_lshl_b32 s4, s4, 8
    s_lshl_b32 s3, s3, 3
    s_add_u32 s4, s4, s3
    s_mul_i32 s4, s4, 2304
    s_add_u32 s4, s4, s54
    v_add_u32 v13, s4, v8
    s_waitcnt lgkmcnt(0)
    v_perm_b32 v10, v161, v160, s52
    v_perm_b32 v11, v163, v162, s52
    v_perm_b32 v12, v165, v164, s52
    global_store_dwordx3 v13, v[10:12], s[60:61] offset:0
    v_perm_b32 v160, v161, v160, s53
    v_perm_b32 v161, v163, v162, s53
    v_perm_b32 v162, v165, v164, s53
    global_store_dwordx3 v13, v[160:162], s[60:61] offset:2304
L_A_oY0:
    ds_read_b64 v[72:73], v49 offset:896
    ds_read_b64 v[74:75], v49 offset:904
    ds_read_b128 v[128:131], v48 offset:8944
    s_waitcnt lgkmcnt(6)
    v_mfma_f32_16x16x32_bf16 v[148:151], v[84:87], v[140:143], v[148:151]
    v_mfma_f32_16x16x32_bf16 v[152:155], v[104:107], v[140:143], v[152:155]
    ds_read_b64 v[140:141], v49 offset:960
    ds_read_b64 v[142:143], v49 offset:968
    ds_read_b128 v[64:67], v48 offset:9008
    s_waitcnt lgkmcnt(6)
    v_mfma_f32_16x16x32_bf16 v[148:151], v[132:135], v[76:79], v[148:151]
    v_mfma_f32_16x16x32_bf16 v[152:155], v[100:103], v[76:79], v[152:155]
    ds_read_b64 v[76:77], v49 offset:1024
    ds_read_b64 v[78:79], v49 offset:1032
    ds_read_b128 v[136:139], v48 offset:9072
    s_waitcnt lgkmcnt(6)
    v_mfma_f32_16x16x32_bf16 v[148:151], v[72:75], v[128:131], v[148:151]
    v_mfma_f32_16x16x32_bf16 v[152:155], v[96:99], v[128:131], v[152:155]
    s_waitcnt lgkmcnt(3)
    v_mfma_f32_16x16x32_bf16 v[148:151], v[140:143], v[64:67], v[148:151]
    v_mfma_f32_16x16x32_bf16 v[152:155], v[92:95], v[64:67], v[152:155]
    s_waitcnt lgkmcnt(0)
    v_mfma_f32_16x16x32_bf16 v[148:151], v[76:79], v[136:139], v[148:151]
    ds_read_b128 v[128:131], v48 offset:7536
    v_mfma_f32_16x16x32_bf16 v[152:155], v[88:91], v[136:139], v[152:155]
    ds_read_b128 v[64:67], v52 offset:8496
    v_mfma_f32_16x16x32_bf16 v[156:159], v[120:123], v[136:139], v[156:159]
    ds_read_b128 v[120:123], v48 offset:9136
    s_nop 2
    v_cvt_pk_bf16_f32 v148, v148, v149
    v_cvt_pk_bf16_f32 v149, v150, v151
    ds_write_b64 v54, v[148:149] offset:13152
    s_mov_b64 exec, 1
    ds_add_u32 v15, v14 offset:4
    s_mov_b64 exec, -1
    s_setprio 1
    ds_read_b128 v[136:139], v48 offset:9200
    s_waitcnt lgkmcnt(5)
    v_mfma_f32_16x16x32_bf16 v[152:155], v[4:7], v[128:131], v[152:155]
    s_waitcnt lgkmcnt(4)
    v_mfma_f32_16x16x32_bf16 v[32:35], v[64:67], v[16:19], 0
    v_mfma_f32_16x16x32_bf16 v[36:39], v[64:67], v[20:23], 0
    s_waitcnt lgkmcnt(3)
    v_mfma_f32_16x16x32_bf16 v[152:155], v[80:83], v[120:123], v[152:155]
    ds_read_b128 v[128:131], v52 offset:8752
    v_mfma_f32_16x16x32_bf16 v[156:159], v[116:119], v[120:123], v[156:159]
    ds_read_b128 v[64:67], v48 offset:9264
    s_waitcnt lgkmcnt(2)
    v_mfma_f32_16x16x32_bf16 v[152:155], v[144:147], v[136:139], v[152:155]
    s_nop 0
    v_cvt_pk_bf16_f32 v119, v36, v32
    v_cvt_pk_bf16_f32 v118, v37, v33
    v_cvt_pk_bf16_f32 v117, v38, v34
    v_cvt_pk_bf16_f32 v116, v39, v35
    ds_read_b128 v[120:123], v48 offset:9328
    v_mfma_f32_16x16x32_bf16 v[156:159], v[112:115], v[136:139], v[156:159]
    s_waitcnt lgkmcnt(2)
    v_mfma_f32_16x16x32_bf16 v[40:43], v[128:131], v[16:19], 0
    v_mfma_f32_16x16x32_bf16 v[44:47], v[128:131], v[20:23], 0
    s_waitcnt lgkmcnt(1)
    v_mfma_f32_16x16x32_bf16 v[152:155], v[60:63], v[64:67], v[152:155]
    v_mfma_f32_16x16x32_bf16 v[156:159], v[108:111], v[64:67], v[156:159]
    s_waitcnt lgkmcnt(0)
    v_mfma_f32_16x16x32_bf16 v[152:155], v[84:87], v[120:123], v[152:155]
    ds_read_b64 v[112:113], v53 offset:7480
    ds_read_b64 v[114:115], v53 offset:7488
    s_nop 0
    v_cvt_pk_bf16_f32 v111, v44, v40
    v_cvt_pk_bf16_f32 v110, v45, v41
    v_cvt_pk_bf16_f32 v109, v46, v42
    v_cvt_pk_bf16_f32 v108, v47, v43
    ds_read_b128 v[136:139], v48 offset:9392
    v_mfma_f32_16x16x32_bf16 v[152:155], v[116:119], v[56:59], v[152:155]
    v_mfma_f32_16x16x32_bf16 v[156:159], v[116:119], v[124:127], v[156:159]
    v_mfma_f32_16x16x32_bf16 v[156:159], v[104:107], v[120:123], v[156:159]
    ds_read_b128 v[128:131], v48 offset:9456
    s_waitcnt lgkmcnt(2)
    v_mfma_f32_16x16x32_bf16 v[32:35], v[112:115], v[24:27], 0
    v_mfma_f32_16x16x32_bf16 v[36:39], v[112:115], v[28:31], 0
    s_waitcnt lgkmcnt(1)
    v_mfma_f32_16x16x32_bf16 v[152:155], v[132:135], v[136:139], v[152:155]
    v_mfma_f32_16x16x32_bf16 v[156:159], v[100:103], v[136:139], v[156:159]
    ds_read_b64 v[64:65], v50 offset:5040
    ds_read_b64 v[66:67], v50 offset:5048
    s_cmp_ge_u32 s31, 4
    s_cbranch_scc1 L_A_oY1
    s_mov_b32 s3, 0x100000
L_A_wY1:
    ds_read_b32 v13, v15 offset:4
    s_sub_u32 s3, s3, 1
    s_cbranch_scc1 L_A_xY1
    s_waitcnt lgkmcnt(0)
    v_cmp_eq_u32 vcc, 12, v13
    s_nop 4
    s_cbranch_vccnz L_A_xY1
    s_sleep 1
    s_branch L_A_wY1
L_A_xY1:
    s_and_b32 s3, s31, 3
    s_cmp_lt_u32 s3, 2
    s_cselect_b32 s4, 2, 5
    s_and_b32 s3, s3, 1
    s_lshl_b32 s5, s4, 9
    s_lshl_b32 s6, s3, 8
    s_add_u32 s5, s5, s6
    s_add_u32 s5, s5, 65888
    v_lshl_add_u32 v12, v1, 2, s5
    v_add_u32 v13, 50304, v12
    ds_read_b32 v160, v12 offset:0
    ds_read_b32 v161, v12 offset:16768
    ds_read_b32 v162, v12 offset:33536
    ds_read_b32 v163, v13 offset:0
    ds_read_b32 v164, v13 offset:16768
    ds_read_b32 v165, v13 offset:33536
    s_lshl_b32 s4, s4, 8
    s_lshl_b32 s3, s3, 3
    s_add_u32 s4, s4, s3
    s_mul_i32 s4, s4, 2304
    s_add_u32 s4, s4, s54
    v_add_u32 v13, s4, v8
    s_waitcnt lgkmcnt(0)
    v_perm_b32 v10, v161, v160, s52
    v_perm_b32 v11, v163, v162, s52
    v_perm_b32 v12, v165, v164, s52
    global_store_dwordx3 v13, v[10:12], s[60:61] offset:0
    v_perm_b32 v160, v161, v160, s53
    v_perm_b32 v161, v163, v162, s53
    v_perm_b32 v162, v165, v164, s53
    global_store_dwordx3 v13, v[160:162], s[60:61] offset:2304
L_A_oY1:
    s_waitcnt lgkmcnt(2)
    v_mfma_f32_16x16x32_bf16 v[152:155], v[72:75], v[128:131], v[152:155]
    ds_read_b128 v[104:107], v48 offset:9520
    v_cvt_pk_bf16_f32 v127, v36, v32
    v_cvt_pk_bf16_f32 v126, v37, v33
    v_cvt_pk_bf16_f32 v125, v38, v34
    v_cvt_pk_bf16_f32 v124, v39, v35
    v_mfma_f32_16x16x32_bf16 v[152:155], v[108:111], v[68:71], v[152:155]
    ds_read_b128 v[116:119], v48 offset:9584
    s_waitcnt lgkmcnt(2)
    v_mfma_f32_16x16x32_bf16 v[156:159], v[108:111], v[64:67], v[156:159]
    ds_read_b64 v[120:121], v51 offset:0
    ds_read_b64 v[122:123], v51 offset:8
    v_mfma_f32_16x16x32_bf16 v[156:159], v[96:99], v[128:131], v[156:159]
    ds_read_b64 v[100:101], v51 offset:64
    ds_read_b64 v[102:103], v51 offset:72
    s_waitcnt lgkmcnt(5)
    v_mfma_f32_16x16x32_bf16 v[152:155], v[140:143], v[104:107], v[152:155]
    v_mfma_f32_16x16x32_bf16 v[156:159], v[92:95], v[104:107], v[156:159]
    s_waitcnt lgkmcnt(4)
    v_mfma_f32_16x16x32_bf16 v[152:155], v[76:79], v[116:119], v[152:155]
    s_waitcnt lgkmcnt(2)
    v_mfma_f32_16x16x32_bf16 v[152:155], v[124:127], v[120:123], v[152:155]
    ds_read_b128 v[112:115], v48 offset:8048
    s_waitcnt lgkmcnt(1)
    v_mfma_f32_16x16x32_bf16 v[156:159], v[124:127], v[100:103], v[156:159]
    ds_read_b128 v[136:139], v52 offset:9008
    v_mfma_f32_16x16x32_bf16 v[156:159], v[88:91], v[116:119], v[156:159]
    ds_read_b128 v[108:111], v48 offset:9648
    s_nop 1
    v_cvt_pk_bf16_f32 v152, v152, v153
    v_cvt_pk_bf16_f32 v153, v154, v155
    ds_write_b64 v54, v[152:153] offset:13664
    ds_read_b128 v[64:67], v48 offset:9712
    s_mov_b64 exec, 1
    ds_add_u32 v15, v14 offset:8
    s_mov_b64 exec, -1
    s_setprio 0
    s_waitcnt lgkmcnt(5)
    v_mfma_f32_16x16x32_bf16 v[156:159], v[4:7], v[112:115], v[156:159]
    ds_read_b128 v[96:99], v52 offset:9264
    s_waitcnt lgkmcnt(5)
    v_mfma_f32_16x16x32_bf16 v[40:43], v[136:139], v[16:19], 0
    v_mfma_f32_16x16x32_bf16 v[44:47], v[136:139], v[20:23], 0
    ds_read_b128 v[128:131], v48 offset:9776
    s_waitcnt lgkmcnt(5)
    v_mfma_f32_16x16x32_bf16 v[156:159], v[80:83], v[108:111], v[156:159]
    ds_read_b128 v[92:95], v48 offset:9840
    s_waitcnt lgkmcnt(4)
    v_mfma_f32_16x16x32_bf16 v[156:159], v[144:147], v[64:67], v[156:159]
    s_nop 1
    v_cvt_pk_bf16_f32 v107, v44, v40
    v_cvt_pk_bf16_f32 v106, v45, v41
    v_cvt_pk_bf16_f32 v105, v46, v42
    v_cvt_pk_bf16_f32 v104, v47, v43
    s_waitcnt lgkmcnt(2)
    v_mfma_f32_16x16x32_bf16 v[32:35], v[96:99], v[16:19], 0
    v_mfma_f32_16x16x32_bf16 v[36:39], v[96:99], v[20:23], 0
    ds_read_b64 v[124:125], v53 offset:7992
    ds_read_b64 v[126:127], v53 offset:8000
    s_waitcnt lgkmcnt(3)
    v_mfma_f32_16x16x32_bf16 v[156:159], v[60:63], v[128:131], v[156:159]
    s_waitcnt lgkmcnt(2)
    v_mfma_f32_16x16x32_bf16 v[156:159], v[84:87], v[92:95], v[156:159]
    ds_read_b128 v[100:103], v48 offset:9904
    s_nop 0
    v_cvt_pk_bf16_f32 v91, v36, v32
    v_cvt_pk_bf16_f32 v90, v37, v33
    v_cvt_pk_bf16_f32 v89, v38, v34
    v_cvt_pk_bf16_f32 v88, v39, v35
    ds_read_b128 v[116:119], v48 offset:9968
    v_mfma_f32_16x16x32_bf16 v[156:159], v[104:107], v[56:59], v[156:159]
    s_waitcnt lgkmcnt(2)
    v_mfma_f32_16x16x32_bf16 v[40:43], v[124:127], v[24:27], 0
    v_mfma_f32_16x16x32_bf16 v[44:47], v[124:127], v[28:31], 0
    s_cmp_ge_u32 s31, 4
    s_cbranch_scc1 L_A_oY2
    s_mov_b32 s3, 0x100000
L_A_wY2:
    ds_read_b32 v13, v15 offset:8
    s_sub_u32 s3, s3, 1
    s_cbranch_scc1 L_A_xY2
    s_waitcnt lgkmcnt(0)
    v_cmp_eq_u32 vcc, 12, v13
    s_nop 4
    s_cbranch_vccnz L_A_xY2
    s_sleep 1
    s_branch L_A_wY2
L_A_xY2:
    s_and_b32 s3, s31, 3
    s_cmp_lt_u32 s3, 2
    s_cselect_b32 s4, 3, 6
    s_and_b32 s3, s3, 1
    s_lshl_b32 s5, s4, 9
    s_lshl_b32 s6, s3, 8
    s_add_u32 s5, s5, s6
    s_add_u32 s5, s5, 65888
    v_lshl_add_u32 v12, v1, 2, s5
    v_add_u32 v13, 50304, v12
    ds_read_b32 v160, v12 offset:0
    ds_read_b32 v161, v12 offset:16768
    ds_read_b32 v162, v12 offset:33536
    ds_read_b32 v163, v13 offset:0
    ds_read_b32 v164, v13 offset:16768
    ds_read_b32 v165, v13 offset:33536
    s_lshl_b32 s4, s4, 8
    s_lshl_b32 s3, s3, 3
    s_add_u32 s4, s4, s3
    s_mul_i32 s4, s4, 2304
    s_add_u32 s4, s4, s54
    v_add_u32 v13, s4, v8
    s_waitcnt lgkmcnt(0)
    v_perm_b32 v10, v161, v160, s52
    v_perm_b32 v11, v163, v162, s52
    v_perm_b32 v12, v165, v164, s52
    global_store_dwordx3 v13, v[10:12], s[60:61] offset:0
    v_perm_b32 v160, v161, v160, s53
    v_perm_b32 v161, v163, v162, s53
    v_perm_b32 v162, v165, v164, s53
    global_store_dwordx3 v13, v[160:162], s[60:61] offset:2304
L_A_oY2:
    ds_read_b128 v[112:115], v48 offset:10032
    s_waitcnt lgkmcnt(2)
    v_mfma_f32_16x16x32_bf16 v[156:159], v[132:135], v[100:103], v[156:159]
    ds_read_b128 v[136:139], v48 offset:10096
    s_waitcnt lgkmcnt(2)
    v_mfma_f32_16x16x32_bf16 v[156:159], v[72:75], v[116:119], v[156:159]
    v_cvt_pk_bf16_f32 v83, v44, v40
    v_cvt_pk_bf16_f32 v82, v45, v41
    v_cvt_pk_bf16_f32 v81, v46, v42
    v_cvt_pk_bf16_f32 v80, v47, v43
    v_mfma_f32_16x16x32_bf16 v[156:159], v[88:91], v[68:71], v[156:159]
    s_waitcnt lgkmcnt(1)
    v_mfma_f32_16x16x32_bf16 v[156:159], v[140:143], v[112:115], v[156:159]
    s_waitcnt lgkmcnt(0)
    v_mfma_f32_16x16x32_bf16 v[156:159], v[76:79], v[136:139], v[156:159]
    v_mfma_f32_16x16x32_bf16 v[156:159], v[80:83], v[120:123], v[156:159]
    s_nop 7
    v_cvt_pk_bf16_f32 v156, v156, v157
    v_cvt_pk_bf16_f32 v157, v158, v159
    ds_write_b64 v54, v[156:157] offset:14176
    s_mov_b64 exec, 1
    ds_add_u32 v15, v14 offset:12
    s_mov_b64 exec, -1
    s_cmp_ge_u32 s31, 4
    s_cbranch_scc1 L_A_oY3
    s_mov_b32 s3, 0x100000
L_A_wY3:
    ds_read_b32 v13, v15 offset:12
    s_sub_u32 s3, s3, 1
    s_cbranch_scc1 L_A_xY3
    s_waitcnt lgkmcnt(0)
    v_cmp_eq_u32 vcc, 12, v13
    s_nop 4
    s_cbranch_vccnz L_A_xY3
    s_sleep 1
    s_branch L_A_wY3
L_A_xY3:
    s_and_b32 s3, s31, 3
    s_cmp_lt_u32 s3, 2
    s_cselect_b32 s4, 4, 7
    s_and_b32 s3, s3, 1
    s_lshl_b32 s5, s4, 9
    s_lshl_b32 s6, s3, 8
    s_add_u32 s5, s5, s6
    s_add_u32 s5, s5, 65888
    v_lshl_add_u32 v12, v1, 2, s5
    v_add_u32 v13, 50304, v12
    ds_read_b32 v160, v12 offset:0
    ds_read_b32 v161, v12 offset:16768
    ds_read_b32 v162, v12 offset:33536
    ds_read_b32 v163, v13 offset:0
    ds_read_b32 v164, v13 offset:16768
    ds_read_b32 v165, v13 offset:33536
    s_lshl_b32 s4, s4, 8
    s_lshl_b32 s3, s3, 3
    s_add_u32 s4, s4, s3
    s_mul_i32 s4, s4, 2304
    s_add_u32 s4, s4, s54
    v_add_u32 v13, s4, v8
    s_waitcnt lgkmcnt(0)
    v_perm_b32 v10, v161, v160, s52
    v_perm_b32 v11, v163, v162, s52
    v_perm_b32 v12, v165, v164, s52
    global_store_dwordx3 v13, v[10:12], s[60:61] offset:0
    v_perm_b32 v160, v161, v160, s53
    v_perm_b32 v161, v163, v162, s53
    v_perm_b32 v162, v165, v164, s53
    global_store_dwordx3 v13, v[160:162], s[60:61] offset:2304
L_A_oY3:
L_A_out:
L_end:
L_exit:
    s_endpgm
.fill 2048, 4, 0xbf810000
.section .rodata,"a"
.p2align 6
.amdhsa_kernel concat_heads__ssm_conv_s4d__spectral_gfnet__prompt_kernel
  .amdhsa_next_free_vgpr 168
  .amdhsa_next_free_sgpr 102
  .amdhsa_accum_offset 168
  .amdhsa_group_segment_fixed_size 0
  .amdhsa_kernarg_size 104
  .amdhsa_user_sgpr_count 2
  .amdhsa_user_sgpr_kernarg_segment_ptr 1
  .amdhsa_system_sgpr_workgroup_id_x 1
.end_amdhsa_kernel
```
